```python
import torch

def _softmax(x, axis=-1):
    return torch.softmax(x, dim=axis)
def _gelu(x):
    return torch.nn.functional.gelu(x, approximate="tanh")
def _silu(x):
    return torch.nn.functional.silu(x)
def _sigmoid(x):
    return torch.sigmoid(x)
def _layernorm(x, axis=-1, eps=1e-5):
    m = x.mean(dim=axis, keepdim=True)
    v = x.var(dim=axis, keepdim=True, unbiased=False)
    return (x - m) / torch.sqrt(v + eps)
def _scatter_add(tgt, idx, src, axis=0):
    return tgt.clone().index_add_(axis, idx, src)
def _segment_sum(src, seg, n):
    out = torch.zeros((n,) + src.shape[1:], dtype=src.dtype)
    return out.index_add_(0, seg, src)
def _pad(x, pw):
    flat = tuple(v for pair in reversed(pw) for v in pair)
    return torch.nn.functional.pad(x, flat)

kernel_name = 'recurrent_scan__spectral_fnet__glu_gated_bilinear__prompt'

def setup_inputs():

    _w = (lambda a: (lambda t: t.to(torch.bfloat16) if t.is_floating_point() else t)(torch.as_tensor(a)))
    def _A_setup():
        B, S, D = 1, 2048, 1024
        ns = torch.arange(S)[:, None] * torch.arange(S)[None, :]
        nd = torch.arange(D)[:, None] * torch.arange(D)[None, :]
        Ws_re = torch.cos(-2.0 * torch.pi * ns / S).to(float)
        Ws_im = torch.sin(-2.0 * torch.pi * ns / S).to(float)
        Wd_re = torch.cos(-2.0 * torch.pi * nd / D).to(float)
        Wd_im = torch.sin(-2.0 * torch.pi * nd / D).to(float)
        return {
            "x": _w((lambda *s: torch.randn(*s, dtype=torch.bfloat16) * 0.05)(B, S, D)),
            "dft_seq_re": _w(Ws_re),
            "dft_seq_im": _w(Ws_im),
            "dft_hid_re": _w(Wd_re),
            "dft_hid_im": _w(Wd_im),
        }
    _A_in = _A_setup()

    def _B_setup():
        B, S, D, F = 1, 2048, 1024, 3584
        return {
            "x": _w((lambda *s: torch.randn(*s, dtype=torch.bfloat16) * 0.05)(B, S, D)),
            "w_gate": _w((lambda *s: torch.randn(*s, dtype=torch.bfloat16) * 0.05)(D, F) * (D ** -0.5)),
            "w_up": _w((lambda *s: torch.randn(*s, dtype=torch.bfloat16) * 0.05)(D, F) * (D ** -0.5)),
            "w_down": _w((lambda *s: torch.randn(*s, dtype=torch.bfloat16) * 0.05)(F, D) * (F ** -0.5)),
        }
    _B_in = _B_setup()

    return {
        "A_x": _A_in["x"],
        "A_dft_seq_re": _A_in["dft_seq_re"],
        "A_dft_seq_im": _A_in["dft_seq_im"],
        "A_dft_hid_re": _A_in["dft_hid_re"],
        "A_dft_hid_im": _A_in["dft_hid_im"],
        "B_x": _B_in["x"],
        "B_w_gate": _B_in["w_gate"],
        "B_w_up": _B_in["w_up"],
        "B_w_down": _B_in["w_down"],
    }

def reference(A_x, A_dft_seq_re, A_dft_seq_im, A_dft_hid_re, A_dft_hid_im, B_x, B_w_gate, B_w_up, B_w_down):
    def _A_ref(x, dft_seq_re, dft_seq_im, dft_hid_re, dft_hid_im):
        a = torch.einsum("bsd,ed->bse", x, dft_hid_re)
        b = torch.einsum("bsd,ed->bse", x, dft_hid_im)
        y = torch.einsum("ts,bse->bte", dft_seq_re, a) - torch.einsum("ts,bse->bte", dft_seq_im, b)
        return y

    def _B_ref(x, w_gate, w_up, w_down):
        g = torch.einsum("bsd,df->bsf", x, w_gate)
        u = torch.einsum("bsd,df->bsf", x, w_up)
        h = g * u
        return torch.einsum("bsf,fd->bsd", h, w_down)

    x = A_x
    xn = _layernorm(x, axis=-1)
    s = _A_ref(xn, A_dft_seq_re, A_dft_seq_im, A_dft_hid_re, A_dft_hid_im)
    g = _silu(_B_ref(xn, B_w_gate, B_w_up, B_w_down))
    return x + s * g
```

```asm
; @launch grid=(256,1,1) block=(256,1,1) lds=163840
.amdgcn_target "amdgcn-amd-amdhsa--gfx950"
.text
.globl recurrent_scan__spectral_fnet__glu_gated_bilinear__prompt_kernel
.p2align 8
.type recurrent_scan__spectral_fnet__glu_gated_bilinear__prompt_kernel,@function
recurrent_scan__spectral_fnet__glu_gated_bilinear__prompt_kernel:
  s_cmp_ge_u32 s2, 256
  s_cbranch_scc1 L_done
  s_load_dwordx16 s[64:79], s[0:1], 0
  s_load_dwordx8 s[80:87], s[0:1], 64
  v_lshrrev_b32 v2, 6, v0
  v_and_b32 v1, 63, v0
  s_nop 0
  v_readfirstlane_b32 s3, v2
  s_and_b32 s41, s2, 7
  s_lshr_b32 s42, s2, 3
  s_lshr_b32 s37, s3, 1
  s_and_b32 s38, s3, 1
  s_getpc_b64 s[24:25]
L_pc:
  s_sub_u32 s24, s24, L_pc-recurrent_scan__spectral_fnet__glu_gated_bilinear__prompt_kernel
  s_subb_u32 s25, s25, 0
  s_mov_b32 s26, L_end-recurrent_scan__spectral_fnet__glu_gated_bilinear__prompt_kernel
  s_mov_b32 s27, 0x20000
  v_lshlrev_b32 v26, 7, v1
  buffer_load_dword v29, v26, s[24:27], 0 offen
  s_lshl_b32 s4, s42, 2
  s_add_u32 s4, s4, s3
  s_lshl_b32 s4, s4, 9
  v_add_u32 v26, s4, v26
  s_mov_b64 exec, 15
  buffer_load_dword v29, v26, s[24:27], 0 offen
  s_mov_b64 exec, -1
  s_sub_u32 s44, s42, 4
  s_and_b32 s54, s41, 1
  s_lshl_b32 s54, s54, 2
  s_and_b32 s45, s44, 3
  s_add_u32 s54, s54, s45
  s_lshr_b32 s55, s41, 1
  s_mul_i32 s55, s55, 7
  s_lshr_b32 s45, s44, 2
  s_add_u32 s55, s55, s45
  s_mul_i32 s43, s54, 28
  s_add_u32 s43, s43, s55
  s_lshl_b32 s44, s41, 2
  s_add_u32 s44, s44, s42
  s_add_u32 s44, s44, 224
  s_cmp_lt_u32 s42, 4
  s_cselect_b32 s43, s44, s43
  v_lshlrev_b32 v32, 4, v1
  v_sub_u32 v33, 0x7f0, v32
  s_lshl_b32 s44, s43, 2
  s_add_u32 s44, s44, s3
  s_sub_u32 s45, 2048, s44
  s_cmp_eq_u32 s44, 0
  s_cselect_b32 s45, 1024, s45
  s_lshl_b32 s46, s44, 11
  s_lshl_b32 s47, s45, 11
  s_waitcnt lgkmcnt(0)
  s_mov_b32 s20, s64
  s_mov_b32 s21, s65
  s_mov_b32 s22, 0x400000
  s_mov_b32 s23, 0x20000
  buffer_load_dwordx4 v[40:43], v32, s[20:23], s46 offen
  buffer_load_dwordx4 v[44:47], v33, s[20:23], s46 offen
  buffer_load_dwordx4 v[48:51], v32, s[20:23], s47 offen
  buffer_load_dwordx4 v[52:55], v33, s[20:23], s47 offen
  s_mov_b32 s28, s84
  s_mov_b32 s29, s85
  s_mov_b32 s30, 0x100
  s_mov_b32 s31, 0x20000
  v_mov_b32 v18, 0
  s_or_b32 s4, s2, s3
  s_cmp_lg_u32 s4, 0
  s_cbranch_scc1 tg_1
  s_memrealtime s[4:5]
  s_waitcnt lgkmcnt(0)
  s_lshl_b32 s4, s4, 3
  s_or_b32 s4, s4, 0x80000000
  v_mov_b32 v19, s4
  buffer_store_dword v19, v18, s[28:31], 0 offen sc1
tg_1:
  s_mov_b32 s24, s86
  s_mov_b32 s25, s87
  s_mov_b32 s26, 0x2000000
  s_mov_b32 s27, 0x20000
  s_mov_b32 s48, 0xffff0000
  s_waitcnt vmcnt(2)
  v_lshlrev_b32 v56, 16, v40
  v_and_b32 v57, s48, v40
  v_lshlrev_b32 v58, 16, v41
  v_and_b32 v59, s48, v41
  v_lshlrev_b32 v60, 16, v42
  v_and_b32 v61, s48, v42
  v_lshlrev_b32 v62, 16, v43
  v_and_b32 v63, s48, v43
  v_lshlrev_b32 v64, 16, v44
  v_and_b32 v65, s48, v44
  v_lshlrev_b32 v66, 16, v45
  v_and_b32 v67, s48, v45
  v_lshlrev_b32 v68, 16, v46
  v_and_b32 v69, s48, v46
  v_lshlrev_b32 v70, 16, v47
  v_and_b32 v71, s48, v47
  s_waitcnt vmcnt(0)
  v_lshlrev_b32 v72, 16, v48
  v_and_b32 v73, s48, v48
  v_lshlrev_b32 v74, 16, v49
  v_and_b32 v75, s48, v49
  v_lshlrev_b32 v76, 16, v50
  v_and_b32 v77, s48, v50
  v_lshlrev_b32 v78, 16, v51
  v_and_b32 v79, s48, v51
  v_lshlrev_b32 v80, 16, v52
  v_and_b32 v81, s48, v52
  v_lshlrev_b32 v82, 16, v53
  v_and_b32 v83, s48, v53
  v_lshlrev_b32 v84, 16, v54
  v_and_b32 v85, s48, v54
  v_lshlrev_b32 v86, 16, v55
  v_and_b32 v87, s48, v55
  v_pk_add_f32 v[88:89], v[56:57], v[58:59]
  v_pk_add_f32 v[90:91], v[60:61], v[62:63]
  v_pk_add_f32 v[88:89], v[88:89], v[64:65]
  v_pk_add_f32 v[90:91], v[90:91], v[66:67]
  v_pk_add_f32 v[88:89], v[88:89], v[68:69]
  v_pk_add_f32 v[90:91], v[90:91], v[70:71]
  v_pk_add_f32 v[88:89], v[88:89], v[90:91]
  v_add_f32 v88, v88, v89
  v_pk_add_f32 v[92:93], v[72:73], v[74:75]
  v_pk_add_f32 v[94:95], v[76:77], v[78:79]
  v_pk_add_f32 v[92:93], v[92:93], v[80:81]
  v_pk_add_f32 v[94:95], v[94:95], v[82:83]
  v_pk_add_f32 v[92:93], v[92:93], v[84:85]
  v_pk_add_f32 v[94:95], v[94:95], v[86:87]
  v_pk_add_f32 v[92:93], v[92:93], v[94:95]
  v_add_f32 v92, v92, v93
  s_nop 0
  v_add_f32_dpp v88, v88, v88 quad_perm:[1,0,3,2] row_mask:0xf bank_mask:0xf
  v_add_f32_dpp v92, v92, v92 quad_perm:[1,0,3,2] row_mask:0xf bank_mask:0xf
  s_nop 0
  v_add_f32_dpp v88, v88, v88 quad_perm:[2,3,0,1] row_mask:0xf bank_mask:0xf
  v_add_f32_dpp v92, v92, v92 quad_perm:[2,3,0,1] row_mask:0xf bank_mask:0xf
  s_nop 0
  v_add_f32_dpp v88, v88, v88 row_half_mirror row_mask:0xf bank_mask:0xf
  v_add_f32_dpp v92, v92, v92 row_half_mirror row_mask:0xf bank_mask:0xf
  s_nop 0
  v_add_f32_dpp v88, v88, v88 row_mirror row_mask:0xf bank_mask:0xf
  v_add_f32_dpp v92, v92, v92 row_mirror row_mask:0xf bank_mask:0xf
  s_nop 0
  v_add_f32_dpp v88, v88, v88 row_bcast:15 row_mask:0xa bank_mask:0xf
  v_add_f32_dpp v92, v92, v92 row_bcast:15 row_mask:0xa bank_mask:0xf
  s_nop 0
  v_add_f32_dpp v88, v88, v88 row_bcast:31 row_mask:0xc bank_mask:0xf
  v_add_f32_dpp v92, v92, v92 row_bcast:31 row_mask:0xc bank_mask:0xf
  s_nop 1
  v_readlane_b32 s50, v88, 63
  v_readlane_b32 s51, v92, 63
  v_mov_b32 v34, 0x3a800000
  s_nop 0
  v_mul_f32 v88, s50, v34
  v_mul_f32 v92, s51, v34
  v_mov_b32 v89, v88
  v_mov_b32 v93, v92
  v_mov_b32 v96, 0
  v_mov_b32 v97, 0
  v_mov_b32 v100, 0
  v_mov_b32 v101, 0
  v_pk_add_f32 v[98:99], v[56:57], v[88:89] neg_lo:[0,1] neg_hi:[0,1]
  v_pk_add_f32 v[102:103], v[72:73], v[92:93] neg_lo:[0,1] neg_hi:[0,1]
  v_pk_fma_f32 v[96:97], v[98:99], v[98:99], v[96:97]
  v_pk_fma_f32 v[100:101], v[102:103], v[102:103], v[100:101]
  v_pk_add_f32 v[98:99], v[58:59], v[88:89] neg_lo:[0,1] neg_hi:[0,1]
  v_pk_add_f32 v[102:103], v[74:75], v[92:93] neg_lo:[0,1] neg_hi:[0,1]
  v_pk_fma_f32 v[96:97], v[98:99], v[98:99], v[96:97]
  v_pk_fma_f32 v[100:101], v[102:103], v[102:103], v[100:101]
  v_pk_add_f32 v[98:99], v[60:61], v[88:89] neg_lo:[0,1] neg_hi:[0,1]
  v_pk_add_f32 v[102:103], v[76:77], v[92:93] neg_lo:[0,1] neg_hi:[0,1]
  v_pk_fma_f32 v[96:97], v[98:99], v[98:99], v[96:97]
  v_pk_fma_f32 v[100:101], v[102:103], v[102:103], v[100:101]
  v_pk_add_f32 v[98:99], v[62:63], v[88:89] neg_lo:[0,1] neg_hi:[0,1]
  v_pk_add_f32 v[102:103], v[78:79], v[92:93] neg_lo:[0,1] neg_hi:[0,1]
  v_pk_fma_f32 v[96:97], v[98:99], v[98:99], v[96:97]
  v_pk_fma_f32 v[100:101], v[102:103], v[102:103], v[100:101]
  v_pk_add_f32 v[98:99], v[64:65], v[88:89] neg_lo:[0,1] neg_hi:[0,1]
  v_pk_add_f32 v[102:103], v[80:81], v[92:93] neg_lo:[0,1] neg_hi:[0,1]
  v_pk_fma_f32 v[96:97], v[98:99], v[98:99], v[96:97]
  v_pk_fma_f32 v[100:101], v[102:103], v[102:103], v[100:101]
  v_pk_add_f32 v[98:99], v[66:67], v[88:89] neg_lo:[0,1] neg_hi:[0,1]
  v_pk_add_f32 v[102:103], v[82:83], v[92:93] neg_lo:[0,1] neg_hi:[0,1]
  v_pk_fma_f32 v[96:97], v[98:99], v[98:99], v[96:97]
  v_pk_fma_f32 v[100:101], v[102:103], v[102:103], v[100:101]
  v_pk_add_f32 v[98:99], v[68:69], v[88:89] neg_lo:[0,1] neg_hi:[0,1]
  v_pk_add_f32 v[102:103], v[84:85], v[92:93] neg_lo:[0,1] neg_hi:[0,1]
  v_pk_fma_f32 v[96:97], v[98:99], v[98:99], v[96:97]
  v_pk_fma_f32 v[100:101], v[102:103], v[102:103], v[100:101]
  v_pk_add_f32 v[98:99], v[70:71], v[88:89] neg_lo:[0,1] neg_hi:[0,1]
  v_pk_add_f32 v[102:103], v[86:87], v[92:93] neg_lo:[0,1] neg_hi:[0,1]
  v_pk_fma_f32 v[96:97], v[98:99], v[98:99], v[96:97]
  v_pk_fma_f32 v[100:101], v[102:103], v[102:103], v[100:101]
  v_add_f32 v96, v96, v97
  v_add_f32 v100, v100, v101
  s_nop 0
  v_add_f32_dpp v96, v96, v96 quad_perm:[1,0,3,2] row_mask:0xf bank_mask:0xf
  v_add_f32_dpp v100, v100, v100 quad_perm:[1,0,3,2] row_mask:0xf bank_mask:0xf
  s_nop 0
  v_add_f32_dpp v96, v96, v96 quad_perm:[2,3,0,1] row_mask:0xf bank_mask:0xf
  v_add_f32_dpp v100, v100, v100 quad_perm:[2,3,0,1] row_mask:0xf bank_mask:0xf
  s_nop 0
  v_add_f32_dpp v96, v96, v96 row_half_mirror row_mask:0xf bank_mask:0xf
  v_add_f32_dpp v100, v100, v100 row_half_mirror row_mask:0xf bank_mask:0xf
  s_nop 0
  v_add_f32_dpp v96, v96, v96 row_mirror row_mask:0xf bank_mask:0xf
  v_add_f32_dpp v100, v100, v100 row_mirror row_mask:0xf bank_mask:0xf
  s_nop 0
  v_add_f32_dpp v96, v96, v96 row_bcast:15 row_mask:0xa bank_mask:0xf
  v_add_f32_dpp v100, v100, v100 row_bcast:15 row_mask:0xa bank_mask:0xf
  s_nop 0
  v_add_f32_dpp v96, v96, v96 row_bcast:31 row_mask:0xc bank_mask:0xf
  v_add_f32_dpp v100, v100, v100 row_bcast:31 row_mask:0xc bank_mask:0xf
  s_nop 1
  v_readlane_b32 s50, v96, 63
  v_readlane_b32 s51, v100, 63
  v_cvt_pk_bf16_f32 v90, v88, v92
  s_nop 0
  v_mul_f32 v96, s50, v34
  v_mul_f32 v100, s51, v34
  v_lshlrev_b32 v88, 16, v90
  v_and_b32 v92, s48, v90
  v_cvt_pk_bf16_f32 v97, v96, v100
  v_mov_b32 v89, v88
  v_mov_b32 v93, v92
  v_lshlrev_b32 v96, 16, v97
  v_and_b32 v100, s48, v97
  v_add_f32 v96, 0x3727c5ac, v96
  v_add_f32 v100, 0x3727c5ac, v100
  v_cvt_pk_bf16_f32 v97, v96, v100
  v_lshlrev_b32 v96, 16, v97
  v_and_b32 v100, s48, v97
  v_sqrt_f32 v96, v96
  v_sqrt_f32 v100, v100
  v_pk_add_f32 v[56:57], v[56:57], v[88:89] neg_lo:[0,1] neg_hi:[0,1]
  v_pk_add_f32 v[58:59], v[58:59], v[88:89] neg_lo:[0,1] neg_hi:[0,1]
  v_pk_add_f32 v[60:61], v[60:61], v[88:89] neg_lo:[0,1] neg_hi:[0,1]
  v_pk_add_f32 v[62:63], v[62:63], v[88:89] neg_lo:[0,1] neg_hi:[0,1]
  v_pk_add_f32 v[64:65], v[64:65], v[88:89] neg_lo:[0,1] neg_hi:[0,1]
  v_pk_add_f32 v[66:67], v[66:67], v[88:89] neg_lo:[0,1] neg_hi:[0,1]
  v_pk_add_f32 v[68:69], v[68:69], v[88:89] neg_lo:[0,1] neg_hi:[0,1]
  v_pk_add_f32 v[70:71], v[70:71], v[88:89] neg_lo:[0,1] neg_hi:[0,1]
  v_pk_add_f32 v[72:73], v[72:73], v[92:93] neg_lo:[0,1] neg_hi:[0,1]
  v_pk_add_f32 v[74:75], v[74:75], v[92:93] neg_lo:[0,1] neg_hi:[0,1]
  v_pk_add_f32 v[76:77], v[76:77], v[92:93] neg_lo:[0,1] neg_hi:[0,1]
  v_pk_add_f32 v[78:79], v[78:79], v[92:93] neg_lo:[0,1] neg_hi:[0,1]
  v_pk_add_f32 v[80:81], v[80:81], v[92:93] neg_lo:[0,1] neg_hi:[0,1]
  v_pk_add_f32 v[82:83], v[82:83], v[92:93] neg_lo:[0,1] neg_hi:[0,1]
  v_pk_add_f32 v[84:85], v[84:85], v[92:93] neg_lo:[0,1] neg_hi:[0,1]
  v_pk_add_f32 v[86:87], v[86:87], v[92:93] neg_lo:[0,1] neg_hi:[0,1]
  v_cvt_pk_bf16_f32 v97, v96, v100
  v_lshlrev_b32 v96, 16, v97
  v_and_b32 v100, s48, v97
  v_rcp_f32 v96, v96
  v_rcp_f32 v100, v100
  v_cvt_pk_bf16_f32 v40, v56, v57
  v_cvt_pk_bf16_f32 v41, v58, v59
  v_cvt_pk_bf16_f32 v42, v60, v61
  v_cvt_pk_bf16_f32 v43, v62, v63
  v_cvt_pk_bf16_f32 v44, v64, v65
  v_cvt_pk_bf16_f32 v45, v66, v67
  v_cvt_pk_bf16_f32 v46, v68, v69
  v_cvt_pk_bf16_f32 v47, v70, v71
  v_cvt_pk_bf16_f32 v48, v72, v73
  v_cvt_pk_bf16_f32 v49, v74, v75
  v_cvt_pk_bf16_f32 v50, v76, v77
  v_cvt_pk_bf16_f32 v51, v78, v79
  v_cvt_pk_bf16_f32 v52, v80, v81
  v_cvt_pk_bf16_f32 v53, v82, v83
  v_cvt_pk_bf16_f32 v54, v84, v85
  v_cvt_pk_bf16_f32 v55, v86, v87
  v_mov_b32 v97, v96
  v_mov_b32 v101, v100
  v_lshlrev_b32 v56, 16, v40
  v_and_b32 v57, s48, v40
  v_lshlrev_b32 v58, 16, v41
  v_and_b32 v59, s48, v41
  v_lshlrev_b32 v60, 16, v42
  v_and_b32 v61, s48, v42
  v_lshlrev_b32 v62, 16, v43
  v_and_b32 v63, s48, v43
  v_lshlrev_b32 v64, 16, v44
  v_and_b32 v65, s48, v44
  v_lshlrev_b32 v66, 16, v45
  v_and_b32 v67, s48, v45
  v_lshlrev_b32 v68, 16, v46
  v_and_b32 v69, s48, v46
  v_lshlrev_b32 v70, 16, v47
  v_and_b32 v71, s48, v47
  v_pk_mul_f32 v[56:57], v[56:57], v[96:97]
  v_pk_mul_f32 v[58:59], v[58:59], v[96:97]
  v_pk_mul_f32 v[60:61], v[60:61], v[96:97]
  v_pk_mul_f32 v[62:63], v[62:63], v[96:97]
  v_pk_mul_f32 v[64:65], v[64:65], v[96:97]
  v_pk_mul_f32 v[66:67], v[66:67], v[96:97]
  v_pk_mul_f32 v[68:69], v[68:69], v[96:97]
  v_pk_mul_f32 v[70:71], v[70:71], v[96:97]
  v_cvt_pk_bf16_f32 v40, v56, v57
  v_cvt_pk_bf16_f32 v41, v58, v59
  v_cvt_pk_bf16_f32 v42, v60, v61
  v_cvt_pk_bf16_f32 v43, v62, v63
  v_cvt_pk_bf16_f32 v44, v64, v65
  v_cvt_pk_bf16_f32 v45, v66, v67
  v_cvt_pk_bf16_f32 v46, v68, v69
  v_cvt_pk_bf16_f32 v47, v70, v71
  v_lshlrev_b32 v72, 16, v48
  v_and_b32 v73, s48, v48
  v_lshlrev_b32 v74, 16, v49
  v_and_b32 v75, s48, v49
  v_lshlrev_b32 v76, 16, v50
  v_and_b32 v77, s48, v50
  v_lshlrev_b32 v78, 16, v51
  v_and_b32 v79, s48, v51
  v_lshlrev_b32 v80, 16, v52
  v_and_b32 v81, s48, v52
  v_lshlrev_b32 v82, 16, v53
  v_and_b32 v83, s48, v53
  v_lshlrev_b32 v84, 16, v54
  v_and_b32 v85, s48, v54
  v_lshlrev_b32 v86, 16, v55
  v_and_b32 v87, s48, v55
  v_pk_mul_f32 v[72:73], v[72:73], v[100:101]
  v_pk_mul_f32 v[74:75], v[74:75], v[100:101]
  v_pk_mul_f32 v[76:77], v[76:77], v[100:101]
  v_pk_mul_f32 v[78:79], v[78:79], v[100:101]
  v_pk_mul_f32 v[80:81], v[80:81], v[100:101]
  v_pk_mul_f32 v[82:83], v[82:83], v[100:101]
  v_pk_mul_f32 v[84:85], v[84:85], v[100:101]
  v_pk_mul_f32 v[86:87], v[86:87], v[100:101]
  v_cvt_pk_bf16_f32 v48, v72, v73
  v_cvt_pk_bf16_f32 v49, v74, v75
  v_cvt_pk_bf16_f32 v50, v76, v77
  v_cvt_pk_bf16_f32 v51, v78, v79
  v_cvt_pk_bf16_f32 v52, v80, v81
  v_cvt_pk_bf16_f32 v53, v82, v83
  v_cvt_pk_bf16_f32 v54, v84, v85
  v_cvt_pk_bf16_f32 v55, v86, v87
  s_mul_i32 s49, s3, 2064
  s_add_u32 s49, s49, 131072
  v_add_u32 v35, s49, v32
  v_add_u32 v36, s49, v33
  ds_write_b128 v35, v[40:43]
  ds_write_b128 v36, v[44:47]
  ds_write_b128 v35, v[48:51] offset:8256
  ds_write_b128 v36, v[52:55] offset:8256
  v_lshlrev_b32 v56, 16, v40
  v_and_b32 v57, s48, v40
  v_lshlrev_b32 v58, 16, v41
  v_and_b32 v59, s48, v41
  v_lshlrev_b32 v60, 16, v42
  v_and_b32 v61, s48, v42
  v_lshlrev_b32 v62, 16, v43
  v_and_b32 v63, s48, v43
  v_lshlrev_b32 v64, 16, v44
  v_and_b32 v65, s48, v44
  v_lshlrev_b32 v66, 16, v45
  v_and_b32 v67, s48, v45
  v_lshlrev_b32 v68, 16, v46
  v_and_b32 v69, s48, v46
  v_lshlrev_b32 v70, 16, v47
  v_and_b32 v71, s48, v47
  v_lshlrev_b32 v72, 16, v48
  v_and_b32 v73, s48, v48
  v_lshlrev_b32 v74, 16, v49
  v_and_b32 v75, s48, v49
  v_lshlrev_b32 v76, 16, v50
  v_and_b32 v77, s48, v50
  v_lshlrev_b32 v78, 16, v51
  v_and_b32 v79, s48, v51
  v_lshlrev_b32 v80, 16, v52
  v_and_b32 v81, s48, v52
  v_lshlrev_b32 v82, 16, v53
  v_and_b32 v83, s48, v53
  v_lshlrev_b32 v84, 16, v54
  v_and_b32 v85, s48, v54
  v_lshlrev_b32 v86, 16, v55
  v_and_b32 v87, s48, v55
  s_mul_i32 s49, s3, 1040
  s_add_u32 s49, s49, 147584
  v_add_u32 v37, s49, v32
  s_cmp_eq_u32 s44, 0
  s_cbranch_scc1 ln_pair0
  v_pk_add_f32 v[120:121], v[56:57], v[72:73] neg_lo:[0,1] neg_hi:[0,1]
  v_pk_add_f32 v[122:123], v[58:59], v[74:75] neg_lo:[0,1] neg_hi:[0,1]
  v_pk_add_f32 v[124:125], v[60:61], v[76:77] neg_lo:[0,1] neg_hi:[0,1]
  v_pk_add_f32 v[126:127], v[62:63], v[78:79] neg_lo:[0,1] neg_hi:[0,1]
  v_pk_add_f32 v[128:129], v[64:65], v[80:81] neg_lo:[0,1] neg_hi:[0,1]
  v_pk_add_f32 v[130:131], v[66:67], v[82:83] neg_lo:[0,1] neg_hi:[0,1]
  v_pk_add_f32 v[132:133], v[68:69], v[84:85] neg_lo:[0,1] neg_hi:[0,1]
  v_pk_add_f32 v[134:135], v[70:71], v[86:87] neg_lo:[0,1] neg_hi:[0,1]
  v_pk_add_f32 v[104:105], v[56:57], v[72:73]
  v_pk_add_f32 v[106:107], v[58:59], v[74:75]
  v_pk_add_f32 v[108:109], v[60:61], v[76:77]
  v_pk_add_f32 v[110:111], v[62:63], v[78:79]
  v_pk_add_f32 v[112:113], v[64:65], v[80:81]
  v_pk_add_f32 v[114:115], v[66:67], v[82:83]
  v_pk_add_f32 v[116:117], v[68:69], v[84:85]
  v_pk_add_f32 v[118:119], v[70:71], v[86:87]
  s_nop 1
  v_mov_b32_dpp v148, v128 wave_shr:1 row_mask:0xf bank_mask:0xf bound_ctrl:0
  v_sub_f32 v141, v121, v135
  v_sub_f32 v142, v122, v134
  v_sub_f32 v143, v123, v133
  v_sub_f32 v144, v124, v132
  v_sub_f32 v145, v125, v131
  v_sub_f32 v146, v126, v130
  v_sub_f32 v147, v127, v129
  v_sub_f32 v140, v120, v148
  v_cvt_pk_bf16_f32 v136, v140, v141
  v_cvt_pk_bf16_f32 v137, v142, v143
  v_cvt_pk_bf16_f32 v138, v144, v145
  v_cvt_pk_bf16_f32 v139, v146, v147
  ds_write_b128 v37, v[136:139] offset:5200
  s_nop 1
  v_mov_b32_dpp v148, v112 wave_shr:1 row_mask:0xf bank_mask:0xf bound_ctrl:0
  v_add_f32 v141, v105, v119
  v_add_f32 v142, v106, v118
  v_add_f32 v143, v107, v117
  v_add_f32 v144, v108, v116
  v_add_f32 v145, v109, v115
  v_add_f32 v146, v110, v114
  v_add_f32 v147, v111, v113
  v_add_f32 v140, v104, v148
  v_cvt_pk_bf16_f32 v136, v140, v141
  v_cvt_pk_bf16_f32 v137, v142, v143
  v_cvt_pk_bf16_f32 v138, v144, v145
  v_cvt_pk_bf16_f32 v139, v146, v147
  ds_write_b128 v37, v[136:139] offset:0
  v_pk_add_f32 v[140:141], v[104:105], v[106:107]
  v_pk_add_f32 v[140:141], v[140:141], v[108:109]
  v_pk_add_f32 v[140:141], v[140:141], v[110:111]
  v_pk_add_f32 v[140:141], v[140:141], v[112:113]
  v_pk_add_f32 v[140:141], v[140:141], v[114:115]
  v_pk_add_f32 v[140:141], v[140:141], v[116:117]
  v_pk_add_f32 v[140:141], v[140:141], v[118:119]
  v_sub_f32 v140, v140, v141
  s_nop 1
  v_add_f32_dpp v140, v140, v140 quad_perm:[1,0,3,2] row_mask:0xf bank_mask:0xf
  s_nop 1
  v_add_f32_dpp v140, v140, v140 quad_perm:[2,3,0,1] row_mask:0xf bank_mask:0xf
  s_nop 1
  v_add_f32_dpp v140, v140, v140 row_half_mirror row_mask:0xf bank_mask:0xf
  s_nop 1
  v_add_f32_dpp v140, v140, v140 row_mirror row_mask:0xf bank_mask:0xf
  s_nop 1
  v_add_f32_dpp v140, v140, v140 row_bcast:15 row_mask:0xa bank_mask:0xf
  s_nop 1
  v_add_f32_dpp v140, v140, v140 row_bcast:31 row_mask:0xc bank_mask:0xf
  s_nop 1
  s_mov_b32 exec_lo, 0
  s_mov_b32 exec_hi, 0x80000000
  s_lshl_b32 s50, s3, 2
  s_add_u32 s50, s50, 156944
  v_mov_b32 v142, s50
  ds_write_b32 v142, v112
  ds_write_b32 v142, v140 offset:16
  s_mov_b64 exec, -1
  s_branch ln_join
ln_pair0:
  s_nop 1
  v_mov_b32_dpp v148, v64 wave_shr:1 row_mask:0xf bank_mask:0xf bound_ctrl:0
  v_add_f32 v141, v57, v71
  v_add_f32 v142, v58, v70
  v_add_f32 v143, v59, v69
  v_add_f32 v144, v60, v68
  v_add_f32 v145, v61, v67
  v_add_f32 v146, v62, v66
  v_add_f32 v147, v63, v65
  v_add_f32 v140, v56, v148
  v_cvt_pk_bf16_f32 v136, v140, v141
  v_cvt_pk_bf16_f32 v137, v142, v143
  v_cvt_pk_bf16_f32 v138, v144, v145
  v_cvt_pk_bf16_f32 v139, v146, v147
  ds_write_b128 v37, v[136:139] offset:0
  v_pk_add_f32 v[140:141], v[56:57], v[58:59]
  v_pk_add_f32 v[140:141], v[140:141], v[60:61]
  v_pk_add_f32 v[140:141], v[140:141], v[62:63]
  v_pk_add_f32 v[140:141], v[140:141], v[64:65]
  v_pk_add_f32 v[140:141], v[140:141], v[66:67]
  v_pk_add_f32 v[140:141], v[140:141], v[68:69]
  v_pk_add_f32 v[140:141], v[140:141], v[70:71]
  v_sub_f32 v140, v140, v141
  s_nop 1
  v_add_f32_dpp v140, v140, v140 quad_perm:[1,0,3,2] row_mask:0xf bank_mask:0xf
  s_nop 1
  v_add_f32_dpp v140, v140, v140 quad_perm:[2,3,0,1] row_mask:0xf bank_mask:0xf
  s_nop 1
  v_add_f32_dpp v140, v140, v140 row_half_mirror row_mask:0xf bank_mask:0xf
  s_nop 1
  v_add_f32_dpp v140, v140, v140 row_mirror row_mask:0xf bank_mask:0xf
  s_nop 1
  v_add_f32_dpp v140, v140, v140 row_bcast:15 row_mask:0xa bank_mask:0xf
  s_nop 1
  v_add_f32_dpp v140, v140, v140 row_bcast:31 row_mask:0xc bank_mask:0xf
  s_nop 1
  s_mov_b32 exec_lo, 0
  s_mov_b32 exec_hi, 0x80000000
  s_lshl_b32 s50, s3, 2
  s_add_u32 s50, s50, 156944
  v_mov_b32 v142, s50
  ds_write_b32 v142, v64
  ds_write_b32 v142, v140 offset:16
  s_mov_b64 exec, -1
  s_nop 1
  v_mov_b32_dpp v148, v80 wave_shr:1 row_mask:0xf bank_mask:0xf bound_ctrl:0
  v_add_f32 v141, v73, v87
  v_add_f32 v142, v74, v86
  v_add_f32 v143, v75, v85
  v_add_f32 v144, v76, v84
  v_add_f32 v145, v77, v83
  v_add_f32 v146, v78, v82
  v_add_f32 v147, v79, v81
  v_add_f32 v140, v72, v148
  v_cvt_pk_bf16_f32 v136, v140, v141
  v_cvt_pk_bf16_f32 v137, v142, v143
  v_cvt_pk_bf16_f32 v138, v144, v145
  v_cvt_pk_bf16_f32 v139, v146, v147
  ds_write_b128 v37, v[136:139] offset:4160
  v_pk_add_f32 v[140:141], v[72:73], v[74:75]
  v_pk_add_f32 v[140:141], v[140:141], v[76:77]
  v_pk_add_f32 v[140:141], v[140:141], v[78:79]
  v_pk_add_f32 v[140:141], v[140:141], v[80:81]
  v_pk_add_f32 v[140:141], v[140:141], v[82:83]
  v_pk_add_f32 v[140:141], v[140:141], v[84:85]
  v_pk_add_f32 v[140:141], v[140:141], v[86:87]
  v_sub_f32 v140, v140, v141
  s_nop 1
  v_add_f32_dpp v140, v140, v140 quad_perm:[1,0,3,2] row_mask:0xf bank_mask:0xf
  s_nop 1
  v_add_f32_dpp v140, v140, v140 quad_perm:[2,3,0,1] row_mask:0xf bank_mask:0xf
  s_nop 1
  v_add_f32_dpp v140, v140, v140 row_half_mirror row_mask:0xf bank_mask:0xf
  s_nop 1
  v_add_f32_dpp v140, v140, v140 row_mirror row_mask:0xf bank_mask:0xf
  s_nop 1
  v_add_f32_dpp v140, v140, v140 row_bcast:15 row_mask:0xa bank_mask:0xf
  s_nop 1
  v_add_f32_dpp v140, v140, v140 row_bcast:31 row_mask:0xc bank_mask:0xf
  s_nop 1
  s_mov_b32 exec_lo, 0
  s_mov_b32 exec_hi, 0x80000000
  v_readlane_b32 s51, v80, 63
  v_readlane_b32 s52, v140, 63
  s_mov_b64 exec, 0xffffffff
  s_mov_b32 s50, 0x1d08000
  v_mov_b32 v143, s52
  v_lshlrev_b32 v142, 2, v1
  v_writelane_b32 v143, s51, 0
  buffer_store_dword v143, v142, s[24:27], s50 offen sc1
  s_mov_b64 exec, -1
  v_mov_b32 v136, 0
  v_mov_b32 v137, 0
  v_mov_b32 v138, 0
  v_mov_b32 v139, 0
  ds_write_b128 v37, v[136:139] offset:5200
ln_join:
  v_and_b32 v40, 3, v1
  v_lshrrev_b32 v49, 4, v1
  v_bfe_u32 v50, v1, 2, 2
  s_mov_b32 s49, 131072
  s_cmp_eq_u32 s3, 1
  s_cselect_b32 s49, 139328, s49
  s_cselect_b32 s48, 0x200000, 0
  s_lshr_b32 s50, s43, 6
  s_lshl_b32 s51, s50, 19
  s_add_u32 s48, s48, s51
  s_add_u32 s53, s48, 0x40000
  s_lshl_b32 s50, s50, 18
  s_add_u32 s46, s50, 0x1200000
  s_add_u32 s47, s50, 0x1400000
  s_mov_b32 s51, 2064
  s_mov_b32 s52, 1024
  s_cmp_eq_u32 s3, 2
  s_cselect_b32 s49, 147584, s49
  s_cselect_b32 s51, 1040, s51
  s_cselect_b32 s52, 5200, s52
  s_cselect_b32 s48, s46, s48
  s_cselect_b32 s53, s47, s53
  s_and_b32 s50, s43, 63
  s_lshl_b32 s50, s50, 8
  v_and_b32 v46, 15, v1
  v_lshlrev_b32 v46, 4, v46
  v_lshl_add_u32 v46, v49, 14, v46
  v_add_u32 v46, s50, v46
  v_mul_lo_u32 v53, v40, s51
  v_lshl_add_u32 v53, v49, 6, v53
  v_lshl_add_u32 v53, v50, 3, v53
  v_add_u32 v53, s49, v53
  v_add_u32 v54, s52, v53
  v_mov_b32 v18, 0
  s_waitcnt lgkmcnt(0)
  s_barrier
  buffer_load_dword v30, v18, s[28:31], 0 offen sc1
  s_cmp_eq_u32 s3, 3
  s_cbranch_scc1 ln_lnd
  ds_read2_b64 v[56:59], v53 offset0:0 offset1:4
  ds_read2_b64 v[60:63], v53 offset0:32 offset1:36
  ds_read2_b64 v[64:67], v53 offset0:64 offset1:68
  ds_read2_b64 v[68:71], v53 offset0:96 offset1:100
  ds_read2_b64 v[72:75], v54 offset0:0 offset1:4
  ds_read2_b64 v[76:79], v54 offset0:32 offset1:36
  ds_read2_b64 v[80:83], v54 offset0:64 offset1:68
  ds_read2_b64 v[84:87], v54 offset0:96 offset1:100
  s_waitcnt lgkmcnt(7)
  buffer_store_dwordx4 v[56:59], v46, s[24:27], s48 offen sc1
  s_add_u32 s48, s48, 0x10000
  s_waitcnt lgkmcnt(6)
  buffer_store_dwordx4 v[60:63], v46, s[24:27], s48 offen sc1
  s_add_u32 s48, s48, 0x10000
  s_waitcnt lgkmcnt(5)
  buffer_store_dwordx4 v[64:67], v46, s[24:27], s48 offen sc1
  s_add_u32 s48, s48, 0x10000
  s_waitcnt lgkmcnt(4)
  buffer_store_dwordx4 v[68:71], v46, s[24:27], s48 offen sc1
  s_add_u32 s48, s48, 0x10000
  s_waitcnt lgkmcnt(3)
  buffer_store_dwordx4 v[72:75], v46, s[24:27], s53 offen sc1
  s_add_u32 s53, s53, 0x10000
  s_waitcnt lgkmcnt(2)
  buffer_store_dwordx4 v[76:79], v46, s[24:27], s53 offen sc1
  s_add_u32 s53, s53, 0x10000
  s_waitcnt lgkmcnt(1)
  buffer_store_dwordx4 v[80:83], v46, s[24:27], s53 offen sc1
  s_add_u32 s53, s53, 0x10000
  s_waitcnt lgkmcnt(0)
  buffer_store_dwordx4 v[84:87], v46, s[24:27], s53 offen sc1
  s_add_u32 s53, s53, 0x10000
  s_cmp_lg_u32 s3, 2
  s_cbranch_scc1 ln_lnd
  v_lshlrev_b32 v51, 2, v1
  v_add_u32 v52, 156944, v51
  s_lshl_b32 s52, s43, 7
  s_add_u32 s52, s52, 0x1d00000
  s_mov_b64 exec, 0xffffffff
  ds_read_b32 v90, v52
  s_waitcnt lgkmcnt(0)
  buffer_store_dword v90, v51, s[24:27], s52 offen sc1
  s_mov_b64 exec, -1
  s_cmp_lg_u32 s43, 0
  s_cbranch_scc1 ln_lnd
  v_lshrrev_b32 v49, 2, v1
  v_and_b32 v50, 3, v1
  v_lshlrev_b32 v51, 4, v1
  v_lshlrev_b32 v52, 6, v49
  v_lshl_add_u32 v52, v50, 3, v52
  v_add_u32 v52, 151744, v52
  ds_read2_b64 v[92:95], v52 offset0:0 offset1:4
  s_mov_b32 s52, 0x1300000
  s_waitcnt lgkmcnt(0)
  buffer_store_dwordx4 v[92:95], v51, s[24:27], s52 offen sc1
ln_lnd:
  s_cmp_lt_u32 s42, 4
  s_cbranch_scc1 L_fft
  s_mul_i32 s35, s3, 4096
  s_add_u32 s35, s35, 16384
  s_mov_b32 s33, 0
  v_lshrrev_b32 v19, 4, v1
  v_and_b32 v20, 15, v1
  s_mov_b32 s40, 7168
  s_mul_i32 s39, s3, 57344
  v_add_u32 v21, 0, v19
  v_mul_lo_u32 v18, v21, s40
  v_add_u32 v18, s39, v18
  v_lshlrev_b32 v21, 1, v21
  v_xor_b32 v21, v21, v20
  v_lshl_add_u32 v18, v21, 4, v18
  v_add_u32 v13, 4096, v18
  v_add_u32 v15, 2048, v18
  v_add_u32 v21, 4, v19
  v_mul_lo_u32 v18, v21, s40
  v_add_u32 v18, s39, v18
  v_lshlrev_b32 v21, 1, v21
  v_xor_b32 v21, v21, v20
  v_lshl_add_u32 v18, v21, 4, v18
  v_add_u32 v14, 3072, v18
  v_add_u32 v16, 1024, v18
  s_lshl_b32 s46, s55, 8
  s_sub_u32 s47, 7344128, s46
  s_add_u32 s12, s76, s46
  s_addc_u32 s13, s77, 0
  s_sub_u32 s12, s12, 0x1000
  s_subb_u32 s13, s13, 0
  s_mov_b32 s14, s47
  s_mov_b32 s15, 0x20000
  s_add_u32 s16, s78, s46
  s_addc_u32 s17, s79, 0
  s_sub_u32 s16, s16, 0x1000
  s_subb_u32 s17, s17, 0
  s_mov_b32 s18, s47
  s_mov_b32 s19, 0x20000
  v_lshlrev_b32 v18, 4, v1
  s_mul_i32 s39, s37, 8192
  v_add_u32 v2, s39, v18
  v_add_u32 v3, 65536, v2
  s_mul_i32 s34, s3, 4096
  s_mov_b32 s32, 0
  v_bfe_u32 v19, v1, 2, 2
  v_lshlrev_b32 v19, 8, v19
  v_lshrrev_b32 v20, 4, v1
  v_lshl_add_u32 v19, v20, 6, v19
  v_and_b32 v20, 3, v1
  v_lshl_add_u32 v19, v20, 4, v19
  v_add_u32 v12, s34, v19
  v_bfe_u32 v19, v1, 2, 3
  v_lshrrev_b32 v20, 5, v1
  v_mul_u32_u24 v20, 4096, v20
  v_lshl_add_u32 v20, v19, 8, v20
  v_and_b32 v21, 3, v1
  v_lshl_add_u32 v20, v21, 3, v20
  v_add_u32 v20, 16384, v20
  s_lshl_b32 s39, s38, 2
  s_add_u32 s40, s39, 0
  v_xor_b32 v21, s40, v19
  v_lshl_add_u32 v4, v21, 5, v20
  v_add_u32 v8, 65536, v4
  s_add_u32 s40, s39, 1
  v_xor_b32 v21, s40, v19
  v_lshl_add_u32 v5, v21, 5, v20
  v_add_u32 v9, 65536, v5
  s_add_u32 s40, s39, 2
  v_xor_b32 v21, s40, v19
  v_lshl_add_u32 v6, v21, 5, v20
  v_add_u32 v10, 65536, v6
  s_add_u32 s40, s39, 3
  v_xor_b32 v21, s40, v19
  v_lshl_add_u32 v7, v21, 5, v20
  v_add_u32 v11, 65536, v7
  s_and_b32 s46, s54, 3
  s_lshl_b32 s46, s46, 13
  v_lshl_add_u32 v22, v1, 7, s46
  s_lshl_b32 s46, s54, 19
  s_add_u32 s8, s86, s46
  s_addc_u32 s9, s87, 0
  s_mov_b32 s10, 0x80000
  s_mov_b32 s11, 0x20000
  s_add_u32 s46, s55, 2
  s_lshr_b32 s46, s46, 2
  s_sub_u32 s46, s55, s46
  s_mul_i32 s47, s54, 21
  s_add_u32 s46, s46, s47
  s_and_b32 s47, s55, 3
  s_cmp_eq_u32 s47, 1
  s_cselect_b32 s63, 0, 7340032
  s_cselect_b32 s98, 0, 4194304
  s_bitcmp1_b32 s46, 0
  s_cselect_b32 s96, s68, s66
  s_cselect_b32 s97, s69, s67
  v_lshrrev_b32 v18, 3, v1
  v_min_u32 v18, 1, v18
  v_lshlrev_b32 v18, 31, v18
  s_lshl_b32 s47, s3, 3
  v_add_u32 v19, s47, v1
  s_lshl_b32 s47, s46, 5
  v_add_u32 v20, s47, v19
  v_lshl_or_b32 v23, v20, 7, v18
  s_lshr_b32 s46, s46, 1
  s_lshl_b32 s46, s46, 5
  v_add_u32 v19, s46, v19
  v_and_b32 v21, 15, v19
  v_lshrrev_b32 v20, 4, v19
  v_lshlrev_b32 v20, 12, v20
  v_lshl_add_u32 v20, v21, 7, v20
  v_or_b32 v26, v20, v18
  s_waitcnt vmcnt(0)
  s_mov_b32 s5, 0x80000
  v_mov_b32 v18, 0
tg_3:
  v_readfirstlane_b32 s100, v30
  s_sub_u32 s5, s5, 1
  s_cbranch_scc1 tgd_4
  s_cmp_lg_u32 s100, 0
  s_cbranch_scc1 tgd_4
  s_sleep 1
  buffer_load_dword v30, v18, s[28:31], 0 offen sc1
  s_waitcnt vmcnt(0)
  s_branch tg_3
tgd_4:
  s_add_u32 s28, s86, 0x1e00000
  s_addc_u32 s29, s87, 0
  s_mov_b32 s30, 0x8000
  s_mov_b32 s31, 0x20000
  s_barrier
  s_cmp_lg_u32 s3, 0
  s_cbranch_scc1 pub_2
  s_lshl_b32 s4, s43, 7
  s_add_u32 s5, s100, 1
  v_lshl_add_u32 v18, v1, 2, s4
  v_mov_b32 v19, s5
  s_mov_b64 exec, 0xffffffff
  buffer_store_dword v19, v18, s[28:31], 0 offen sc1
  s_mov_b64 exec, -1
pub_2:
  s_add_u32 m0, s35, 0
  s_nop 0
  buffer_load_dwordx4 v13, s[12:15], s33 offen offset:0 nt lds
  buffer_load_dwordx4 v14, s[12:15], s33 offen offset:1024 nt lds
  buffer_load_dwordx4 v15, s[16:19], s33 offen offset:2048 nt lds
  buffer_load_dwordx4 v16, s[16:19], s33 offen offset:3072 nt lds
  s_add_u32 s33, s33, 229376
  s_add_u32 m0, s35, 32768
  s_nop 0
  buffer_load_dwordx4 v13, s[12:15], s33 offen offset:0 nt lds
  buffer_load_dwordx4 v14, s[12:15], s33 offen offset:1024 nt lds
  buffer_load_dwordx4 v15, s[16:19], s33 offen offset:2048 nt lds
  buffer_load_dwordx4 v16, s[16:19], s33 offen offset:3072 nt lds
  s_add_u32 s33, s33, 229376
  s_add_u32 m0, s35, 65536
  s_nop 0
  buffer_load_dwordx4 v13, s[12:15], s33 offen offset:0 nt lds
  buffer_load_dwordx4 v14, s[12:15], s33 offen offset:1024 nt lds
  buffer_load_dwordx4 v15, s[16:19], s33 offen offset:2048 nt lds
  buffer_load_dwordx4 v16, s[16:19], s33 offen offset:3072 nt lds
  s_add_u32 s33, s33, 229376
  s_add_u32 m0, s35, 98304
  s_nop 0
  buffer_load_dwordx4 v13, s[12:15], s33 offen offset:0 nt lds
  buffer_load_dwordx4 v14, s[12:15], s33 offen offset:1024 nt lds
  buffer_load_dwordx4 v15, s[16:19], s33 offen offset:2048 nt lds
  buffer_load_dwordx4 v16, s[16:19], s33 offen offset:3072 nt lds
  s_add_u32 s33, s33, 229376
  s_mov_b32 s24, s96
  s_mov_b32 s25, s97
  s_mov_b32 s26, s98
  s_mov_b32 s27, 0x20000
  s_mov_b32 s62, 688128
  s_cmp_lg_u32 s3, 0
  s_cbranch_scc1 polld_6
  s_mov_b32 s5, 0x80000
poll_5:
  buffer_load_dwordx2 v[40:41], v22, s[28:31], 0 offen sc1
  s_waitcnt vmcnt(0)
  v_subrev_u32 v40, s100, v40
  v_subrev_u32 v40, 1, v40
  v_subrev_u32 v41, s100, v41
  v_subrev_u32 v41, 1, v41
  v_max_u32 v40, v40, v41
  v_cmp_lt_u32 vcc, 7, v40
  s_sub_u32 s5, s5, 1
  s_cbranch_scc1 polld_6
  s_cbranch_vccz polld_6
  s_sleep 1
  s_branch poll_5
polld_6:
  s_barrier
  s_add_u32 m0, s34, 0
  s_nop 0
  buffer_load_dwordx4 v12, s[8:11], s32 offen offset:0 lds
  buffer_load_dwordx4 v12, s[8:11], s32 offen offset:1024 lds
  buffer_load_dwordx4 v12, s[8:11], s32 offen offset:2048 lds
  buffer_load_dwordx4 v12, s[8:11], s32 offen offset:3072 lds
  s_add_u32 s32, s32, 16384
  s_add_u32 m0, s34, 32768
  s_nop 0
  buffer_load_dwordx4 v12, s[8:11], s32 offen offset:0 lds
  buffer_load_dwordx4 v12, s[8:11], s32 offen offset:1024 lds
  buffer_load_dwordx4 v12, s[8:11], s32 offen offset:2048 lds
  buffer_load_dwordx4 v12, s[8:11], s32 offen offset:3072 lds
  s_add_u32 s32, s32, 16384
  s_add_u32 m0, s34, 65536
  s_nop 0
  buffer_load_dwordx4 v12, s[8:11], s32 offen offset:0 lds
  buffer_load_dwordx4 v12, s[8:11], s32 offen offset:1024 lds
  buffer_load_dwordx4 v12, s[8:11], s32 offen offset:2048 lds
  buffer_load_dwordx4 v12, s[8:11], s32 offen offset:3072 lds
  s_add_u32 s32, s32, 16384
  s_add_u32 m0, s34, 98304
  s_nop 0
  buffer_load_dwordx4 v12, s[8:11], s32 offen offset:0 lds
  buffer_load_dwordx4 v12, s[8:11], s32 offen offset:1024 lds
  buffer_load_dwordx4 v12, s[8:11], s32 offen offset:2048 lds
  buffer_load_dwordx4 v12, s[8:11], s32 offen offset:3072 lds
  s_add_u32 s32, s32, 16384
  s_waitcnt vmcnt(12) lgkmcnt(0)
  s_barrier
  ds_read_b128 a[0:3], v2 offset:0
  ds_read_b64_tr_b16 a[32:33], v4 offset:0
  ds_read_b64_tr_b16 a[34:35], v4 offset:8192
  ds_read_b128 a[4:7], v2 offset:1024
  ds_read_b64_tr_b16 a[36:37], v5 offset:0
  ds_read_b64_tr_b16 a[38:39], v5 offset:8192
  ds_read_b128 a[8:11], v2 offset:2048
  ds_read_b64_tr_b16 a[40:41], v6 offset:0
  ds_read_b64_tr_b16 a[42:43], v6 offset:8192
  ds_read_b128 a[12:15], v2 offset:3072
  ds_read_b64_tr_b16 a[44:45], v7 offset:0
  ds_read_b64_tr_b16 a[46:47], v7 offset:8192
  ds_read_b128 a[16:19], v2 offset:4096
  ds_read_b64_tr_b16 a[48:49], v4 offset:2048
  ds_read_b64_tr_b16 a[50:51], v4 offset:10240
  ds_read_b128 a[20:23], v2 offset:5120
  ds_read_b64_tr_b16 a[52:53], v5 offset:2048
  ds_read_b64_tr_b16 a[54:55], v5 offset:10240
  ds_read_b128 a[24:27], v2 offset:6144
  ds_read_b64_tr_b16 a[56:57], v6 offset:2048
  ds_read_b64_tr_b16 a[58:59], v6 offset:10240
  ds_read_b128 a[28:31], v2 offset:7168
  ds_read_b64_tr_b16 a[60:61], v7 offset:2048
  ds_read_b64_tr_b16 a[62:63], v7 offset:10240
  s_waitcnt vmcnt(8) lgkmcnt(0)
  s_barrier
  v_mfma_f32_16x16x32_bf16 v[32:35], a[32:35], a[0:3], 0
  buffer_load_dword v29, v26, s[24:27], 0 offen
  v_add_u32 v26, s62, v26
  v_mfma_f32_16x16x32_bf16 v[36:39], a[32:35], a[4:7], 0
  ds_read_b128 a[64:67], v2 offset:32768
  v_mfma_f32_16x16x32_bf16 v[40:43], a[32:35], a[8:11], 0
  v_mfma_f32_16x16x32_bf16 v[44:47], a[32:35], a[12:15], 0
  ds_read_b64_tr_b16 a[96:97], v4 offset:32768
  v_mfma_f32_16x16x32_bf16 v[48:51], a[32:35], a[16:19], 0
  ds_read_b64_tr_b16 a[98:99], v4 offset:40960
  v_mfma_f32_16x16x32_bf16 v[52:55], a[32:35], a[20:23], 0
  v_mfma_f32_16x16x32_bf16 v[56:59], a[32:35], a[24:27], 0
  s_add_u32 m0, s34, 0
  v_mfma_f32_16x16x32_bf16 v[60:63], a[32:35], a[28:31], 0
  buffer_load_dwordx4 v12, s[8:11], s32 offen offset:0 lds
  v_mfma_f32_16x16x32_bf16 v[92:95], a[36:39], a[28:31], 0
  v_mfma_f32_16x16x32_bf16 v[88:91], a[36:39], a[24:27], 0
  ds_read_b128 a[68:71], v2 offset:33792
  v_mfma_f32_16x16x32_bf16 v[84:87], a[36:39], a[20:23], 0
  ds_read_b64_tr_b16 a[100:101], v5 offset:32768
  v_mfma_f32_16x16x32_bf16 v[80:83], a[36:39], a[16:19], 0
  v_mfma_f32_16x16x32_bf16 v[76:79], a[36:39], a[12:15], 0
  ds_read_b64_tr_b16 a[102:103], v5 offset:40960
  v_mfma_f32_16x16x32_bf16 v[72:75], a[36:39], a[8:11], 0
  buffer_load_dwordx4 v12, s[8:11], s32 offen offset:1024 lds
  v_mfma_f32_16x16x32_bf16 v[68:71], a[36:39], a[4:7], 0
  v_mfma_f32_16x16x32_bf16 v[64:67], a[36:39], a[0:3], 0
  ds_read_b128 a[72:75], v2 offset:34816
  v_mfma_f32_16x16x32_bf16 v[96:99], a[40:43], a[0:3], 0
  ds_read_b64_tr_b16 a[104:105], v6 offset:32768
  v_mfma_f32_16x16x32_bf16 v[100:103], a[40:43], a[4:7], 0
  v_mfma_f32_16x16x32_bf16 v[104:107], a[40:43], a[8:11], 0
  buffer_load_dwordx4 v12, s[8:11], s32 offen offset:2048 lds
  v_mfma_f32_16x16x32_bf16 v[108:111], a[40:43], a[12:15], 0
  v_mfma_f32_16x16x32_bf16 v[112:115], a[40:43], a[16:19], 0
  ds_read_b64_tr_b16 a[106:107], v6 offset:40960
  v_mfma_f32_16x16x32_bf16 v[116:119], a[40:43], a[20:23], 0
  ds_read_b128 a[76:79], v2 offset:35840
  v_mfma_f32_16x16x32_bf16 v[120:123], a[40:43], a[24:27], 0
  v_mfma_f32_16x16x32_bf16 v[124:127], a[40:43], a[28:31], 0
  ds_read_b64_tr_b16 a[108:109], v7 offset:32768
  v_mfma_f32_16x16x32_bf16 v[156:159], a[44:47], a[28:31], 0
  buffer_load_dwordx4 v12, s[8:11], s32 offen offset:3072 lds
  s_add_u32 s32, s32, 16384
  v_mfma_f32_16x16x32_bf16 v[152:155], a[44:47], a[24:27], 0
  v_mfma_f32_16x16x32_bf16 v[148:151], a[44:47], a[20:23], 0
  ds_read_b64_tr_b16 a[110:111], v7 offset:40960
  v_mfma_f32_16x16x32_bf16 v[144:147], a[44:47], a[16:19], 0
  ds_read_b128 a[80:83], v2 offset:36864
  v_mfma_f32_16x16x32_bf16 v[140:143], a[44:47], a[12:15], 0
  v_mfma_f32_16x16x32_bf16 v[136:139], a[44:47], a[8:11], 0
  ds_read_b64_tr_b16 a[112:113], v4 offset:34816
  v_mfma_f32_16x16x32_bf16 v[132:135], a[44:47], a[4:7], 0
  s_add_u32 m0, s35, 0
  v_mfma_f32_16x16x32_bf16 v[128:131], a[44:47], a[0:3], 0
  v_mfma_f32_16x16x32_bf16 v[160:163], a[48:51], a[0:3], 0
  buffer_load_dwordx4 v13, s[12:15], s33 offen offset:0 nt lds
  v_mfma_f32_16x16x32_bf16 v[164:167], a[48:51], a[4:7], 0
  ds_read_b64_tr_b16 a[114:115], v4 offset:43008
  v_mfma_f32_16x16x32_bf16 v[168:171], a[48:51], a[8:11], 0
  v_mfma_f32_16x16x32_bf16 v[172:175], a[48:51], a[12:15], 0
  ds_read_b128 a[84:87], v2 offset:37888
  v_mfma_f32_16x16x32_bf16 v[176:179], a[48:51], a[16:19], 0
  v_mfma_f32_16x16x32_bf16 v[180:183], a[48:51], a[20:23], 0
  buffer_load_dwordx4 v14, s[12:15], s33 offen offset:1024 nt lds
  v_mfma_f32_16x16x32_bf16 v[184:187], a[48:51], a[24:27], 0
  ds_read_b64_tr_b16 a[116:117], v5 offset:34816
  v_mfma_f32_16x16x32_bf16 v[188:191], a[48:51], a[28:31], 0
  v_mfma_f32_16x16x32_bf16 v[220:223], a[52:55], a[28:31], 0
  ds_read_b64_tr_b16 a[118:119], v5 offset:43008
  v_mfma_f32_16x16x32_bf16 v[216:219], a[52:55], a[24:27], 0
  ds_read_b128 a[88:91], v2 offset:38912
  v_mfma_f32_16x16x32_bf16 v[212:215], a[52:55], a[20:23], 0
  v_mfma_f32_16x16x32_bf16 v[208:211], a[52:55], a[16:19], 0
  buffer_load_dwordx4 v15, s[16:19], s33 offen offset:2048 nt lds
  v_mfma_f32_16x16x32_bf16 v[204:207], a[52:55], a[12:15], 0
  ds_read_b64_tr_b16 a[120:121], v6 offset:34816
  v_mfma_f32_16x16x32_bf16 v[200:203], a[52:55], a[8:11], 0
  v_mfma_f32_16x16x32_bf16 v[196:199], a[52:55], a[4:7], 0
  ds_read_b64_tr_b16 a[122:123], v6 offset:43008
  v_mfma_f32_16x16x32_bf16 v[192:195], a[52:55], a[0:3], 0
  ds_read_b128 a[92:95], v2 offset:39936
  v_mfma_f32_16x16x32_bf16 v[224:227], a[56:59], a[0:3], 0
  v_mfma_f32_16x16x32_bf16 v[228:231], a[56:59], a[4:7], 0
  buffer_load_dwordx4 v16, s[16:19], s33 offen offset:3072 nt lds
  s_add_u32 s33, s33, 229376
  v_mfma_f32_16x16x32_bf16 v[232:235], a[56:59], a[8:11], 0
  ds_read_b64_tr_b16 a[124:125], v7 offset:34816
  v_mfma_f32_16x16x32_bf16 v[236:239], a[56:59], a[12:15], 0
  v_mfma_f32_16x16x32_bf16 v[240:243], a[56:59], a[16:19], 0
  ds_read_b64_tr_b16 a[126:127], v7 offset:43008
  v_mfma_f32_16x16x32_bf16 v[244:247], a[56:59], a[20:23], 0
  v_mfma_f32_16x16x32_bf16 v[248:251], a[56:59], a[24:27], 0
  v_mfma_f32_16x16x32_bf16 v[252:255], a[56:59], a[28:31], 0
  v_mfma_f32_16x16x32_bf16 a[156:159], a[60:63], a[28:31], 0
  v_mfma_f32_16x16x32_bf16 a[152:155], a[60:63], a[24:27], 0
  v_mfma_f32_16x16x32_bf16 a[148:151], a[60:63], a[20:23], 0
  v_mfma_f32_16x16x32_bf16 a[144:147], a[60:63], a[16:19], 0
  v_mfma_f32_16x16x32_bf16 a[140:143], a[60:63], a[12:15], 0
  v_mfma_f32_16x16x32_bf16 a[136:139], a[60:63], a[8:11], 0
  v_mfma_f32_16x16x32_bf16 a[132:135], a[60:63], a[4:7], 0
  v_mfma_f32_16x16x32_bf16 a[128:131], a[60:63], a[0:3], 0
  s_waitcnt vmcnt(12) lgkmcnt(0)
  s_barrier
  v_mfma_f32_16x16x32_bf16 v[32:35], a[96:99], a[64:67], v[32:35]
  buffer_load_dword v29, v26, s[24:27], 0 offen
  v_add_u32 v26, s62, v26
  v_mfma_f32_16x16x32_bf16 v[36:39], a[96:99], a[68:71], v[36:39]
  ds_read_b128 a[0:3], v3 offset:0
  v_mfma_f32_16x16x32_bf16 v[40:43], a[96:99], a[72:75], v[40:43]
  v_mfma_f32_16x16x32_bf16 v[44:47], a[96:99], a[76:79], v[44:47]
  ds_read_b64_tr_b16 a[32:33], v8 offset:0
  v_mfma_f32_16x16x32_bf16 v[48:51], a[96:99], a[80:83], v[48:51]
  ds_read_b64_tr_b16 a[34:35], v8 offset:8192
  v_mfma_f32_16x16x32_bf16 v[52:55], a[96:99], a[84:87], v[52:55]
  v_mfma_f32_16x16x32_bf16 v[56:59], a[96:99], a[88:91], v[56:59]
  s_add_u32 m0, s34, 32768
  v_mfma_f32_16x16x32_bf16 v[60:63], a[96:99], a[92:95], v[60:63]
  buffer_load_dwordx4 v12, s[8:11], s32 offen offset:0 lds
  v_mfma_f32_16x16x32_bf16 v[92:95], a[100:103], a[92:95], v[92:95]
  v_mfma_f32_16x16x32_bf16 v[88:91], a[100:103], a[88:91], v[88:91]
  ds_read_b128 a[4:7], v3 offset:1024
  v_mfma_f32_16x16x32_bf16 v[84:87], a[100:103], a[84:87], v[84:87]
  ds_read_b64_tr_b16 a[36:37], v9 offset:0
  v_mfma_f32_16x16x32_bf16 v[80:83], a[100:103], a[80:83], v[80:83]
  v_mfma_f32_16x16x32_bf16 v[76:79], a[100:103], a[76:79], v[76:79]
  ds_read_b64_tr_b16 a[38:39], v9 offset:8192
  v_mfma_f32_16x16x32_bf16 v[72:75], a[100:103], a[72:75], v[72:75]
  buffer_load_dwordx4 v12, s[8:11], s32 offen offset:1024 lds
  v_mfma_f32_16x16x32_bf16 v[68:71], a[100:103], a[68:71], v[68:71]
  v_mfma_f32_16x16x32_bf16 v[64:67], a[100:103], a[64:67], v[64:67]
  ds_read_b128 a[8:11], v3 offset:2048
  v_mfma_f32_16x16x32_bf16 v[96:99], a[104:107], a[64:67], v[96:99]
  ds_read_b64_tr_b16 a[40:41], v10 offset:0
  v_mfma_f32_16x16x32_bf16 v[100:103], a[104:107], a[68:71], v[100:103]
  v_mfma_f32_16x16x32_bf16 v[104:107], a[104:107], a[72:75], v[104:107]
  buffer_load_dwordx4 v12, s[8:11], s32 offen offset:2048 lds
  v_mfma_f32_16x16x32_bf16 v[108:111], a[104:107], a[76:79], v[108:111]
  v_mfma_f32_16x16x32_bf16 v[112:115], a[104:107], a[80:83], v[112:115]
  ds_read_b64_tr_b16 a[42:43], v10 offset:8192
  v_mfma_f32_16x16x32_bf16 v[116:119], a[104:107], a[84:87], v[116:119]
  ds_read_b128 a[12:15], v3 offset:3072
  v_mfma_f32_16x16x32_bf16 v[120:123], a[104:107], a[88:91], v[120:123]
  v_mfma_f32_16x16x32_bf16 v[124:127], a[104:107], a[92:95], v[124:127]
  ds_read_b64_tr_b16 a[44:45], v11 offset:0
  v_mfma_f32_16x16x32_bf16 v[156:159], a[108:111], a[92:95], v[156:159]
  buffer_load_dwordx4 v12, s[8:11], s32 offen offset:3072 lds
  s_add_u32 s32, s32, 16384
  v_mfma_f32_16x16x32_bf16 v[152:155], a[108:111], a[88:91], v[152:155]
  v_mfma_f32_16x16x32_bf16 v[148:151], a[108:111], a[84:87], v[148:151]
  ds_read_b64_tr_b16 a[46:47], v11 offset:8192
  v_mfma_f32_16x16x32_bf16 v[144:147], a[108:111], a[80:83], v[144:147]
  ds_read_b128 a[16:19], v3 offset:4096
  v_mfma_f32_16x16x32_bf16 v[140:143], a[108:111], a[76:79], v[140:143]
  v_mfma_f32_16x16x32_bf16 v[136:139], a[108:111], a[72:75], v[136:139]
  ds_read_b64_tr_b16 a[48:49], v8 offset:2048
  v_mfma_f32_16x16x32_bf16 v[132:135], a[108:111], a[68:71], v[132:135]
  s_add_u32 m0, s35, 32768
  v_mfma_f32_16x16x32_bf16 v[128:131], a[108:111], a[64:67], v[128:131]
  v_mfma_f32_16x16x32_bf16 v[160:163], a[112:115], a[64:67], v[160:163]
  buffer_load_dwordx4 v13, s[12:15], s33 offen offset:0 nt lds
  v_mfma_f32_16x16x32_bf16 v[164:167], a[112:115], a[68:71], v[164:167]
  ds_read_b64_tr_b16 a[50:51], v8 offset:10240
  v_mfma_f32_16x16x32_bf16 v[168:171], a[112:115], a[72:75], v[168:171]
  v_mfma_f32_16x16x32_bf16 v[172:175], a[112:115], a[76:79], v[172:175]
  ds_read_b128 a[20:23], v3 offset:5120
  v_mfma_f32_16x16x32_bf16 v[176:179], a[112:115], a[80:83], v[176:179]
  v_mfma_f32_16x16x32_bf16 v[180:183], a[112:115], a[84:87], v[180:183]
  buffer_load_dwordx4 v14, s[12:15], s33 offen offset:1024 nt lds
  v_mfma_f32_16x16x32_bf16 v[184:187], a[112:115], a[88:91], v[184:187]
  ds_read_b64_tr_b16 a[52:53], v9 offset:2048
  v_mfma_f32_16x16x32_bf16 v[188:191], a[112:115], a[92:95], v[188:191]
  v_mfma_f32_16x16x32_bf16 v[220:223], a[116:119], a[92:95], v[220:223]
  ds_read_b64_tr_b16 a[54:55], v9 offset:10240
  v_mfma_f32_16x16x32_bf16 v[216:219], a[116:119], a[88:91], v[216:219]
  ds_read_b128 a[24:27], v3 offset:6144
  v_mfma_f32_16x16x32_bf16 v[212:215], a[116:119], a[84:87], v[212:215]
  v_mfma_f32_16x16x32_bf16 v[208:211], a[116:119], a[80:83], v[208:211]
  buffer_load_dwordx4 v15, s[16:19], s33 offen offset:2048 nt lds
  v_mfma_f32_16x16x32_bf16 v[204:207], a[116:119], a[76:79], v[204:207]
  ds_read_b64_tr_b16 a[56:57], v10 offset:2048
  v_mfma_f32_16x16x32_bf16 v[200:203], a[116:119], a[72:75], v[200:203]
  v_mfma_f32_16x16x32_bf16 v[196:199], a[116:119], a[68:71], v[196:199]
  ds_read_b64_tr_b16 a[58:59], v10 offset:10240
  v_mfma_f32_16x16x32_bf16 v[192:195], a[116:119], a[64:67], v[192:195]
  ds_read_b128 a[28:31], v3 offset:7168
  v_mfma_f32_16x16x32_bf16 v[224:227], a[120:123], a[64:67], v[224:227]
  v_mfma_f32_16x16x32_bf16 v[228:231], a[120:123], a[68:71], v[228:231]
  buffer_load_dwordx4 v16, s[16:19], s33 offen offset:3072 nt lds
  s_add_u32 s33, s33, 229376
  v_mfma_f32_16x16x32_bf16 v[232:235], a[120:123], a[72:75], v[232:235]
  ds_read_b64_tr_b16 a[60:61], v11 offset:2048
  v_mfma_f32_16x16x32_bf16 v[236:239], a[120:123], a[76:79], v[236:239]
  v_mfma_f32_16x16x32_bf16 v[240:243], a[120:123], a[80:83], v[240:243]
  ds_read_b64_tr_b16 a[62:63], v11 offset:10240
  v_mfma_f32_16x16x32_bf16 v[244:247], a[120:123], a[84:87], v[244:247]
  v_mfma_f32_16x16x32_bf16 v[248:251], a[120:123], a[88:91], v[248:251]
  v_mfma_f32_16x16x32_bf16 v[252:255], a[120:123], a[92:95], v[252:255]
  v_mfma_f32_16x16x32_bf16 a[156:159], a[124:127], a[92:95], a[156:159]
  v_mfma_f32_16x16x32_bf16 a[152:155], a[124:127], a[88:91], a[152:155]
  v_mfma_f32_16x16x32_bf16 a[148:151], a[124:127], a[84:87], a[148:151]
  v_mfma_f32_16x16x32_bf16 a[144:147], a[124:127], a[80:83], a[144:147]
  v_mfma_f32_16x16x32_bf16 a[140:143], a[124:127], a[76:79], a[140:143]
  v_mfma_f32_16x16x32_bf16 a[136:139], a[124:127], a[72:75], a[136:139]
  v_mfma_f32_16x16x32_bf16 a[132:135], a[124:127], a[68:71], a[132:135]
  v_mfma_f32_16x16x32_bf16 a[128:131], a[124:127], a[64:67], a[128:131]
  s_waitcnt vmcnt(16) lgkmcnt(0)
  s_barrier
  v_mfma_f32_16x16x32_bf16 v[32:35], a[32:35], a[0:3], v[32:35]
  buffer_load_dword v29, v26, s[24:27], 0 offen
  v_add_u32 v26, s62, v26
  v_mfma_f32_16x16x32_bf16 v[36:39], a[32:35], a[4:7], v[36:39]
  ds_read_b128 a[64:67], v3 offset:32768
  v_mfma_f32_16x16x32_bf16 v[40:43], a[32:35], a[8:11], v[40:43]
  v_mfma_f32_16x16x32_bf16 v[44:47], a[32:35], a[12:15], v[44:47]
  ds_read_b64_tr_b16 a[96:97], v8 offset:32768
  v_mfma_f32_16x16x32_bf16 v[48:51], a[32:35], a[16:19], v[48:51]
  ds_read_b64_tr_b16 a[98:99], v8 offset:40960
  v_mfma_f32_16x16x32_bf16 v[52:55], a[32:35], a[20:23], v[52:55]
  v_mfma_f32_16x16x32_bf16 v[56:59], a[32:35], a[24:27], v[56:59]
  s_add_u32 m0, s34, 65536
  v_mfma_f32_16x16x32_bf16 v[60:63], a[32:35], a[28:31], v[60:63]
  buffer_load_dwordx4 v12, s[8:11], s32 offen offset:0 lds
  v_mfma_f32_16x16x32_bf16 v[92:95], a[36:39], a[28:31], v[92:95]
  v_mfma_f32_16x16x32_bf16 v[88:91], a[36:39], a[24:27], v[88:91]
  ds_read_b128 a[68:71], v3 offset:33792
  v_mfma_f32_16x16x32_bf16 v[84:87], a[36:39], a[20:23], v[84:87]
  ds_read_b64_tr_b16 a[100:101], v9 offset:32768
  v_mfma_f32_16x16x32_bf16 v[80:83], a[36:39], a[16:19], v[80:83]
  v_mfma_f32_16x16x32_bf16 v[76:79], a[36:39], a[12:15], v[76:79]
  ds_read_b64_tr_b16 a[102:103], v9 offset:40960
  v_mfma_f32_16x16x32_bf16 v[72:75], a[36:39], a[8:11], v[72:75]
  buffer_load_dwordx4 v12, s[8:11], s32 offen offset:1024 lds
  v_mfma_f32_16x16x32_bf16 v[68:71], a[36:39], a[4:7], v[68:71]
  v_mfma_f32_16x16x32_bf16 v[64:67], a[36:39], a[0:3], v[64:67]
  ds_read_b128 a[72:75], v3 offset:34816
  v_mfma_f32_16x16x32_bf16 v[96:99], a[40:43], a[0:3], v[96:99]
  ds_read_b64_tr_b16 a[104:105], v10 offset:32768
  v_mfma_f32_16x16x32_bf16 v[100:103], a[40:43], a[4:7], v[100:103]
  v_mfma_f32_16x16x32_bf16 v[104:107], a[40:43], a[8:11], v[104:107]
  buffer_load_dwordx4 v12, s[8:11], s32 offen offset:2048 lds
  v_mfma_f32_16x16x32_bf16 v[108:111], a[40:43], a[12:15], v[108:111]
  v_mfma_f32_16x16x32_bf16 v[112:115], a[40:43], a[16:19], v[112:115]
  ds_read_b64_tr_b16 a[106:107], v10 offset:40960
  v_mfma_f32_16x16x32_bf16 v[116:119], a[40:43], a[20:23], v[116:119]
  ds_read_b128 a[76:79], v3 offset:35840
  v_mfma_f32_16x16x32_bf16 v[120:123], a[40:43], a[24:27], v[120:123]
  v_mfma_f32_16x16x32_bf16 v[124:127], a[40:43], a[28:31], v[124:127]
  ds_read_b64_tr_b16 a[108:109], v11 offset:32768
  v_mfma_f32_16x16x32_bf16 v[156:159], a[44:47], a[28:31], v[156:159]
  buffer_load_dwordx4 v12, s[8:11], s32 offen offset:3072 lds
  s_add_u32 s32, s32, 16384
  v_mfma_f32_16x16x32_bf16 v[152:155], a[44:47], a[24:27], v[152:155]
  v_mfma_f32_16x16x32_bf16 v[148:151], a[44:47], a[20:23], v[148:151]
  ds_read_b64_tr_b16 a[110:111], v11 offset:40960
  v_mfma_f32_16x16x32_bf16 v[144:147], a[44:47], a[16:19], v[144:147]
  ds_read_b128 a[80:83], v3 offset:36864
  v_mfma_f32_16x16x32_bf16 v[140:143], a[44:47], a[12:15], v[140:143]
  v_mfma_f32_16x16x32_bf16 v[136:139], a[44:47], a[8:11], v[136:139]
  ds_read_b64_tr_b16 a[112:113], v8 offset:34816
  v_mfma_f32_16x16x32_bf16 v[132:135], a[44:47], a[4:7], v[132:135]
  s_add_u32 m0, s35, 65536
  v_mfma_f32_16x16x32_bf16 v[128:131], a[44:47], a[0:3], v[128:131]
  v_mfma_f32_16x16x32_bf16 v[160:163], a[48:51], a[0:3], v[160:163]
  buffer_load_dwordx4 v13, s[12:15], s33 offen offset:0 nt lds
  v_mfma_f32_16x16x32_bf16 v[164:167], a[48:51], a[4:7], v[164:167]
  ds_read_b64_tr_b16 a[114:115], v8 offset:43008
  v_mfma_f32_16x16x32_bf16 v[168:171], a[48:51], a[8:11], v[168:171]
  v_mfma_f32_16x16x32_bf16 v[172:175], a[48:51], a[12:15], v[172:175]
  ds_read_b128 a[84:87], v3 offset:37888
  v_mfma_f32_16x16x32_bf16 v[176:179], a[48:51], a[16:19], v[176:179]
  v_mfma_f32_16x16x32_bf16 v[180:183], a[48:51], a[20:23], v[180:183]
  buffer_load_dwordx4 v14, s[12:15], s33 offen offset:1024 nt lds
  v_mfma_f32_16x16x32_bf16 v[184:187], a[48:51], a[24:27], v[184:187]
  ds_read_b64_tr_b16 a[116:117], v9 offset:34816
  v_mfma_f32_16x16x32_bf16 v[188:191], a[48:51], a[28:31], v[188:191]
  v_mfma_f32_16x16x32_bf16 v[220:223], a[52:55], a[28:31], v[220:223]
  ds_read_b64_tr_b16 a[118:119], v9 offset:43008
  v_mfma_f32_16x16x32_bf16 v[216:219], a[52:55], a[24:27], v[216:219]
  ds_read_b128 a[88:91], v3 offset:38912
  v_mfma_f32_16x16x32_bf16 v[212:215], a[52:55], a[20:23], v[212:215]
  v_mfma_f32_16x16x32_bf16 v[208:211], a[52:55], a[16:19], v[208:211]
  buffer_load_dwordx4 v15, s[16:19], s33 offen offset:2048 nt lds
  v_mfma_f32_16x16x32_bf16 v[204:207], a[52:55], a[12:15], v[204:207]
  ds_read_b64_tr_b16 a[120:121], v10 offset:34816
  v_mfma_f32_16x16x32_bf16 v[200:203], a[52:55], a[8:11], v[200:203]
  v_mfma_f32_16x16x32_bf16 v[196:199], a[52:55], a[4:7], v[196:199]
  ds_read_b64_tr_b16 a[122:123], v10 offset:43008
  v_mfma_f32_16x16x32_bf16 v[192:195], a[52:55], a[0:3], v[192:195]
  ds_read_b128 a[92:95], v3 offset:39936
  v_mfma_f32_16x16x32_bf16 v[224:227], a[56:59], a[0:3], v[224:227]
  v_mfma_f32_16x16x32_bf16 v[228:231], a[56:59], a[4:7], v[228:231]
  buffer_load_dwordx4 v16, s[16:19], s33 offen offset:3072 nt lds
  s_add_u32 s33, s33, 229376
  v_mfma_f32_16x16x32_bf16 v[232:235], a[56:59], a[8:11], v[232:235]
  ds_read_b64_tr_b16 a[124:125], v11 offset:34816
  v_mfma_f32_16x16x32_bf16 v[236:239], a[56:59], a[12:15], v[236:239]
  v_mfma_f32_16x16x32_bf16 v[240:243], a[56:59], a[16:19], v[240:243]
  ds_read_b64_tr_b16 a[126:127], v11 offset:43008
  v_mfma_f32_16x16x32_bf16 v[244:247], a[56:59], a[20:23], v[244:247]
  v_mfma_f32_16x16x32_bf16 v[248:251], a[56:59], a[24:27], v[248:251]
  v_mfma_f32_16x16x32_bf16 v[252:255], a[56:59], a[28:31], v[252:255]
  v_mfma_f32_16x16x32_bf16 a[156:159], a[60:63], a[28:31], a[156:159]
  v_mfma_f32_16x16x32_bf16 a[152:155], a[60:63], a[24:27], a[152:155]
  v_mfma_f32_16x16x32_bf16 a[148:151], a[60:63], a[20:23], a[148:151]
  v_mfma_f32_16x16x32_bf16 a[144:147], a[60:63], a[16:19], a[144:147]
  v_mfma_f32_16x16x32_bf16 a[140:143], a[60:63], a[12:15], a[140:143]
  v_mfma_f32_16x16x32_bf16 a[136:139], a[60:63], a[8:11], a[136:139]
  v_mfma_f32_16x16x32_bf16 a[132:135], a[60:63], a[4:7], a[132:135]
  v_mfma_f32_16x16x32_bf16 a[128:131], a[60:63], a[0:3], a[128:131]
  s_waitcnt vmcnt(16) lgkmcnt(0)
  s_barrier
  v_mfma_f32_16x16x32_bf16 v[32:35], a[96:99], a[64:67], v[32:35]
  buffer_load_dword v29, v26, s[24:27], 0 offen
  v_add_u32 v26, s62, v26
  v_mfma_f32_16x16x32_bf16 v[36:39], a[96:99], a[68:71], v[36:39]
  ds_read_b128 a[0:3], v2 offset:0
  v_mfma_f32_16x16x32_bf16 v[40:43], a[96:99], a[72:75], v[40:43]
  v_mfma_f32_16x16x32_bf16 v[44:47], a[96:99], a[76:79], v[44:47]
  ds_read_b64_tr_b16 a[32:33], v4 offset:0
  v_mfma_f32_16x16x32_bf16 v[48:51], a[96:99], a[80:83], v[48:51]
  ds_read_b64_tr_b16 a[34:35], v4 offset:8192
  v_mfma_f32_16x16x32_bf16 v[52:55], a[96:99], a[84:87], v[52:55]
  v_mfma_f32_16x16x32_bf16 v[56:59], a[96:99], a[88:91], v[56:59]
  s_add_u32 m0, s34, 98304
  v_mfma_f32_16x16x32_bf16 v[60:63], a[96:99], a[92:95], v[60:63]
  buffer_load_dwordx4 v12, s[8:11], s32 offen offset:0 lds
  v_mfma_f32_16x16x32_bf16 v[92:95], a[100:103], a[92:95], v[92:95]
  v_mfma_f32_16x16x32_bf16 v[88:91], a[100:103], a[88:91], v[88:91]
  ds_read_b128 a[4:7], v2 offset:1024
  v_mfma_f32_16x16x32_bf16 v[84:87], a[100:103], a[84:87], v[84:87]
  ds_read_b64_tr_b16 a[36:37], v5 offset:0
  v_mfma_f32_16x16x32_bf16 v[80:83], a[100:103], a[80:83], v[80:83]
  v_mfma_f32_16x16x32_bf16 v[76:79], a[100:103], a[76:79], v[76:79]
  ds_read_b64_tr_b16 a[38:39], v5 offset:8192
  v_mfma_f32_16x16x32_bf16 v[72:75], a[100:103], a[72:75], v[72:75]
  buffer_load_dwordx4 v12, s[8:11], s32 offen offset:1024 lds
  v_mfma_f32_16x16x32_bf16 v[68:71], a[100:103], a[68:71], v[68:71]
  v_mfma_f32_16x16x32_bf16 v[64:67], a[100:103], a[64:67], v[64:67]
  ds_read_b128 a[8:11], v2 offset:2048
  v_mfma_f32_16x16x32_bf16 v[96:99], a[104:107], a[64:67], v[96:99]
  ds_read_b64_tr_b16 a[40:41], v6 offset:0
  v_mfma_f32_16x16x32_bf16 v[100:103], a[104:107], a[68:71], v[100:103]
  v_mfma_f32_16x16x32_bf16 v[104:107], a[104:107], a[72:75], v[104:107]
  buffer_load_dwordx4 v12, s[8:11], s32 offen offset:2048 lds
  v_mfma_f32_16x16x32_bf16 v[108:111], a[104:107], a[76:79], v[108:111]
  v_mfma_f32_16x16x32_bf16 v[112:115], a[104:107], a[80:83], v[112:115]
  ds_read_b64_tr_b16 a[42:43], v6 offset:8192
  v_mfma_f32_16x16x32_bf16 v[116:119], a[104:107], a[84:87], v[116:119]
  ds_read_b128 a[12:15], v2 offset:3072
  v_mfma_f32_16x16x32_bf16 v[120:123], a[104:107], a[88:91], v[120:123]
  v_mfma_f32_16x16x32_bf16 v[124:127], a[104:107], a[92:95], v[124:127]
  ds_read_b64_tr_b16 a[44:45], v7 offset:0
  v_mfma_f32_16x16x32_bf16 v[156:159], a[108:111], a[92:95], v[156:159]
  buffer_load_dwordx4 v12, s[8:11], s32 offen offset:3072 lds
  s_add_u32 s32, s32, 16384
  v_mfma_f32_16x16x32_bf16 v[152:155], a[108:111], a[88:91], v[152:155]
  v_mfma_f32_16x16x32_bf16 v[148:151], a[108:111], a[84:87], v[148:151]
  ds_read_b64_tr_b16 a[46:47], v7 offset:8192
  v_mfma_f32_16x16x32_bf16 v[144:147], a[108:111], a[80:83], v[144:147]
  ds_read_b128 a[16:19], v2 offset:4096
  v_mfma_f32_16x16x32_bf16 v[140:143], a[108:111], a[76:79], v[140:143]
  v_mfma_f32_16x16x32_bf16 v[136:139], a[108:111], a[72:75], v[136:139]
  ds_read_b64_tr_b16 a[48:49], v4 offset:2048
  v_mfma_f32_16x16x32_bf16 v[132:135], a[108:111], a[68:71], v[132:135]
  s_add_u32 m0, s35, 98304
  v_mfma_f32_16x16x32_bf16 v[128:131], a[108:111], a[64:67], v[128:131]
  v_mfma_f32_16x16x32_bf16 v[160:163], a[112:115], a[64:67], v[160:163]
  buffer_load_dwordx4 v13, s[12:15], s33 offen offset:0 nt lds
  v_mfma_f32_16x16x32_bf16 v[164:167], a[112:115], a[68:71], v[164:167]
  ds_read_b64_tr_b16 a[50:51], v4 offset:10240
  v_mfma_f32_16x16x32_bf16 v[168:171], a[112:115], a[72:75], v[168:171]
  v_mfma_f32_16x16x32_bf16 v[172:175], a[112:115], a[76:79], v[172:175]
  ds_read_b128 a[20:23], v2 offset:5120
  v_mfma_f32_16x16x32_bf16 v[176:179], a[112:115], a[80:83], v[176:179]
  v_mfma_f32_16x16x32_bf16 v[180:183], a[112:115], a[84:87], v[180:183]
  buffer_load_dwordx4 v14, s[12:15], s33 offen offset:1024 nt lds
  v_mfma_f32_16x16x32_bf16 v[184:187], a[112:115], a[88:91], v[184:187]
  ds_read_b64_tr_b16 a[52:53], v5 offset:2048
  v_mfma_f32_16x16x32_bf16 v[188:191], a[112:115], a[92:95], v[188:191]
  v_mfma_f32_16x16x32_bf16 v[220:223], a[116:119], a[92:95], v[220:223]
  ds_read_b64_tr_b16 a[54:55], v5 offset:10240
  v_mfma_f32_16x16x32_bf16 v[216:219], a[116:119], a[88:91], v[216:219]
  ds_read_b128 a[24:27], v2 offset:6144
  v_mfma_f32_16x16x32_bf16 v[212:215], a[116:119], a[84:87], v[212:215]
  v_mfma_f32_16x16x32_bf16 v[208:211], a[116:119], a[80:83], v[208:211]
  buffer_load_dwordx4 v15, s[16:19], s33 offen offset:2048 nt lds
  v_mfma_f32_16x16x32_bf16 v[204:207], a[116:119], a[76:79], v[204:207]
  ds_read_b64_tr_b16 a[56:57], v6 offset:2048
  v_mfma_f32_16x16x32_bf16 v[200:203], a[116:119], a[72:75], v[200:203]
  v_mfma_f32_16x16x32_bf16 v[196:199], a[116:119], a[68:71], v[196:199]
  ds_read_b64_tr_b16 a[58:59], v6 offset:10240
  v_mfma_f32_16x16x32_bf16 v[192:195], a[116:119], a[64:67], v[192:195]
  ds_read_b128 a[28:31], v2 offset:7168
  v_mfma_f32_16x16x32_bf16 v[224:227], a[120:123], a[64:67], v[224:227]
  v_mfma_f32_16x16x32_bf16 v[228:231], a[120:123], a[68:71], v[228:231]
  buffer_load_dwordx4 v16, s[16:19], s33 offen offset:3072 nt lds
  s_add_u32 s33, s33, 229376
  v_mfma_f32_16x16x32_bf16 v[232:235], a[120:123], a[72:75], v[232:235]
  ds_read_b64_tr_b16 a[60:61], v7 offset:2048
  v_mfma_f32_16x16x32_bf16 v[236:239], a[120:123], a[76:79], v[236:239]
  v_mfma_f32_16x16x32_bf16 v[240:243], a[120:123], a[80:83], v[240:243]
  ds_read_b64_tr_b16 a[62:63], v7 offset:10240
  v_mfma_f32_16x16x32_bf16 v[244:247], a[120:123], a[84:87], v[244:247]
  v_mfma_f32_16x16x32_bf16 v[248:251], a[120:123], a[88:91], v[248:251]
  v_mfma_f32_16x16x32_bf16 v[252:255], a[120:123], a[92:95], v[252:255]
  v_mfma_f32_16x16x32_bf16 a[156:159], a[124:127], a[92:95], a[156:159]
  v_mfma_f32_16x16x32_bf16 a[152:155], a[124:127], a[88:91], a[152:155]
  v_mfma_f32_16x16x32_bf16 a[148:151], a[124:127], a[84:87], a[148:151]
  v_mfma_f32_16x16x32_bf16 a[144:147], a[124:127], a[80:83], a[144:147]
  v_mfma_f32_16x16x32_bf16 a[140:143], a[124:127], a[76:79], a[140:143]
  v_mfma_f32_16x16x32_bf16 a[136:139], a[124:127], a[72:75], a[136:139]
  v_mfma_f32_16x16x32_bf16 a[132:135], a[124:127], a[68:71], a[132:135]
  v_mfma_f32_16x16x32_bf16 a[128:131], a[124:127], a[64:67], a[128:131]
  s_mov_b32 s36, 6
L_g1:
  s_waitcnt vmcnt(16) lgkmcnt(0)
  s_barrier
  v_mfma_f32_16x16x32_bf16 v[32:35], a[32:35], a[0:3], v[32:35]
  buffer_load_dword v29, v26, s[24:27], 0 offen
  v_add_u32 v26, s62, v26
  v_mfma_f32_16x16x32_bf16 v[36:39], a[32:35], a[4:7], v[36:39]
  ds_read_b128 a[64:67], v2 offset:32768
  v_mfma_f32_16x16x32_bf16 v[40:43], a[32:35], a[8:11], v[40:43]
  v_mfma_f32_16x16x32_bf16 v[44:47], a[32:35], a[12:15], v[44:47]
  ds_read_b64_tr_b16 a[96:97], v4 offset:32768
  v_mfma_f32_16x16x32_bf16 v[48:51], a[32:35], a[16:19], v[48:51]
  ds_read_b64_tr_b16 a[98:99], v4 offset:40960
  v_mfma_f32_16x16x32_bf16 v[52:55], a[32:35], a[20:23], v[52:55]
  v_mfma_f32_16x16x32_bf16 v[56:59], a[32:35], a[24:27], v[56:59]
  s_add_u32 m0, s34, 0
  v_mfma_f32_16x16x32_bf16 v[60:63], a[32:35], a[28:31], v[60:63]
  buffer_load_dwordx4 v12, s[8:11], s32 offen offset:0 lds
  v_mfma_f32_16x16x32_bf16 v[92:95], a[36:39], a[28:31], v[92:95]
  v_mfma_f32_16x16x32_bf16 v[88:91], a[36:39], a[24:27], v[88:91]
  ds_read_b128 a[68:71], v2 offset:33792
  v_mfma_f32_16x16x32_bf16 v[84:87], a[36:39], a[20:23], v[84:87]
  ds_read_b64_tr_b16 a[100:101], v5 offset:32768
  v_mfma_f32_16x16x32_bf16 v[80:83], a[36:39], a[16:19], v[80:83]
  v_mfma_f32_16x16x32_bf16 v[76:79], a[36:39], a[12:15], v[76:79]
  ds_read_b64_tr_b16 a[102:103], v5 offset:40960
  v_mfma_f32_16x16x32_bf16 v[72:75], a[36:39], a[8:11], v[72:75]
  buffer_load_dwordx4 v12, s[8:11], s32 offen offset:1024 lds
  v_mfma_f32_16x16x32_bf16 v[68:71], a[36:39], a[4:7], v[68:71]
  v_mfma_f32_16x16x32_bf16 v[64:67], a[36:39], a[0:3], v[64:67]
  ds_read_b128 a[72:75], v2 offset:34816
  v_mfma_f32_16x16x32_bf16 v[96:99], a[40:43], a[0:3], v[96:99]
  ds_read_b64_tr_b16 a[104:105], v6 offset:32768
  v_mfma_f32_16x16x32_bf16 v[100:103], a[40:43], a[4:7], v[100:103]
  v_mfma_f32_16x16x32_bf16 v[104:107], a[40:43], a[8:11], v[104:107]
  buffer_load_dwordx4 v12, s[8:11], s32 offen offset:2048 lds
  v_mfma_f32_16x16x32_bf16 v[108:111], a[40:43], a[12:15], v[108:111]
  v_mfma_f32_16x16x32_bf16 v[112:115], a[40:43], a[16:19], v[112:115]
  ds_read_b64_tr_b16 a[106:107], v6 offset:40960
  v_mfma_f32_16x16x32_bf16 v[116:119], a[40:43], a[20:23], v[116:119]
  ds_read_b128 a[76:79], v2 offset:35840
  v_mfma_f32_16x16x32_bf16 v[120:123], a[40:43], a[24:27], v[120:123]
  v_mfma_f32_16x16x32_bf16 v[124:127], a[40:43], a[28:31], v[124:127]
  ds_read_b64_tr_b16 a[108:109], v7 offset:32768
  v_mfma_f32_16x16x32_bf16 v[156:159], a[44:47], a[28:31], v[156:159]
  buffer_load_dwordx4 v12, s[8:11], s32 offen offset:3072 lds
  s_add_u32 s32, s32, 16384
  v_mfma_f32_16x16x32_bf16 v[152:155], a[44:47], a[24:27], v[152:155]
  v_mfma_f32_16x16x32_bf16 v[148:151], a[44:47], a[20:23], v[148:151]
  ds_read_b64_tr_b16 a[110:111], v7 offset:40960
  v_mfma_f32_16x16x32_bf16 v[144:147], a[44:47], a[16:19], v[144:147]
  ds_read_b128 a[80:83], v2 offset:36864
  v_mfma_f32_16x16x32_bf16 v[140:143], a[44:47], a[12:15], v[140:143]
  v_mfma_f32_16x16x32_bf16 v[136:139], a[44:47], a[8:11], v[136:139]
  ds_read_b64_tr_b16 a[112:113], v4 offset:34816
  v_mfma_f32_16x16x32_bf16 v[132:135], a[44:47], a[4:7], v[132:135]
  s_add_u32 m0, s35, 0
  v_mfma_f32_16x16x32_bf16 v[128:131], a[44:47], a[0:3], v[128:131]
  v_mfma_f32_16x16x32_bf16 v[160:163], a[48:51], a[0:3], v[160:163]
  buffer_load_dwordx4 v13, s[12:15], s33 offen offset:0 nt lds
  v_mfma_f32_16x16x32_bf16 v[164:167], a[48:51], a[4:7], v[164:167]
  ds_read_b64_tr_b16 a[114:115], v4 offset:43008
  v_mfma_f32_16x16x32_bf16 v[168:171], a[48:51], a[8:11], v[168:171]
  v_mfma_f32_16x16x32_bf16 v[172:175], a[48:51], a[12:15], v[172:175]
  ds_read_b128 a[84:87], v2 offset:37888
  v_mfma_f32_16x16x32_bf16 v[176:179], a[48:51], a[16:19], v[176:179]
  v_mfma_f32_16x16x32_bf16 v[180:183], a[48:51], a[20:23], v[180:183]
  buffer_load_dwordx4 v14, s[12:15], s33 offen offset:1024 nt lds
  v_mfma_f32_16x16x32_bf16 v[184:187], a[48:51], a[24:27], v[184:187]
  ds_read_b64_tr_b16 a[116:117], v5 offset:34816
  v_mfma_f32_16x16x32_bf16 v[188:191], a[48:51], a[28:31], v[188:191]
  v_mfma_f32_16x16x32_bf16 v[220:223], a[52:55], a[28:31], v[220:223]
  ds_read_b64_tr_b16 a[118:119], v5 offset:43008
  v_mfma_f32_16x16x32_bf16 v[216:219], a[52:55], a[24:27], v[216:219]
  ds_read_b128 a[88:91], v2 offset:38912
  v_mfma_f32_16x16x32_bf16 v[212:215], a[52:55], a[20:23], v[212:215]
  v_mfma_f32_16x16x32_bf16 v[208:211], a[52:55], a[16:19], v[208:211]
  buffer_load_dwordx4 v15, s[16:19], s33 offen offset:2048 nt lds
  v_mfma_f32_16x16x32_bf16 v[204:207], a[52:55], a[12:15], v[204:207]
  ds_read_b64_tr_b16 a[120:121], v6 offset:34816
  v_mfma_f32_16x16x32_bf16 v[200:203], a[52:55], a[8:11], v[200:203]
  v_mfma_f32_16x16x32_bf16 v[196:199], a[52:55], a[4:7], v[196:199]
  ds_read_b64_tr_b16 a[122:123], v6 offset:43008
  v_mfma_f32_16x16x32_bf16 v[192:195], a[52:55], a[0:3], v[192:195]
  ds_read_b128 a[92:95], v2 offset:39936
  v_mfma_f32_16x16x32_bf16 v[224:227], a[56:59], a[0:3], v[224:227]
  v_mfma_f32_16x16x32_bf16 v[228:231], a[56:59], a[4:7], v[228:231]
  buffer_load_dwordx4 v16, s[16:19], s33 offen offset:3072 nt lds
  s_add_u32 s33, s33, 229376
  v_mfma_f32_16x16x32_bf16 v[232:235], a[56:59], a[8:11], v[232:235]
  ds_read_b64_tr_b16 a[124:125], v7 offset:34816
  v_mfma_f32_16x16x32_bf16 v[236:239], a[56:59], a[12:15], v[236:239]
  v_mfma_f32_16x16x32_bf16 v[240:243], a[56:59], a[16:19], v[240:243]
  ds_read_b64_tr_b16 a[126:127], v7 offset:43008
  v_mfma_f32_16x16x32_bf16 v[244:247], a[56:59], a[20:23], v[244:247]
  v_mfma_f32_16x16x32_bf16 v[248:251], a[56:59], a[24:27], v[248:251]
  v_mfma_f32_16x16x32_bf16 v[252:255], a[56:59], a[28:31], v[252:255]
  v_mfma_f32_16x16x32_bf16 a[156:159], a[60:63], a[28:31], a[156:159]
  v_mfma_f32_16x16x32_bf16 a[152:155], a[60:63], a[24:27], a[152:155]
  v_mfma_f32_16x16x32_bf16 a[148:151], a[60:63], a[20:23], a[148:151]
  v_mfma_f32_16x16x32_bf16 a[144:147], a[60:63], a[16:19], a[144:147]
  v_mfma_f32_16x16x32_bf16 a[140:143], a[60:63], a[12:15], a[140:143]
  v_mfma_f32_16x16x32_bf16 a[136:139], a[60:63], a[8:11], a[136:139]
  v_mfma_f32_16x16x32_bf16 a[132:135], a[60:63], a[4:7], a[132:135]
  v_mfma_f32_16x16x32_bf16 a[128:131], a[60:63], a[0:3], a[128:131]
  s_waitcnt vmcnt(16) lgkmcnt(0)
  s_barrier
  v_mfma_f32_16x16x32_bf16 v[32:35], a[96:99], a[64:67], v[32:35]
  buffer_load_dword v29, v26, s[24:27], 0 offen
  v_add_u32 v26, s62, v26
  v_mfma_f32_16x16x32_bf16 v[36:39], a[96:99], a[68:71], v[36:39]
  ds_read_b128 a[0:3], v3 offset:0
  v_mfma_f32_16x16x32_bf16 v[40:43], a[96:99], a[72:75], v[40:43]
  v_mfma_f32_16x16x32_bf16 v[44:47], a[96:99], a[76:79], v[44:47]
  ds_read_b64_tr_b16 a[32:33], v8 offset:0
  v_mfma_f32_16x16x32_bf16 v[48:51], a[96:99], a[80:83], v[48:51]
  ds_read_b64_tr_b16 a[34:35], v8 offset:8192
  v_mfma_f32_16x16x32_bf16 v[52:55], a[96:99], a[84:87], v[52:55]
  v_mfma_f32_16x16x32_bf16 v[56:59], a[96:99], a[88:91], v[56:59]
  s_add_u32 m0, s34, 32768
  v_mfma_f32_16x16x32_bf16 v[60:63], a[96:99], a[92:95], v[60:63]
  buffer_load_dwordx4 v12, s[8:11], s32 offen offset:0 lds
  v_mfma_f32_16x16x32_bf16 v[92:95], a[100:103], a[92:95], v[92:95]
  v_mfma_f32_16x16x32_bf16 v[88:91], a[100:103], a[88:91], v[88:91]
  ds_read_b128 a[4:7], v3 offset:1024
  v_mfma_f32_16x16x32_bf16 v[84:87], a[100:103], a[84:87], v[84:87]
  ds_read_b64_tr_b16 a[36:37], v9 offset:0
  v_mfma_f32_16x16x32_bf16 v[80:83], a[100:103], a[80:83], v[80:83]
  v_mfma_f32_16x16x32_bf16 v[76:79], a[100:103], a[76:79], v[76:79]
  ds_read_b64_tr_b16 a[38:39], v9 offset:8192
  v_mfma_f32_16x16x32_bf16 v[72:75], a[100:103], a[72:75], v[72:75]
  buffer_load_dwordx4 v12, s[8:11], s32 offen offset:1024 lds
  v_mfma_f32_16x16x32_bf16 v[68:71], a[100:103], a[68:71], v[68:71]
  v_mfma_f32_16x16x32_bf16 v[64:67], a[100:103], a[64:67], v[64:67]
  ds_read_b128 a[8:11], v3 offset:2048
  v_mfma_f32_16x16x32_bf16 v[96:99], a[104:107], a[64:67], v[96:99]
  ds_read_b64_tr_b16 a[40:41], v10 offset:0
  v_mfma_f32_16x16x32_bf16 v[100:103], a[104:107], a[68:71], v[100:103]
  v_mfma_f32_16x16x32_bf16 v[104:107], a[104:107], a[72:75], v[104:107]
  buffer_load_dwordx4 v12, s[8:11], s32 offen offset:2048 lds
  v_mfma_f32_16x16x32_bf16 v[108:111], a[104:107], a[76:79], v[108:111]
  v_mfma_f32_16x16x32_bf16 v[112:115], a[104:107], a[80:83], v[112:115]
  ds_read_b64_tr_b16 a[42:43], v10 offset:8192
  v_mfma_f32_16x16x32_bf16 v[116:119], a[104:107], a[84:87], v[116:119]
  ds_read_b128 a[12:15], v3 offset:3072
  v_mfma_f32_16x16x32_bf16 v[120:123], a[104:107], a[88:91], v[120:123]
  v_mfma_f32_16x16x32_bf16 v[124:127], a[104:107], a[92:95], v[124:127]
  ds_read_b64_tr_b16 a[44:45], v11 offset:0
  v_mfma_f32_16x16x32_bf16 v[156:159], a[108:111], a[92:95], v[156:159]
  buffer_load_dwordx4 v12, s[8:11], s32 offen offset:3072 lds
  s_add_u32 s32, s32, 16384
  v_mfma_f32_16x16x32_bf16 v[152:155], a[108:111], a[88:91], v[152:155]
  v_mfma_f32_16x16x32_bf16 v[148:151], a[108:111], a[84:87], v[148:151]
  ds_read_b64_tr_b16 a[46:47], v11 offset:8192
  v_mfma_f32_16x16x32_bf16 v[144:147], a[108:111], a[80:83], v[144:147]
  ds_read_b128 a[16:19], v3 offset:4096
  v_mfma_f32_16x16x32_bf16 v[140:143], a[108:111], a[76:79], v[140:143]
  v_mfma_f32_16x16x32_bf16 v[136:139], a[108:111], a[72:75], v[136:139]
  ds_read_b64_tr_b16 a[48:49], v8 offset:2048
  v_mfma_f32_16x16x32_bf16 v[132:135], a[108:111], a[68:71], v[132:135]
  s_add_u32 m0, s35, 32768
  v_mfma_f32_16x16x32_bf16 v[128:131], a[108:111], a[64:67], v[128:131]
  v_mfma_f32_16x16x32_bf16 v[160:163], a[112:115], a[64:67], v[160:163]
  buffer_load_dwordx4 v13, s[12:15], s33 offen offset:0 nt lds
  v_mfma_f32_16x16x32_bf16 v[164:167], a[112:115], a[68:71], v[164:167]
  ds_read_b64_tr_b16 a[50:51], v8 offset:10240
  v_mfma_f32_16x16x32_bf16 v[168:171], a[112:115], a[72:75], v[168:171]
  v_mfma_f32_16x16x32_bf16 v[172:175], a[112:115], a[76:79], v[172:175]
  ds_read_b128 a[20:23], v3 offset:5120
  v_mfma_f32_16x16x32_bf16 v[176:179], a[112:115], a[80:83], v[176:179]
  v_mfma_f32_16x16x32_bf16 v[180:183], a[112:115], a[84:87], v[180:183]
  buffer_load_dwordx4 v14, s[12:15], s33 offen offset:1024 nt lds
  v_mfma_f32_16x16x32_bf16 v[184:187], a[112:115], a[88:91], v[184:187]
  ds_read_b64_tr_b16 a[52:53], v9 offset:2048
  v_mfma_f32_16x16x32_bf16 v[188:191], a[112:115], a[92:95], v[188:191]
  v_mfma_f32_16x16x32_bf16 v[220:223], a[116:119], a[92:95], v[220:223]
  ds_read_b64_tr_b16 a[54:55], v9 offset:10240
  v_mfma_f32_16x16x32_bf16 v[216:219], a[116:119], a[88:91], v[216:219]
  ds_read_b128 a[24:27], v3 offset:6144
  v_mfma_f32_16x16x32_bf16 v[212:215], a[116:119], a[84:87], v[212:215]
  v_mfma_f32_16x16x32_bf16 v[208:211], a[116:119], a[80:83], v[208:211]
  buffer_load_dwordx4 v15, s[16:19], s33 offen offset:2048 nt lds
  v_mfma_f32_16x16x32_bf16 v[204:207], a[116:119], a[76:79], v[204:207]
  ds_read_b64_tr_b16 a[56:57], v10 offset:2048
  v_mfma_f32_16x16x32_bf16 v[200:203], a[116:119], a[72:75], v[200:203]
  v_mfma_f32_16x16x32_bf16 v[196:199], a[116:119], a[68:71], v[196:199]
  ds_read_b64_tr_b16 a[58:59], v10 offset:10240
  v_mfma_f32_16x16x32_bf16 v[192:195], a[116:119], a[64:67], v[192:195]
  ds_read_b128 a[28:31], v3 offset:7168
  v_mfma_f32_16x16x32_bf16 v[224:227], a[120:123], a[64:67], v[224:227]
  v_mfma_f32_16x16x32_bf16 v[228:231], a[120:123], a[68:71], v[228:231]
  buffer_load_dwordx4 v16, s[16:19], s33 offen offset:3072 nt lds
  s_add_u32 s33, s33, 229376
  v_mfma_f32_16x16x32_bf16 v[232:235], a[120:123], a[72:75], v[232:235]
  ds_read_b64_tr_b16 a[60:61], v11 offset:2048
  v_mfma_f32_16x16x32_bf16 v[236:239], a[120:123], a[76:79], v[236:239]
  v_mfma_f32_16x16x32_bf16 v[240:243], a[120:123], a[80:83], v[240:243]
  ds_read_b64_tr_b16 a[62:63], v11 offset:10240
  v_mfma_f32_16x16x32_bf16 v[244:247], a[120:123], a[84:87], v[244:247]
  v_mfma_f32_16x16x32_bf16 v[248:251], a[120:123], a[88:91], v[248:251]
  v_mfma_f32_16x16x32_bf16 v[252:255], a[120:123], a[92:95], v[252:255]
  v_mfma_f32_16x16x32_bf16 a[156:159], a[124:127], a[92:95], a[156:159]
  v_mfma_f32_16x16x32_bf16 a[152:155], a[124:127], a[88:91], a[152:155]
  v_mfma_f32_16x16x32_bf16 a[148:151], a[124:127], a[84:87], a[148:151]
  v_mfma_f32_16x16x32_bf16 a[144:147], a[124:127], a[80:83], a[144:147]
  v_mfma_f32_16x16x32_bf16 a[140:143], a[124:127], a[76:79], a[140:143]
  v_mfma_f32_16x16x32_bf16 a[136:139], a[124:127], a[72:75], a[136:139]
  v_mfma_f32_16x16x32_bf16 a[132:135], a[124:127], a[68:71], a[132:135]
  v_mfma_f32_16x16x32_bf16 a[128:131], a[124:127], a[64:67], a[128:131]
  s_waitcnt vmcnt(16) lgkmcnt(0)
  s_barrier
  v_mfma_f32_16x16x32_bf16 v[32:35], a[32:35], a[0:3], v[32:35]
  buffer_load_dword v29, v26, s[24:27], 0 offen
  v_add_u32 v26, s62, v26
  v_mfma_f32_16x16x32_bf16 v[36:39], a[32:35], a[4:7], v[36:39]
  ds_read_b128 a[64:67], v3 offset:32768
  v_mfma_f32_16x16x32_bf16 v[40:43], a[32:35], a[8:11], v[40:43]
  v_mfma_f32_16x16x32_bf16 v[44:47], a[32:35], a[12:15], v[44:47]
  ds_read_b64_tr_b16 a[96:97], v8 offset:32768
  v_mfma_f32_16x16x32_bf16 v[48:51], a[32:35], a[16:19], v[48:51]
  ds_read_b64_tr_b16 a[98:99], v8 offset:40960
  v_mfma_f32_16x16x32_bf16 v[52:55], a[32:35], a[20:23], v[52:55]
  v_mfma_f32_16x16x32_bf16 v[56:59], a[32:35], a[24:27], v[56:59]
  s_add_u32 m0, s34, 65536
  v_mfma_f32_16x16x32_bf16 v[60:63], a[32:35], a[28:31], v[60:63]
  buffer_load_dwordx4 v12, s[8:11], s32 offen offset:0 lds
  v_mfma_f32_16x16x32_bf16 v[92:95], a[36:39], a[28:31], v[92:95]
  v_mfma_f32_16x16x32_bf16 v[88:91], a[36:39], a[24:27], v[88:91]
  ds_read_b128 a[68:71], v3 offset:33792
  v_mfma_f32_16x16x32_bf16 v[84:87], a[36:39], a[20:23], v[84:87]
  ds_read_b64_tr_b16 a[100:101], v9 offset:32768
  v_mfma_f32_16x16x32_bf16 v[80:83], a[36:39], a[16:19], v[80:83]
  v_mfma_f32_16x16x32_bf16 v[76:79], a[36:39], a[12:15], v[76:79]
  ds_read_b64_tr_b16 a[102:103], v9 offset:40960
  v_mfma_f32_16x16x32_bf16 v[72:75], a[36:39], a[8:11], v[72:75]
  buffer_load_dwordx4 v12, s[8:11], s32 offen offset:1024 lds
  v_mfma_f32_16x16x32_bf16 v[68:71], a[36:39], a[4:7], v[68:71]
  v_mfma_f32_16x16x32_bf16 v[64:67], a[36:39], a[0:3], v[64:67]
  ds_read_b128 a[72:75], v3 offset:34816
  v_mfma_f32_16x16x32_bf16 v[96:99], a[40:43], a[0:3], v[96:99]
  ds_read_b64_tr_b16 a[104:105], v10 offset:32768
  v_mfma_f32_16x16x32_bf16 v[100:103], a[40:43], a[4:7], v[100:103]
  v_mfma_f32_16x16x32_bf16 v[104:107], a[40:43], a[8:11], v[104:107]
  buffer_load_dwordx4 v12, s[8:11], s32 offen offset:2048 lds
  v_mfma_f32_16x16x32_bf16 v[108:111], a[40:43], a[12:15], v[108:111]
  v_mfma_f32_16x16x32_bf16 v[112:115], a[40:43], a[16:19], v[112:115]
  ds_read_b64_tr_b16 a[106:107], v10 offset:40960
  v_mfma_f32_16x16x32_bf16 v[116:119], a[40:43], a[20:23], v[116:119]
  ds_read_b128 a[76:79], v3 offset:35840
  v_mfma_f32_16x16x32_bf16 v[120:123], a[40:43], a[24:27], v[120:123]
  v_mfma_f32_16x16x32_bf16 v[124:127], a[40:43], a[28:31], v[124:127]
  ds_read_b64_tr_b16 a[108:109], v11 offset:32768
  v_mfma_f32_16x16x32_bf16 v[156:159], a[44:47], a[28:31], v[156:159]
  buffer_load_dwordx4 v12, s[8:11], s32 offen offset:3072 lds
  s_add_u32 s32, s32, 16384
  v_mfma_f32_16x16x32_bf16 v[152:155], a[44:47], a[24:27], v[152:155]
  v_mfma_f32_16x16x32_bf16 v[148:151], a[44:47], a[20:23], v[148:151]
  ds_read_b64_tr_b16 a[110:111], v11 offset:40960
  v_mfma_f32_16x16x32_bf16 v[144:147], a[44:47], a[16:19], v[144:147]
  ds_read_b128 a[80:83], v3 offset:36864
  v_mfma_f32_16x16x32_bf16 v[140:143], a[44:47], a[12:15], v[140:143]
  v_mfma_f32_16x16x32_bf16 v[136:139], a[44:47], a[8:11], v[136:139]
  ds_read_b64_tr_b16 a[112:113], v8 offset:34816
  v_mfma_f32_16x16x32_bf16 v[132:135], a[44:47], a[4:7], v[132:135]
  s_add_u32 m0, s35, 65536
  v_mfma_f32_16x16x32_bf16 v[128:131], a[44:47], a[0:3], v[128:131]
  v_mfma_f32_16x16x32_bf16 v[160:163], a[48:51], a[0:3], v[160:163]
  buffer_load_dwordx4 v13, s[12:15], s33 offen offset:0 nt lds
  v_mfma_f32_16x16x32_bf16 v[164:167], a[48:51], a[4:7], v[164:167]
  ds_read_b64_tr_b16 a[114:115], v8 offset:43008
  v_mfma_f32_16x16x32_bf16 v[168:171], a[48:51], a[8:11], v[168:171]
  v_mfma_f32_16x16x32_bf16 v[172:175], a[48:51], a[12:15], v[172:175]
  ds_read_b128 a[84:87], v3 offset:37888
  v_mfma_f32_16x16x32_bf16 v[176:179], a[48:51], a[16:19], v[176:179]
  v_mfma_f32_16x16x32_bf16 v[180:183], a[48:51], a[20:23], v[180:183]
  buffer_load_dwordx4 v14, s[12:15], s33 offen offset:1024 nt lds
  v_mfma_f32_16x16x32_bf16 v[184:187], a[48:51], a[24:27], v[184:187]
  ds_read_b64_tr_b16 a[116:117], v9 offset:34816
  v_mfma_f32_16x16x32_bf16 v[188:191], a[48:51], a[28:31], v[188:191]
  v_mfma_f32_16x16x32_bf16 v[220:223], a[52:55], a[28:31], v[220:223]
  ds_read_b64_tr_b16 a[118:119], v9 offset:43008
  v_mfma_f32_16x16x32_bf16 v[216:219], a[52:55], a[24:27], v[216:219]
  ds_read_b128 a[88:91], v3 offset:38912
  v_mfma_f32_16x16x32_bf16 v[212:215], a[52:55], a[20:23], v[212:215]
  v_mfma_f32_16x16x32_bf16 v[208:211], a[52:55], a[16:19], v[208:211]
  buffer_load_dwordx4 v15, s[16:19], s33 offen offset:2048 nt lds
  v_mfma_f32_16x16x32_bf16 v[204:207], a[52:55], a[12:15], v[204:207]
  ds_read_b64_tr_b16 a[120:121], v10 offset:34816
  v_mfma_f32_16x16x32_bf16 v[200:203], a[52:55], a[8:11], v[200:203]
  v_mfma_f32_16x16x32_bf16 v[196:199], a[52:55], a[4:7], v[196:199]
  ds_read_b64_tr_b16 a[122:123], v10 offset:43008
  v_mfma_f32_16x16x32_bf16 v[192:195], a[52:55], a[0:3], v[192:195]
  ds_read_b128 a[92:95], v3 offset:39936
  v_mfma_f32_16x16x32_bf16 v[224:227], a[56:59], a[0:3], v[224:227]
  v_mfma_f32_16x16x32_bf16 v[228:231], a[56:59], a[4:7], v[228:231]
  buffer_load_dwordx4 v16, s[16:19], s33 offen offset:3072 nt lds
  s_add_u32 s33, s33, 229376
  v_mfma_f32_16x16x32_bf16 v[232:235], a[56:59], a[8:11], v[232:235]
  ds_read_b64_tr_b16 a[124:125], v11 offset:34816
  v_mfma_f32_16x16x32_bf16 v[236:239], a[56:59], a[12:15], v[236:239]
  v_mfma_f32_16x16x32_bf16 v[240:243], a[56:59], a[16:19], v[240:243]
  ds_read_b64_tr_b16 a[126:127], v11 offset:43008
  v_mfma_f32_16x16x32_bf16 v[244:247], a[56:59], a[20:23], v[244:247]
  v_mfma_f32_16x16x32_bf16 v[248:251], a[56:59], a[24:27], v[248:251]
  v_mfma_f32_16x16x32_bf16 v[252:255], a[56:59], a[28:31], v[252:255]
  v_mfma_f32_16x16x32_bf16 a[156:159], a[60:63], a[28:31], a[156:159]
  v_mfma_f32_16x16x32_bf16 a[152:155], a[60:63], a[24:27], a[152:155]
  v_mfma_f32_16x16x32_bf16 a[148:151], a[60:63], a[20:23], a[148:151]
  v_mfma_f32_16x16x32_bf16 a[144:147], a[60:63], a[16:19], a[144:147]
  v_mfma_f32_16x16x32_bf16 a[140:143], a[60:63], a[12:15], a[140:143]
  v_mfma_f32_16x16x32_bf16 a[136:139], a[60:63], a[8:11], a[136:139]
  v_mfma_f32_16x16x32_bf16 a[132:135], a[60:63], a[4:7], a[132:135]
  v_mfma_f32_16x16x32_bf16 a[128:131], a[60:63], a[0:3], a[128:131]
  s_waitcnt vmcnt(16) lgkmcnt(0)
  s_barrier
  v_mfma_f32_16x16x32_bf16 v[32:35], a[96:99], a[64:67], v[32:35]
  buffer_load_dword v29, v26, s[24:27], 0 offen
  v_add_u32 v26, s62, v26
  v_mfma_f32_16x16x32_bf16 v[36:39], a[96:99], a[68:71], v[36:39]
  ds_read_b128 a[0:3], v2 offset:0
  v_mfma_f32_16x16x32_bf16 v[40:43], a[96:99], a[72:75], v[40:43]
  v_mfma_f32_16x16x32_bf16 v[44:47], a[96:99], a[76:79], v[44:47]
  ds_read_b64_tr_b16 a[32:33], v4 offset:0
  v_mfma_f32_16x16x32_bf16 v[48:51], a[96:99], a[80:83], v[48:51]
  ds_read_b64_tr_b16 a[34:35], v4 offset:8192
  v_mfma_f32_16x16x32_bf16 v[52:55], a[96:99], a[84:87], v[52:55]
  v_mfma_f32_16x16x32_bf16 v[56:59], a[96:99], a[88:91], v[56:59]
  s_cmp_eq_u32 s36, 5
  s_cselect_b32 s24, s80, s24
  s_cselect_b32 s25, s81, s25
  s_cselect_b32 s26, s63, s26
  s_cselect_b32 s62, 688128, s62
  s_cselect_b64 s[46:47], -1, 0
  v_cndmask_b32 v26, v26, v23, s[46:47]
  v_mfma_f32_16x16x32_bf16 v[60:63], a[96:99], a[92:95], v[60:63]
  ds_read_b128 a[4:7], v2 offset:1024
  v_mfma_f32_16x16x32_bf16 v[92:95], a[100:103], a[92:95], v[92:95]
  v_mfma_f32_16x16x32_bf16 v[88:91], a[100:103], a[88:91], v[88:91]
  ds_read_b64_tr_b16 a[36:37], v5 offset:0
  v_mfma_f32_16x16x32_bf16 v[84:87], a[100:103], a[84:87], v[84:87]
  s_add_u32 m0, s34, 98304
  v_mfma_f32_16x16x32_bf16 v[80:83], a[100:103], a[80:83], v[80:83]
  v_mfma_f32_16x16x32_bf16 v[76:79], a[100:103], a[76:79], v[76:79]
  buffer_load_dwordx4 v12, s[8:11], s32 offen offset:0 lds
  v_mfma_f32_16x16x32_bf16 v[72:75], a[100:103], a[72:75], v[72:75]
  ds_read_b64_tr_b16 a[38:39], v5 offset:8192
  v_mfma_f32_16x16x32_bf16 v[68:71], a[100:103], a[68:71], v[68:71]
  v_mfma_f32_16x16x32_bf16 v[64:67], a[100:103], a[64:67], v[64:67]
  ds_read_b128 a[8:11], v2 offset:2048
  v_mfma_f32_16x16x32_bf16 v[96:99], a[104:107], a[64:67], v[96:99]
  ds_read_b64_tr_b16 a[40:41], v6 offset:0
  v_mfma_f32_16x16x32_bf16 v[100:103], a[104:107], a[68:71], v[100:103]
  v_mfma_f32_16x16x32_bf16 v[104:107], a[104:107], a[72:75], v[104:107]
  buffer_load_dwordx4 v12, s[8:11], s32 offen offset:1024 lds
  v_mfma_f32_16x16x32_bf16 v[108:111], a[104:107], a[76:79], v[108:111]
  ds_read_b64_tr_b16 a[42:43], v6 offset:8192
  v_mfma_f32_16x16x32_bf16 v[112:115], a[104:107], a[80:83], v[112:115]
  v_mfma_f32_16x16x32_bf16 v[116:119], a[104:107], a[84:87], v[116:119]
  ds_read_b128 a[12:15], v2 offset:3072
  v_mfma_f32_16x16x32_bf16 v[120:123], a[104:107], a[88:91], v[120:123]
  buffer_load_dwordx4 v12, s[8:11], s32 offen offset:2048 lds
  v_mfma_f32_16x16x32_bf16 v[124:127], a[104:107], a[92:95], v[124:127]
  v_mfma_f32_16x16x32_bf16 v[156:159], a[108:111], a[92:95], v[156:159]
  ds_read_b64_tr_b16 a[44:45], v7 offset:0
  v_mfma_f32_16x16x32_bf16 v[152:155], a[108:111], a[88:91], v[152:155]
  ds_read_b64_tr_b16 a[46:47], v7 offset:8192
  v_mfma_f32_16x16x32_bf16 v[148:151], a[108:111], a[84:87], v[148:151]
  v_mfma_f32_16x16x32_bf16 v[144:147], a[108:111], a[80:83], v[144:147]
  buffer_load_dwordx4 v12, s[8:11], s32 offen offset:3072 lds
  s_add_u32 s32, s32, 16384
  v_mfma_f32_16x16x32_bf16 v[140:143], a[108:111], a[76:79], v[140:143]
  ds_read_b128 a[16:19], v2 offset:4096
  v_mfma_f32_16x16x32_bf16 v[136:139], a[108:111], a[72:75], v[136:139]
  v_mfma_f32_16x16x32_bf16 v[132:135], a[108:111], a[68:71], v[132:135]
  ds_read_b64_tr_b16 a[48:49], v4 offset:2048
  v_mfma_f32_16x16x32_bf16 v[128:131], a[108:111], a[64:67], v[128:131]
  ds_read_b64_tr_b16 a[50:51], v4 offset:10240
  v_mfma_f32_16x16x32_bf16 v[160:163], a[112:115], a[64:67], v[160:163]
  v_mfma_f32_16x16x32_bf16 v[164:167], a[112:115], a[68:71], v[164:167]
  s_add_u32 m0, s35, 98304
  v_mfma_f32_16x16x32_bf16 v[168:171], a[112:115], a[72:75], v[168:171]
  buffer_load_dwordx4 v13, s[12:15], s33 offen offset:0 nt lds
  v_mfma_f32_16x16x32_bf16 v[172:175], a[112:115], a[76:79], v[172:175]
  v_mfma_f32_16x16x32_bf16 v[176:179], a[112:115], a[80:83], v[176:179]
  ds_read_b128 a[20:23], v2 offset:5120
  v_mfma_f32_16x16x32_bf16 v[180:183], a[112:115], a[84:87], v[180:183]
  ds_read_b64_tr_b16 a[52:53], v5 offset:2048
  v_mfma_f32_16x16x32_bf16 v[184:187], a[112:115], a[88:91], v[184:187]
  v_mfma_f32_16x16x32_bf16 v[188:191], a[112:115], a[92:95], v[188:191]
  buffer_load_dwordx4 v14, s[12:15], s33 offen offset:1024 nt lds
  v_mfma_f32_16x16x32_bf16 v[220:223], a[116:119], a[92:95], v[220:223]
  ds_read_b64_tr_b16 a[54:55], v5 offset:10240
  v_mfma_f32_16x16x32_bf16 v[216:219], a[116:119], a[88:91], v[216:219]
  v_mfma_f32_16x16x32_bf16 v[212:215], a[116:119], a[84:87], v[212:215]
  ds_read_b128 a[24:27], v2 offset:6144
  v_mfma_f32_16x16x32_bf16 v[208:211], a[116:119], a[80:83], v[208:211]
  ds_read_b64_tr_b16 a[56:57], v6 offset:2048
  v_mfma_f32_16x16x32_bf16 v[204:207], a[116:119], a[76:79], v[204:207]
  v_mfma_f32_16x16x32_bf16 v[200:203], a[116:119], a[72:75], v[200:203]
  buffer_load_dwordx4 v15, s[16:19], s33 offen offset:2048 nt lds
  v_mfma_f32_16x16x32_bf16 v[196:199], a[116:119], a[68:71], v[196:199]
  ds_read_b64_tr_b16 a[58:59], v6 offset:10240
  v_mfma_f32_16x16x32_bf16 v[192:195], a[116:119], a[64:67], v[192:195]
  v_mfma_f32_16x16x32_bf16 v[224:227], a[120:123], a[64:67], v[224:227]
  ds_read_b128 a[28:31], v2 offset:7168
  v_mfma_f32_16x16x32_bf16 v[228:231], a[120:123], a[68:71], v[228:231]
  buffer_load_dwordx4 v16, s[16:19], s33 offen offset:3072 nt lds
  s_add_u32 s33, s33, 229376
  v_mfma_f32_16x16x32_bf16 v[232:235], a[120:123], a[72:75], v[232:235]
  v_mfma_f32_16x16x32_bf16 v[236:239], a[120:123], a[76:79], v[236:239]
  ds_read_b64_tr_b16 a[60:61], v7 offset:2048
  v_mfma_f32_16x16x32_bf16 v[240:243], a[120:123], a[80:83], v[240:243]
  ds_read_b64_tr_b16 a[62:63], v7 offset:10240
  v_mfma_f32_16x16x32_bf16 v[244:247], a[120:123], a[84:87], v[244:247]
  v_mfma_f32_16x16x32_bf16 v[248:251], a[120:123], a[88:91], v[248:251]
  v_mfma_f32_16x16x32_bf16 v[252:255], a[120:123], a[92:95], v[252:255]
  v_mfma_f32_16x16x32_bf16 a[156:159], a[124:127], a[92:95], a[156:159]
  v_mfma_f32_16x16x32_bf16 a[152:155], a[124:127], a[88:91], a[152:155]
  v_mfma_f32_16x16x32_bf16 a[148:151], a[124:127], a[84:87], a[148:151]
  v_mfma_f32_16x16x32_bf16 a[144:147], a[124:127], a[80:83], a[144:147]
  v_mfma_f32_16x16x32_bf16 a[140:143], a[124:127], a[76:79], a[140:143]
  v_mfma_f32_16x16x32_bf16 a[136:139], a[124:127], a[72:75], a[136:139]
  v_mfma_f32_16x16x32_bf16 a[132:135], a[124:127], a[68:71], a[132:135]
  s_sub_u32 s36, s36, 1
  s_cmp_lg_u32 s36, 0
  v_mfma_f32_16x16x32_bf16 a[128:131], a[124:127], a[64:67], a[128:131]
  s_cbranch_scc1 L_g1
  s_waitcnt vmcnt(16) lgkmcnt(0)
  s_barrier
  v_mfma_f32_16x16x32_bf16 v[32:35], a[32:35], a[0:3], v[32:35]
  s_and_b32 s56, s41, 1
  s_lshl_b32 s56, s56, 2
  s_and_b32 s57, s42, 3
  s_add_u32 s56, s56, s57
  s_lshr_b32 s57, s42, 2
  s_lshr_b32 s58, s41, 1
  v_mfma_f32_16x16x32_bf16 v[36:39], a[32:35], a[4:7], v[36:39]
  ds_read_b128 a[64:67], v2 offset:32768
  v_mfma_f32_16x16x32_bf16 v[40:43], a[32:35], a[8:11], v[40:43]
  s_mul_i32 s60, s3, 2048
  s_add_u32 s60, s60, 0
  s_mov_b32 s59, 0
  v_mfma_f32_16x16x32_bf16 v[44:47], a[32:35], a[12:15], v[44:47]
  ds_read_b64_tr_b16 a[96:97], v4 offset:32768
  v_mfma_f32_16x16x32_bf16 v[48:51], a[32:35], a[16:19], v[48:51]
  v_lshrrev_b32 v19, 4, v1
  v_and_b32 v20, 15, v1
  v_mfma_f32_16x16x32_bf16 v[52:55], a[32:35], a[20:23], v[52:55]
  ds_read_b64_tr_b16 a[98:99], v4 offset:40960
  v_mfma_f32_16x16x32_bf16 v[56:59], a[32:35], a[24:27], v[56:59]
  s_mov_b32 s40, 2048
  s_mul_i32 s39, s3, 16384
  v_mfma_f32_16x16x32_bf16 v[60:63], a[32:35], a[28:31], v[60:63]
  ds_read_b128 a[68:71], v2 offset:33792
  v_mfma_f32_16x16x32_bf16 v[92:95], a[36:39], a[28:31], v[92:95]
  v_add_u32 v21, 0, v19
  v_mfma_f32_16x16x32_bf16 v[88:91], a[36:39], a[24:27], v[88:91]
  ds_read_b64_tr_b16 a[100:101], v5 offset:32768
  v_mfma_f32_16x16x32_bf16 v[84:87], a[36:39], a[20:23], v[84:87]
  v_mul_lo_u32 v18, v21, s40
  v_add_u32 v18, s39, v18
  v_mfma_f32_16x16x32_bf16 v[80:83], a[36:39], a[16:19], v[80:83]
  ds_read_b64_tr_b16 a[102:103], v5 offset:40960
  v_mfma_f32_16x16x32_bf16 v[76:79], a[36:39], a[12:15], v[76:79]
  v_lshlrev_b32 v21, 1, v21
  v_xor_b32 v21, v21, v20
  v_lshl_add_u32 v18, v21, 4, v18
  v_mfma_f32_16x16x32_bf16 v[72:75], a[36:39], a[8:11], v[72:75]
  v_mfma_f32_16x16x32_bf16 v[68:71], a[36:39], a[4:7], v[68:71]
  ds_read_b128 a[72:75], v2 offset:34816
  v_mfma_f32_16x16x32_bf16 v[64:67], a[36:39], a[0:3], v[64:67]
  v_add_u32 v24, 4096, v18
  v_mfma_f32_16x16x32_bf16 v[96:99], a[40:43], a[0:3], v[96:99]
  ds_read_b64_tr_b16 a[104:105], v6 offset:32768
  v_mfma_f32_16x16x32_bf16 v[100:103], a[40:43], a[4:7], v[100:103]
  v_add_u32 v21, 4, v19
  v_mfma_f32_16x16x32_bf16 v[104:107], a[40:43], a[8:11], v[104:107]
  ds_read_b64_tr_b16 a[106:107], v6 offset:40960
  v_mfma_f32_16x16x32_bf16 v[108:111], a[40:43], a[12:15], v[108:111]
  v_mul_lo_u32 v18, v21, s40
  v_add_u32 v18, s39, v18
  v_mfma_f32_16x16x32_bf16 v[112:115], a[40:43], a[16:19], v[112:115]
  ds_read_b128 a[76:79], v2 offset:35840
  v_mfma_f32_16x16x32_bf16 v[116:119], a[40:43], a[20:23], v[116:119]
  v_lshlrev_b32 v21, 1, v21
  v_xor_b32 v21, v21, v20
  v_lshl_add_u32 v18, v21, 4, v18
  v_mfma_f32_16x16x32_bf16 v[120:123], a[40:43], a[24:27], v[120:123]
  ds_read_b64_tr_b16 a[108:109], v7 offset:32768
  v_mfma_f32_16x16x32_bf16 v[124:127], a[40:43], a[28:31], v[124:127]
  v_add_u32 v25, 3072, v18
  v_mfma_f32_16x16x32_bf16 v[156:159], a[44:47], a[28:31], v[156:159]
  ds_read_b64_tr_b16 a[110:111], v7 offset:40960
  v_mfma_f32_16x16x32_bf16 v[152:155], a[44:47], a[24:27], v[152:155]
  s_mul_i32 s96, s58, 1835008
  v_mfma_f32_16x16x32_bf16 v[148:151], a[44:47], a[20:23], v[148:151]
  v_mfma_f32_16x16x32_bf16 v[144:147], a[44:47], a[16:19], v[144:147]
  s_sub_u32 s98, s42, 4
  s_max_i32 s98, s98, 0
  s_lshr_b32 s98, s98, 2
  v_mfma_f32_16x16x32_bf16 v[140:143], a[44:47], a[12:15], v[140:143]
  ds_read_b128 a[80:83], v2 offset:36864
  v_mfma_f32_16x16x32_bf16 v[136:139], a[44:47], a[8:11], v[136:139]
  s_lshl_b32 s59, s98, 18
  s_add_u32 s59, s59, s96
  v_mfma_f32_16x16x32_bf16 v[132:135], a[44:47], a[4:7], v[132:135]
  ds_read_b64_tr_b16 a[112:113], v4 offset:34816
  v_mfma_f32_16x16x32_bf16 v[128:131], a[44:47], a[0:3], v[128:131]
  s_lshl_b32 s44, s57, 8
  s_sub_u32 s45, 7344128, s44
  v_mfma_f32_16x16x32_bf16 v[160:163], a[48:51], a[0:3], v[160:163]
  ds_read_b64_tr_b16 a[114:115], v4 offset:43008
  v_mfma_f32_16x16x32_bf16 v[164:167], a[48:51], a[4:7], v[164:167]
  s_add_u32 s20, s80, s44
  s_addc_u32 s21, s81, 0
  v_mfma_f32_16x16x32_bf16 v[168:171], a[48:51], a[8:11], v[168:171]
  ds_read_b128 a[84:87], v2 offset:37888
  v_mfma_f32_16x16x32_bf16 v[172:175], a[48:51], a[12:15], v[172:175]
  s_sub_u32 s20, s20, 0x1000
  s_subb_u32 s21, s21, 0
  v_mfma_f32_16x16x32_bf16 v[176:179], a[48:51], a[16:19], v[176:179]
  ds_read_b64_tr_b16 a[116:117], v5 offset:34816
  v_mfma_f32_16x16x32_bf16 v[180:183], a[48:51], a[20:23], v[180:183]
  s_mov_b32 s22, s45
  s_mov_b32 s23, 0x20000
  v_mfma_f32_16x16x32_bf16 v[184:187], a[48:51], a[24:27], v[184:187]
  ds_read_b64_tr_b16 a[118:119], v5 offset:43008
  v_mfma_f32_16x16x32_bf16 v[188:191], a[48:51], a[28:31], v[188:191]
  s_add_u32 s24, s86, 0x400000
  s_addc_u32 s25, s87, 0
  v_mfma_f32_16x16x32_bf16 v[220:223], a[52:55], a[28:31], v[220:223]
  v_mfma_f32_16x16x32_bf16 v[216:219], a[52:55], a[24:27], v[216:219]
  ds_read_b128 a[88:91], v2 offset:38912
  v_mfma_f32_16x16x32_bf16 v[212:215], a[52:55], a[20:23], v[212:215]
  s_mov_b32 s26, 0xe00000
  s_mov_b32 s27, 0x20000
  v_mfma_f32_16x16x32_bf16 v[208:211], a[52:55], a[16:19], v[208:211]
  ds_read_b64_tr_b16 a[120:121], v6 offset:34816
  v_mfma_f32_16x16x32_bf16 v[204:207], a[52:55], a[12:15], v[204:207]
  s_mul_i32 s50, s54, 1835008
  s_lshl_b32 s51, s37, 13
  s_add_u32 s50, s50, s51
  v_mfma_f32_16x16x32_bf16 v[200:203], a[52:55], a[8:11], v[200:203]
  ds_read_b64_tr_b16 a[122:123], v6 offset:43008
  v_mfma_f32_16x16x32_bf16 v[196:199], a[52:55], a[4:7], v[196:199]
  s_lshl_b32 s51, s55, 2
  s_lshl_b32 s52, s38, 1
  s_add_u32 s51, s51, s52
  s_lshl_b32 s51, s51, 14
  v_mfma_f32_16x16x32_bf16 v[192:195], a[52:55], a[0:3], v[192:195]
  ds_read_b128 a[92:95], v2 offset:39936
  v_mfma_f32_16x16x32_bf16 v[224:227], a[56:59], a[0:3], v[224:227]
  s_add_u32 s50, s50, s51
  s_add_u32 s51, s50, 0x4000
  v_mfma_f32_16x16x32_bf16 v[228:231], a[56:59], a[4:7], v[228:231]
  ds_read_b64_tr_b16 a[124:125], v7 offset:34816
  v_mfma_f32_16x16x32_bf16 v[232:235], a[56:59], a[8:11], v[232:235]
  v_lshlrev_b32 v26, 4, v1
  v_add_u32 v27, 0x1000, v26
  v_mfma_f32_16x16x32_bf16 v[236:239], a[56:59], a[12:15], v[236:239]
  ds_read_b64_tr_b16 a[126:127], v7 offset:43008
  v_mfma_f32_16x16x32_bf16 v[240:243], a[56:59], a[16:19], v[240:243]
  s_lshl_b32 s4, s38, 15
  s_lshl_b32 s5, s37, 13
  s_add_u32 s4, s4, s5
  s_add_u32 s4, s4, 81920
  v_add_u32 v28, s4, v26
  v_mfma_f32_16x16x32_bf16 v[244:247], a[56:59], a[20:23], v[244:247]
  v_mfma_f32_16x16x32_bf16 v[248:251], a[56:59], a[24:27], v[248:251]
  v_mfma_f32_16x16x32_bf16 v[252:255], a[56:59], a[28:31], v[252:255]
  v_mfma_f32_16x16x32_bf16 a[156:159], a[60:63], a[28:31], a[156:159]
  v_mfma_f32_16x16x32_bf16 a[152:155], a[60:63], a[24:27], a[152:155]
  v_mfma_f32_16x16x32_bf16 a[148:151], a[60:63], a[20:23], a[148:151]
  v_mfma_f32_16x16x32_bf16 a[144:147], a[60:63], a[16:19], a[144:147]
  v_mfma_f32_16x16x32_bf16 a[140:143], a[60:63], a[12:15], a[140:143]
  v_mfma_f32_16x16x32_bf16 a[136:139], a[60:63], a[8:11], a[136:139]
  v_mfma_f32_16x16x32_bf16 a[132:135], a[60:63], a[4:7], a[132:135]
  v_mfma_f32_16x16x32_bf16 a[128:131], a[60:63], a[0:3], a[128:131]
  s_waitcnt vmcnt(0) lgkmcnt(0)
  s_barrier
  v_mfma_f32_16x16x32_bf16 v[32:35], a[96:99], a[64:67], v[32:35]
  s_add_u32 m0, s60, 0
  s_nop 0
  buffer_load_dwordx4 v24, s[20:23], s59 offen offset:0 lds
  v_mfma_f32_16x16x32_bf16 v[36:39], a[96:99], a[68:71], v[36:39]
  ds_read_b128 a[0:3], v3 offset:0
  v_mfma_f32_16x16x32_bf16 v[40:43], a[96:99], a[72:75], v[40:43]
  buffer_load_dwordx4 v25, s[20:23], s59 offen offset:1024 lds
  s_add_u32 s59, s59, 65536
  v_mfma_f32_16x16x32_bf16 v[44:47], a[96:99], a[76:79], v[44:47]
  ds_read_b64_tr_b16 a[32:33], v8 offset:0
  v_mfma_f32_16x16x32_bf16 v[48:51], a[96:99], a[80:83], v[48:51]
  s_add_u32 m0, s60, 8192
  v_mfma_f32_16x16x32_bf16 v[52:55], a[96:99], a[84:87], v[52:55]
  buffer_load_dwordx4 v24, s[20:23], s59 offen offset:0 lds
  v_mfma_f32_16x16x32_bf16 v[56:59], a[96:99], a[88:91], v[56:59]
  ds_read_b64_tr_b16 a[34:35], v8 offset:8192
  v_mfma_f32_16x16x32_bf16 v[60:63], a[96:99], a[92:95], v[60:63]
  buffer_load_dwordx4 v25, s[20:23], s59 offen offset:1024 lds
  s_add_u32 s59, s59, 65536
  v_mfma_f32_16x16x32_bf16 v[92:95], a[100:103], a[92:95], v[92:95]
  s_add_u32 m0, s60, 16384
  v_mfma_f32_16x16x32_bf16 v[88:91], a[100:103], a[88:91], v[88:91]
  buffer_load_dwordx4 v24, s[20:23], s59 offen offset:0 lds
  ds_read_b128 a[4:7], v3 offset:1024
  v_mfma_f32_16x16x32_bf16 v[84:87], a[100:103], a[84:87], v[84:87]
  buffer_load_dwordx4 v25, s[20:23], s59 offen offset:1024 lds
  s_add_u32 s59, s59, 65536
  v_mfma_f32_16x16x32_bf16 v[80:83], a[100:103], a[80:83], v[80:83]
  ds_read_b64_tr_b16 a[36:37], v9 offset:0
  v_mfma_f32_16x16x32_bf16 v[76:79], a[100:103], a[76:79], v[76:79]
  s_add_u32 m0, s60, 24576
  v_mfma_f32_16x16x32_bf16 v[72:75], a[100:103], a[72:75], v[72:75]
  buffer_load_dwordx4 v24, s[20:23], s59 offen offset:0 lds
  v_mfma_f32_16x16x32_bf16 v[68:71], a[100:103], a[68:71], v[68:71]
  ds_read_b64_tr_b16 a[38:39], v9 offset:8192
  v_mfma_f32_16x16x32_bf16 v[64:67], a[100:103], a[64:67], v[64:67]
  buffer_load_dwordx4 v25, s[20:23], s59 offen offset:1024 lds
  s_add_u32 s59, s59, 65536
  v_mfma_f32_16x16x32_bf16 v[96:99], a[104:107], a[64:67], v[96:99]
  ds_read_b128 a[160:163], v3 offset:32768
  v_mfma_f32_16x16x32_bf16 v[100:103], a[104:107], a[68:71], v[100:103]
  ds_read_b128 a[8:11], v3 offset:2048
  v_mfma_f32_16x16x32_bf16 v[104:107], a[104:107], a[72:75], v[104:107]
  ds_read_b64_tr_b16 a[192:193], v8 offset:32768
  ds_read_b64_tr_b16 a[40:41], v10 offset:0
  v_mfma_f32_16x16x32_bf16 v[108:111], a[104:107], a[76:79], v[108:111]
  ds_read_b64_tr_b16 a[194:195], v8 offset:40960
  v_mfma_f32_16x16x32_bf16 v[112:115], a[104:107], a[80:83], v[112:115]
  ds_read_b64_tr_b16 a[42:43], v10 offset:8192
  v_mfma_f32_16x16x32_bf16 v[116:119], a[104:107], a[84:87], v[116:119]
  ds_read_b128 a[164:167], v3 offset:33792
  v_mfma_f32_16x16x32_bf16 v[120:123], a[104:107], a[88:91], v[120:123]
  ds_read_b64_tr_b16 a[196:197], v9 offset:32768
  v_mfma_f32_16x16x32_bf16 v[124:127], a[104:107], a[92:95], v[124:127]
  ds_read_b128 a[12:15], v3 offset:3072
  v_mfma_f32_16x16x32_bf16 v[156:159], a[108:111], a[92:95], v[156:159]
  ds_read_b64_tr_b16 a[198:199], v9 offset:40960
  v_mfma_f32_16x16x32_bf16 v[152:155], a[108:111], a[88:91], v[152:155]
  ds_read_b64_tr_b16 a[44:45], v11 offset:0
  v_mfma_f32_16x16x32_bf16 v[148:151], a[108:111], a[84:87], v[148:151]
  ds_read_b128 a[168:171], v3 offset:34816
  v_mfma_f32_16x16x32_bf16 v[144:147], a[108:111], a[80:83], v[144:147]
  ds_read_b64_tr_b16 a[46:47], v11 offset:8192
  ds_read_b64_tr_b16 a[200:201], v10 offset:32768
  v_mfma_f32_16x16x32_bf16 v[140:143], a[108:111], a[76:79], v[140:143]
  ds_read_b64_tr_b16 a[202:203], v10 offset:40960
  v_mfma_f32_16x16x32_bf16 v[136:139], a[108:111], a[72:75], v[136:139]
  ds_read_b128 a[16:19], v3 offset:4096
  v_mfma_f32_16x16x32_bf16 v[132:135], a[108:111], a[68:71], v[132:135]
  ds_read_b128 a[172:175], v3 offset:35840
  v_mfma_f32_16x16x32_bf16 v[128:131], a[108:111], a[64:67], v[128:131]
  ds_read_b64_tr_b16 a[48:49], v8 offset:2048
  v_mfma_f32_16x16x32_bf16 v[160:163], a[112:115], a[64:67], v[160:163]
  ds_read_b64_tr_b16 a[204:205], v11 offset:32768
  v_mfma_f32_16x16x32_bf16 v[164:167], a[112:115], a[68:71], v[164:167]
  ds_read_b64_tr_b16 a[50:51], v8 offset:10240
  v_mfma_f32_16x16x32_bf16 v[168:171], a[112:115], a[72:75], v[168:171]
  ds_read_b64_tr_b16 a[206:207], v11 offset:40960
  v_mfma_f32_16x16x32_bf16 v[172:175], a[112:115], a[76:79], v[172:175]
  ds_read_b128 a[176:179], v3 offset:36864
  v_mfma_f32_16x16x32_bf16 v[176:179], a[112:115], a[80:83], v[176:179]
  ds_read_b128 a[20:23], v3 offset:5120
  ds_read_b64_tr_b16 a[208:209], v8 offset:34816
  v_mfma_f32_16x16x32_bf16 v[180:183], a[112:115], a[84:87], v[180:183]
  ds_read_b64_tr_b16 a[52:53], v9 offset:2048
  v_mfma_f32_16x16x32_bf16 v[184:187], a[112:115], a[88:91], v[184:187]
  ds_read_b64_tr_b16 a[210:211], v8 offset:43008
  v_mfma_f32_16x16x32_bf16 v[188:191], a[112:115], a[92:95], v[188:191]
  ds_read_b64_tr_b16 a[54:55], v9 offset:10240
  v_mfma_f32_16x16x32_bf16 v[220:223], a[116:119], a[92:95], v[220:223]
  ds_read_b128 a[180:183], v3 offset:37888
  v_mfma_f32_16x16x32_bf16 v[216:219], a[116:119], a[88:91], v[216:219]
  ds_read_b64_tr_b16 a[212:213], v9 offset:34816
  v_mfma_f32_16x16x32_bf16 v[212:215], a[116:119], a[84:87], v[212:215]
  ds_read_b128 a[24:27], v3 offset:6144
  v_mfma_f32_16x16x32_bf16 v[208:211], a[116:119], a[80:83], v[208:211]
  ds_read_b64_tr_b16 a[214:215], v9 offset:43008
  v_mfma_f32_16x16x32_bf16 v[204:207], a[116:119], a[76:79], v[204:207]
  ds_read_b64_tr_b16 a[56:57], v10 offset:2048
  v_mfma_f32_16x16x32_bf16 v[200:203], a[116:119], a[72:75], v[200:203]
  ds_read_b128 a[184:187], v3 offset:38912
  ds_read_b64_tr_b16 a[58:59], v10 offset:10240
  v_mfma_f32_16x16x32_bf16 v[196:199], a[116:119], a[68:71], v[196:199]
  ds_read_b64_tr_b16 a[216:217], v10 offset:34816
  v_mfma_f32_16x16x32_bf16 v[192:195], a[116:119], a[64:67], v[192:195]
  ds_read_b64_tr_b16 a[218:219], v10 offset:43008
  v_mfma_f32_16x16x32_bf16 v[224:227], a[120:123], a[64:67], v[224:227]
  ds_read_b128 a[28:31], v3 offset:7168
  v_mfma_f32_16x16x32_bf16 v[228:231], a[120:123], a[68:71], v[228:231]
  ds_read_b128 a[188:191], v3 offset:39936
  v_mfma_f32_16x16x32_bf16 v[232:235], a[120:123], a[72:75], v[232:235]
  ds_read_b64_tr_b16 a[60:61], v11 offset:2048
  v_mfma_f32_16x16x32_bf16 v[236:239], a[120:123], a[76:79], v[236:239]
  ds_read_b64_tr_b16 a[220:221], v11 offset:34816
  v_mfma_f32_16x16x32_bf16 v[240:243], a[120:123], a[80:83], v[240:243]
  ds_read_b64_tr_b16 a[62:63], v11 offset:10240
  v_mfma_f32_16x16x32_bf16 v[244:247], a[120:123], a[84:87], v[244:247]
  ds_read_b64_tr_b16 a[222:223], v11 offset:43008
  v_mfma_f32_16x16x32_bf16 v[248:251], a[120:123], a[88:91], v[248:251]
  v_mfma_f32_16x16x32_bf16 v[252:255], a[120:123], a[92:95], v[252:255]
  v_mfma_f32_16x16x32_bf16 a[156:159], a[124:127], a[92:95], a[156:159]
  v_mfma_f32_16x16x32_bf16 a[152:155], a[124:127], a[88:91], a[152:155]
  v_mfma_f32_16x16x32_bf16 a[148:151], a[124:127], a[84:87], a[148:151]
  v_mfma_f32_16x16x32_bf16 a[144:147], a[124:127], a[80:83], a[144:147]
  v_mfma_f32_16x16x32_bf16 a[140:143], a[124:127], a[76:79], a[140:143]
  v_mfma_f32_16x16x32_bf16 a[136:139], a[124:127], a[72:75], a[136:139]
  v_mfma_f32_16x16x32_bf16 a[132:135], a[124:127], a[68:71], a[132:135]
  v_mfma_f32_16x16x32_bf16 a[128:131], a[124:127], a[64:67], a[128:131]
  s_waitcnt lgkmcnt(0)
  s_barrier
  v_mfma_f32_16x16x32_bf16 v[32:35], a[32:35], a[0:3], v[32:35]
  v_mfma_f32_16x16x32_bf16 v[64:67], a[36:39], a[0:3], v[64:67]
  v_mfma_f32_16x16x32_bf16 v[160:163], a[48:51], a[0:3], v[160:163]
  v_mfma_f32_16x16x32_bf16 v[192:195], a[52:55], a[0:3], v[192:195]
  v_mfma_f32_16x16x32_bf16 v[32:35], a[192:195], a[160:163], v[32:35]
  v_mfma_f32_16x16x32_bf16 v[64:67], a[196:199], a[160:163], v[64:67]
  v_mfma_f32_16x16x32_bf16 v[160:163], a[208:211], a[160:163], v[160:163]
  v_mfma_f32_16x16x32_bf16 v[192:195], a[212:215], a[160:163], v[192:195]
  v_mfma_f32_16x16x32_bf16 v[36:39], a[32:35], a[4:7], v[36:39]
  v_mfma_f32_16x16x32_bf16 v[68:71], a[36:39], a[4:7], v[68:71]
  v_mfma_f32_16x16x32_bf16 v[164:167], a[48:51], a[4:7], v[164:167]
  v_mfma_f32_16x16x32_bf16 v[196:199], a[52:55], a[4:7], v[196:199]
  v_mfma_f32_16x16x32_bf16 v[36:39], a[192:195], a[164:167], v[36:39]
  v_mfma_f32_16x16x32_bf16 v[68:71], a[196:199], a[164:167], v[68:71]
  v_mfma_f32_16x16x32_bf16 v[164:167], a[208:211], a[164:167], v[164:167]
  v_mfma_f32_16x16x32_bf16 v[196:199], a[212:215], a[164:167], v[196:199]
  v_mfma_f32_16x16x32_bf16 v[40:43], a[32:35], a[8:11], v[40:43]
  v_pk_mul_f32 v[32:33], v[32:33], v[160:161]
  v_pk_mul_f32 v[34:35], v[34:35], v[162:163]
  v_mfma_f32_16x16x32_bf16 v[72:75], a[36:39], a[8:11], v[72:75]
  v_cvt_pk_bf16_f32 v12, v32, v33
  v_cvt_pk_bf16_f32 v13, v34, v35
  v_mfma_f32_16x16x32_bf16 v[168:171], a[48:51], a[8:11], v[168:171]
  v_pk_mul_f32 v[64:65], v[64:65], v[192:193]
  v_pk_mul_f32 v[66:67], v[66:67], v[194:195]
  v_mfma_f32_16x16x32_bf16 v[200:203], a[52:55], a[8:11], v[200:203]
  v_cvt_pk_bf16_f32 v14, v64, v65
  v_cvt_pk_bf16_f32 v15, v66, v67
  v_mfma_f32_16x16x32_bf16 v[40:43], a[192:195], a[168:171], v[40:43]
  buffer_store_dwordx4 v[12:15], v26, s[24:27], s50 offen offset:0 sc1
  ds_write_b128 v28, v[12:15] offset:0
  v_mfma_f32_16x16x32_bf16 v[72:75], a[196:199], a[168:171], v[72:75]
  v_mfma_f32_16x16x32_bf16 v[168:171], a[208:211], a[168:171], v[168:171]
  v_mfma_f32_16x16x32_bf16 v[200:203], a[212:215], a[168:171], v[200:203]
  v_mfma_f32_16x16x32_bf16 v[44:47], a[32:35], a[12:15], v[44:47]
  v_pk_mul_f32 v[36:37], v[36:37], v[164:165]
  v_pk_mul_f32 v[38:39], v[38:39], v[166:167]
  v_mfma_f32_16x16x32_bf16 v[76:79], a[36:39], a[12:15], v[76:79]
  v_cvt_pk_bf16_f32 v16, v36, v37
  v_cvt_pk_bf16_f32 v17, v38, v39
  v_mfma_f32_16x16x32_bf16 v[172:175], a[48:51], a[12:15], v[172:175]
  v_pk_mul_f32 v[68:69], v[68:69], v[196:197]
  v_pk_mul_f32 v[70:71], v[70:71], v[198:199]
  v_mfma_f32_16x16x32_bf16 v[204:207], a[52:55], a[12:15], v[204:207]
  v_cvt_pk_bf16_f32 v18, v68, v69
  v_cvt_pk_bf16_f32 v19, v70, v71
  v_mfma_f32_16x16x32_bf16 v[44:47], a[192:195], a[172:175], v[44:47]
  buffer_store_dwordx4 v[16:19], v26, s[24:27], s50 offen offset:1024 sc1
  ds_write_b128 v28, v[16:19] offset:1024
  v_mfma_f32_16x16x32_bf16 v[76:79], a[196:199], a[172:175], v[76:79]
  v_mfma_f32_16x16x32_bf16 v[172:175], a[208:211], a[172:175], v[172:175]
  v_mfma_f32_16x16x32_bf16 v[204:207], a[212:215], a[172:175], v[204:207]
  v_mfma_f32_16x16x32_bf16 v[48:51], a[32:35], a[16:19], v[48:51]
  v_pk_mul_f32 v[40:41], v[40:41], v[168:169]
  v_pk_mul_f32 v[42:43], v[42:43], v[170:171]
  v_mfma_f32_16x16x32_bf16 v[80:83], a[36:39], a[16:19], v[80:83]
  v_cvt_pk_bf16_f32 v12, v40, v41
  v_cvt_pk_bf16_f32 v13, v42, v43
  v_mfma_f32_16x16x32_bf16 v[176:179], a[48:51], a[16:19], v[176:179]
  v_pk_mul_f32 v[72:73], v[72:73], v[200:201]
  v_pk_mul_f32 v[74:75], v[74:75], v[202:203]
  v_mfma_f32_16x16x32_bf16 v[208:211], a[52:55], a[16:19], v[208:211]
  v_cvt_pk_bf16_f32 v14, v72, v73
  v_cvt_pk_bf16_f32 v15, v74, v75
  v_mfma_f32_16x16x32_bf16 v[48:51], a[192:195], a[176:179], v[48:51]
  buffer_store_dwordx4 v[12:15], v26, s[24:27], s50 offen offset:2048 sc1
  ds_write_b128 v28, v[12:15] offset:2048
  v_mfma_f32_16x16x32_bf16 v[80:83], a[196:199], a[176:179], v[80:83]
  v_mfma_f32_16x16x32_bf16 v[176:179], a[208:211], a[176:179], v[176:179]
  v_mfma_f32_16x16x32_bf16 v[208:211], a[212:215], a[176:179], v[208:211]
  v_mfma_f32_16x16x32_bf16 v[52:55], a[32:35], a[20:23], v[52:55]
  v_pk_mul_f32 v[44:45], v[44:45], v[172:173]
  v_pk_mul_f32 v[46:47], v[46:47], v[174:175]
  v_mfma_f32_16x16x32_bf16 v[84:87], a[36:39], a[20:23], v[84:87]
  v_cvt_pk_bf16_f32 v16, v44, v45
  v_cvt_pk_bf16_f32 v17, v46, v47
  v_mfma_f32_16x16x32_bf16 v[180:183], a[48:51], a[20:23], v[180:183]
  v_pk_mul_f32 v[76:77], v[76:77], v[204:205]
  v_pk_mul_f32 v[78:79], v[78:79], v[206:207]
  v_mfma_f32_16x16x32_bf16 v[212:215], a[52:55], a[20:23], v[212:215]
  v_cvt_pk_bf16_f32 v18, v76, v77
  v_cvt_pk_bf16_f32 v19, v78, v79
  v_mfma_f32_16x16x32_bf16 v[52:55], a[192:195], a[180:183], v[52:55]
  buffer_store_dwordx4 v[16:19], v26, s[24:27], s50 offen offset:3072 sc1
  ds_write_b128 v28, v[16:19] offset:3072
  v_mfma_f32_16x16x32_bf16 v[84:87], a[196:199], a[180:183], v[84:87]
  v_mfma_f32_16x16x32_bf16 v[180:183], a[208:211], a[180:183], v[180:183]
  v_mfma_f32_16x16x32_bf16 v[212:215], a[212:215], a[180:183], v[212:215]
  v_mfma_f32_16x16x32_bf16 v[56:59], a[32:35], a[24:27], v[56:59]
  v_pk_mul_f32 v[48:49], v[48:49], v[176:177]
  v_pk_mul_f32 v[50:51], v[50:51], v[178:179]
  v_mfma_f32_16x16x32_bf16 v[88:91], a[36:39], a[24:27], v[88:91]
  v_cvt_pk_bf16_f32 v12, v48, v49
  v_cvt_pk_bf16_f32 v13, v50, v51
  v_mfma_f32_16x16x32_bf16 v[184:187], a[48:51], a[24:27], v[184:187]
  v_pk_mul_f32 v[80:81], v[80:81], v[208:209]
  v_pk_mul_f32 v[82:83], v[82:83], v[210:211]
  v_mfma_f32_16x16x32_bf16 v[216:219], a[52:55], a[24:27], v[216:219]
  v_cvt_pk_bf16_f32 v14, v80, v81
  v_cvt_pk_bf16_f32 v15, v82, v83
  v_mfma_f32_16x16x32_bf16 v[56:59], a[192:195], a[184:187], v[56:59]
  buffer_store_dwordx4 v[12:15], v27, s[24:27], s50 offen offset:0 sc1
  ds_write_b128 v28, v[12:15] offset:4096
  v_mfma_f32_16x16x32_bf16 v[88:91], a[196:199], a[184:187], v[88:91]
  v_mfma_f32_16x16x32_bf16 v[184:187], a[208:211], a[184:187], v[184:187]
  v_mfma_f32_16x16x32_bf16 v[216:219], a[212:215], a[184:187], v[216:219]
  v_mfma_f32_16x16x32_bf16 v[60:63], a[32:35], a[28:31], v[60:63]
  v_pk_mul_f32 v[52:53], v[52:53], v[180:181]
  v_pk_mul_f32 v[54:55], v[54:55], v[182:183]
  v_mfma_f32_16x16x32_bf16 v[92:95], a[36:39], a[28:31], v[92:95]
  v_cvt_pk_bf16_f32 v16, v52, v53
  v_cvt_pk_bf16_f32 v17, v54, v55
  v_mfma_f32_16x16x32_bf16 v[188:191], a[48:51], a[28:31], v[188:191]
  v_pk_mul_f32 v[84:85], v[84:85], v[212:213]
  v_pk_mul_f32 v[86:87], v[86:87], v[214:215]
  v_mfma_f32_16x16x32_bf16 v[220:223], a[52:55], a[28:31], v[220:223]
  v_cvt_pk_bf16_f32 v18, v84, v85
  v_cvt_pk_bf16_f32 v19, v86, v87
  v_mfma_f32_16x16x32_bf16 v[60:63], a[192:195], a[188:191], v[60:63]
  buffer_store_dwordx4 v[16:19], v27, s[24:27], s50 offen offset:1024 sc1
  ds_write_b128 v28, v[16:19] offset:5120
  v_mfma_f32_16x16x32_bf16 v[92:95], a[196:199], a[188:191], v[92:95]
  v_mfma_f32_16x16x32_bf16 v[188:191], a[208:211], a[188:191], v[188:191]
  v_mfma_f32_16x16x32_bf16 v[220:223], a[212:215], a[188:191], v[220:223]
  v_mfma_f32_16x16x32_bf16 v[96:99], a[40:43], a[0:3], v[96:99]
  v_pk_mul_f32 v[56:57], v[56:57], v[184:185]
  v_pk_mul_f32 v[58:59], v[58:59], v[186:187]
  v_mfma_f32_16x16x32_bf16 v[128:131], a[44:47], a[0:3], v[128:131]
  v_cvt_pk_bf16_f32 v12, v56, v57
  v_cvt_pk_bf16_f32 v13, v58, v59
  v_mfma_f32_16x16x32_bf16 v[224:227], a[56:59], a[0:3], v[224:227]
  v_pk_mul_f32 v[88:89], v[88:89], v[216:217]
  v_pk_mul_f32 v[90:91], v[90:91], v[218:219]
  v_mfma_f32_16x16x32_bf16 a[128:131], a[60:63], a[0:3], a[128:131]
  v_cvt_pk_bf16_f32 v14, v88, v89
  v_cvt_pk_bf16_f32 v15, v90, v91
  v_mfma_f32_16x16x32_bf16 v[96:99], a[200:203], a[160:163], v[96:99]
  buffer_store_dwordx4 v[12:15], v27, s[24:27], s50 offen offset:2048 sc1
  ds_write_b128 v28, v[12:15] offset:6144
  v_mfma_f32_16x16x32_bf16 v[128:131], a[204:207], a[160:163], v[128:131]
  v_mfma_f32_16x16x32_bf16 v[224:227], a[216:219], a[160:163], v[224:227]
  v_mfma_f32_16x16x32_bf16 a[128:131], a[220:223], a[160:163], a[128:131]
  v_mfma_f32_16x16x32_bf16 v[100:103], a[40:43], a[4:7], v[100:103]
  v_pk_mul_f32 v[60:61], v[60:61], v[188:189]
  v_pk_mul_f32 v[62:63], v[62:63], v[190:191]
  v_mfma_f32_16x16x32_bf16 v[132:135], a[44:47], a[4:7], v[132:135]
  v_cvt_pk_bf16_f32 v16, v60, v61
  v_cvt_pk_bf16_f32 v17, v62, v63
  v_mfma_f32_16x16x32_bf16 v[228:231], a[56:59], a[4:7], v[228:231]
  v_pk_mul_f32 v[92:93], v[92:93], v[220:221]
  v_pk_mul_f32 v[94:95], v[94:95], v[222:223]
  v_mfma_f32_16x16x32_bf16 a[132:135], a[60:63], a[4:7], a[132:135]
  v_cvt_pk_bf16_f32 v18, v92, v93
  v_cvt_pk_bf16_f32 v19, v94, v95
  v_mfma_f32_16x16x32_bf16 v[100:103], a[200:203], a[164:167], v[100:103]
  buffer_store_dwordx4 v[16:19], v27, s[24:27], s50 offen offset:3072 sc1
  ds_write_b128 v28, v[16:19] offset:7168
  v_mfma_f32_16x16x32_bf16 v[132:135], a[204:207], a[164:167], v[132:135]
  v_mfma_f32_16x16x32_bf16 v[228:231], a[216:219], a[164:167], v[228:231]
  v_mfma_f32_16x16x32_bf16 a[132:135], a[220:223], a[164:167], a[132:135]
  v_mfma_f32_16x16x32_bf16 v[104:107], a[40:43], a[8:11], v[104:107]
  v_pk_mul_f32 v[96:97], v[96:97], v[224:225]
  v_pk_mul_f32 v[98:99], v[98:99], v[226:227]
  v_mfma_f32_16x16x32_bf16 v[136:139], a[44:47], a[8:11], v[136:139]
  v_cvt_pk_bf16_f32 v12, v96, v97
  v_cvt_pk_bf16_f32 v13, v98, v99
  v_mfma_f32_16x16x32_bf16 v[232:235], a[56:59], a[8:11], v[232:235]
  v_accvgpr_read_b32 v20, a128
  v_accvgpr_read_b32 v21, a129
  v_mfma_f32_16x16x32_bf16 a[136:139], a[60:63], a[8:11], a[136:139]
  v_accvgpr_read_b32 v22, a130
  v_accvgpr_read_b32 v23, a131
  v_mfma_f32_16x16x32_bf16 v[104:107], a[200:203], a[168:171], v[104:107]
  v_pk_mul_f32 v[128:129], v[128:129], v[20:21]
  v_pk_mul_f32 v[130:131], v[130:131], v[22:23]
  v_mfma_f32_16x16x32_bf16 v[136:139], a[204:207], a[168:171], v[136:139]
  v_cvt_pk_bf16_f32 v14, v128, v129
  v_cvt_pk_bf16_f32 v15, v130, v131
  v_mfma_f32_16x16x32_bf16 v[232:235], a[216:219], a[168:171], v[232:235]
  buffer_store_dwordx4 v[12:15], v26, s[24:27], s51 offen offset:0 sc1
  ds_write_b128 v28, v[12:15] offset:16384
  v_mfma_f32_16x16x32_bf16 a[136:139], a[220:223], a[168:171], a[136:139]
  v_mfma_f32_16x16x32_bf16 v[108:111], a[40:43], a[12:15], v[108:111]
  v_pk_mul_f32 v[100:101], v[100:101], v[228:229]
  v_pk_mul_f32 v[102:103], v[102:103], v[230:231]
  v_mfma_f32_16x16x32_bf16 v[140:143], a[44:47], a[12:15], v[140:143]
  v_cvt_pk_bf16_f32 v16, v100, v101
  v_cvt_pk_bf16_f32 v17, v102, v103
  v_mfma_f32_16x16x32_bf16 v[236:239], a[56:59], a[12:15], v[236:239]
  v_accvgpr_read_b32 v20, a132
  v_accvgpr_read_b32 v21, a133
  v_mfma_f32_16x16x32_bf16 a[140:143], a[60:63], a[12:15], a[140:143]
  v_accvgpr_read_b32 v22, a134
  v_accvgpr_read_b32 v23, a135
  v_mfma_f32_16x16x32_bf16 v[108:111], a[200:203], a[172:175], v[108:111]
  v_pk_mul_f32 v[132:133], v[132:133], v[20:21]
  v_pk_mul_f32 v[134:135], v[134:135], v[22:23]
  v_mfma_f32_16x16x32_bf16 v[140:143], a[204:207], a[172:175], v[140:143]
  v_cvt_pk_bf16_f32 v18, v132, v133
  v_cvt_pk_bf16_f32 v19, v134, v135
  v_mfma_f32_16x16x32_bf16 v[236:239], a[216:219], a[172:175], v[236:239]
  buffer_store_dwordx4 v[16:19], v26, s[24:27], s51 offen offset:1024 sc1
  ds_write_b128 v28, v[16:19] offset:17408
  v_mfma_f32_16x16x32_bf16 a[140:143], a[220:223], a[172:175], a[140:143]
  v_mfma_f32_16x16x32_bf16 v[112:115], a[40:43], a[16:19], v[112:115]
  v_pk_mul_f32 v[104:105], v[104:105], v[232:233]
  v_pk_mul_f32 v[106:107], v[106:107], v[234:235]
  v_mfma_f32_16x16x32_bf16 v[144:147], a[44:47], a[16:19], v[144:147]
  v_cvt_pk_bf16_f32 v12, v104, v105
  v_cvt_pk_bf16_f32 v13, v106, v107
  v_mfma_f32_16x16x32_bf16 v[240:243], a[56:59], a[16:19], v[240:243]
  v_accvgpr_read_b32 v20, a136
  v_accvgpr_read_b32 v21, a137
  v_mfma_f32_16x16x32_bf16 a[144:147], a[60:63], a[16:19], a[144:147]
  v_accvgpr_read_b32 v22, a138
  v_accvgpr_read_b32 v23, a139
  v_mfma_f32_16x16x32_bf16 v[112:115], a[200:203], a[176:179], v[112:115]
  v_pk_mul_f32 v[136:137], v[136:137], v[20:21]
  v_pk_mul_f32 v[138:139], v[138:139], v[22:23]
  v_mfma_f32_16x16x32_bf16 v[144:147], a[204:207], a[176:179], v[144:147]
  v_cvt_pk_bf16_f32 v14, v136, v137
  v_cvt_pk_bf16_f32 v15, v138, v139
  v_mfma_f32_16x16x32_bf16 v[240:243], a[216:219], a[176:179], v[240:243]
  buffer_store_dwordx4 v[12:15], v26, s[24:27], s51 offen offset:2048 sc1
  ds_write_b128 v28, v[12:15] offset:18432
  v_mfma_f32_16x16x32_bf16 a[144:147], a[220:223], a[176:179], a[144:147]
  v_mfma_f32_16x16x32_bf16 v[116:119], a[40:43], a[20:23], v[116:119]
  v_pk_mul_f32 v[108:109], v[108:109], v[236:237]
  v_pk_mul_f32 v[110:111], v[110:111], v[238:239]
  v_mfma_f32_16x16x32_bf16 v[148:151], a[44:47], a[20:23], v[148:151]
  v_cvt_pk_bf16_f32 v16, v108, v109
  v_cvt_pk_bf16_f32 v17, v110, v111
  v_mfma_f32_16x16x32_bf16 v[244:247], a[56:59], a[20:23], v[244:247]
  v_accvgpr_read_b32 v20, a140
  v_accvgpr_read_b32 v21, a141
  v_mfma_f32_16x16x32_bf16 a[148:151], a[60:63], a[20:23], a[148:151]
  v_accvgpr_read_b32 v22, a142
  v_accvgpr_read_b32 v23, a143
  v_mfma_f32_16x16x32_bf16 v[116:119], a[200:203], a[180:183], v[116:119]
  v_pk_mul_f32 v[140:141], v[140:141], v[20:21]
  v_pk_mul_f32 v[142:143], v[142:143], v[22:23]
  v_mfma_f32_16x16x32_bf16 v[148:151], a[204:207], a[180:183], v[148:151]
  v_cvt_pk_bf16_f32 v18, v140, v141
  v_cvt_pk_bf16_f32 v19, v142, v143
  v_mfma_f32_16x16x32_bf16 v[244:247], a[216:219], a[180:183], v[244:247]
  buffer_store_dwordx4 v[16:19], v26, s[24:27], s51 offen offset:3072 sc1
  ds_write_b128 v28, v[16:19] offset:19456
  v_mfma_f32_16x16x32_bf16 a[148:151], a[220:223], a[180:183], a[148:151]
  v_mfma_f32_16x16x32_bf16 v[120:123], a[40:43], a[24:27], v[120:123]
  v_pk_mul_f32 v[112:113], v[112:113], v[240:241]
  v_pk_mul_f32 v[114:115], v[114:115], v[242:243]
  v_mfma_f32_16x16x32_bf16 v[152:155], a[44:47], a[24:27], v[152:155]
  v_cvt_pk_bf16_f32 v12, v112, v113
  v_cvt_pk_bf16_f32 v13, v114, v115
  v_mfma_f32_16x16x32_bf16 v[248:251], a[56:59], a[24:27], v[248:251]
  v_accvgpr_read_b32 v20, a144
  v_accvgpr_read_b32 v21, a145
  v_mfma_f32_16x16x32_bf16 a[152:155], a[60:63], a[24:27], a[152:155]
  v_accvgpr_read_b32 v22, a146
  v_accvgpr_read_b32 v23, a147
  v_mfma_f32_16x16x32_bf16 v[120:123], a[200:203], a[184:187], v[120:123]
  v_pk_mul_f32 v[144:145], v[144:145], v[20:21]
  v_pk_mul_f32 v[146:147], v[146:147], v[22:23]
  v_mfma_f32_16x16x32_bf16 v[152:155], a[204:207], a[184:187], v[152:155]
  v_cvt_pk_bf16_f32 v14, v144, v145
  v_cvt_pk_bf16_f32 v15, v146, v147
  v_mfma_f32_16x16x32_bf16 v[248:251], a[216:219], a[184:187], v[248:251]
  buffer_store_dwordx4 v[12:15], v27, s[24:27], s51 offen offset:0 sc1
  ds_write_b128 v28, v[12:15] offset:20480
  v_mfma_f32_16x16x32_bf16 a[152:155], a[220:223], a[184:187], a[152:155]
  v_mfma_f32_16x16x32_bf16 v[124:127], a[40:43], a[28:31], v[124:127]
  v_pk_mul_f32 v[116:117], v[116:117], v[244:245]
  v_pk_mul_f32 v[118:119], v[118:119], v[246:247]
  v_mfma_f32_16x16x32_bf16 v[156:159], a[44:47], a[28:31], v[156:159]
  v_cvt_pk_bf16_f32 v16, v116, v117
  v_cvt_pk_bf16_f32 v17, v118, v119
  v_mfma_f32_16x16x32_bf16 v[252:255], a[56:59], a[28:31], v[252:255]
  v_accvgpr_read_b32 v20, a148
  v_accvgpr_read_b32 v21, a149
  v_mfma_f32_16x16x32_bf16 a[156:159], a[60:63], a[28:31], a[156:159]
  v_accvgpr_read_b32 v22, a150
  v_accvgpr_read_b32 v23, a151
  v_mfma_f32_16x16x32_bf16 v[124:127], a[200:203], a[188:191], v[124:127]
  v_pk_mul_f32 v[148:149], v[148:149], v[20:21]
  v_pk_mul_f32 v[150:151], v[150:151], v[22:23]
  v_mfma_f32_16x16x32_bf16 v[156:159], a[204:207], a[188:191], v[156:159]
  v_cvt_pk_bf16_f32 v18, v148, v149
  v_cvt_pk_bf16_f32 v19, v150, v151
  v_mfma_f32_16x16x32_bf16 v[252:255], a[216:219], a[188:191], v[252:255]
  buffer_store_dwordx4 v[16:19], v27, s[24:27], s51 offen offset:1024 sc1
  ds_write_b128 v28, v[16:19] offset:21504
  v_mfma_f32_16x16x32_bf16 a[156:159], a[220:223], a[188:191], a[156:159]
  s_nop 7
  v_pk_mul_f32 v[120:121], v[120:121], v[248:249]
  v_pk_mul_f32 v[122:123], v[122:123], v[250:251]
  v_cvt_pk_bf16_f32 v12, v120, v121
  v_cvt_pk_bf16_f32 v13, v122, v123
  v_accvgpr_read_b32 v20, a152
  v_accvgpr_read_b32 v21, a153
  v_accvgpr_read_b32 v22, a154
  v_accvgpr_read_b32 v23, a155
  v_pk_mul_f32 v[152:153], v[152:153], v[20:21]
  v_pk_mul_f32 v[154:155], v[154:155], v[22:23]
  v_cvt_pk_bf16_f32 v14, v152, v153
  v_cvt_pk_bf16_f32 v15, v154, v155
  buffer_store_dwordx4 v[12:15], v27, s[24:27], s51 offen offset:2048 sc1
  ds_write_b128 v28, v[12:15] offset:22528
  v_pk_mul_f32 v[124:125], v[124:125], v[252:253]
  v_pk_mul_f32 v[126:127], v[126:127], v[254:255]
  v_cvt_pk_bf16_f32 v16, v124, v125
  v_cvt_pk_bf16_f32 v17, v126, v127
  v_accvgpr_read_b32 v20, a156
  v_accvgpr_read_b32 v21, a157
  v_accvgpr_read_b32 v22, a158
  v_accvgpr_read_b32 v23, a159
  v_pk_mul_f32 v[156:157], v[156:157], v[20:21]
  v_pk_mul_f32 v[158:159], v[158:159], v[22:23]
  v_cvt_pk_bf16_f32 v18, v156, v157
  v_cvt_pk_bf16_f32 v19, v158, v159
  buffer_store_dwordx4 v[16:19], v27, s[24:27], s51 offen offset:3072 sc1
  ds_write_b128 v28, v[16:19] offset:23552
  s_nop 1
  v_lshlrev_b32 v18, 4, v1
  s_mul_i32 s39, s3, 4096
  v_add_u32 v18, s39, v18
  s_mov_b32 s32, 0
  s_add_u32 s39, s58, 0
  s_and_b32 s39, s39, 3
  s_lshl_b32 s39, s39, 10
  v_add_u32 v12, s39, v18
  s_add_u32 s39, s58, 1
  s_and_b32 s39, s39, 3
  s_lshl_b32 s39, s39, 10
  v_add_u32 v13, s39, v18
  s_add_u32 s39, s58, 2
  s_and_b32 s39, s39, 3
  s_lshl_b32 s39, s39, 10
  v_add_u32 v14, s39, v18
  s_add_u32 s39, s58, 3
  s_and_b32 s39, s39, 3
  s_lshl_b32 s39, s39, 10
  v_add_u32 v15, s39, v18
  v_bfe_u32 v19, v1, 2, 3
  v_lshrrev_b32 v20, 5, v1
  v_lshlrev_b32 v20, 11, v20
  v_lshl_add_u32 v20, v19, 8, v20
  v_and_b32 v21, 3, v1
  v_lshl_add_u32 v20, v21, 3, v20
  v_lshl_add_u32 v20, v19, 5, v20
  v_xor_b32 v4, 0, v20
  v_xor_b32 v5, 32, v20
  v_xor_b32 v6, 64, v20
  v_xor_b32 v7, 96, v20
  v_xor_b32 v8, 128, v20
  v_xor_b32 v9, 160, v20
  v_xor_b32 v10, 192, v20
  v_xor_b32 v11, 224, v20
  s_mul_i32 s44, s56, 1835008
  s_mul_i32 s45, s58, 458752
  s_add_u32 s44, s44, s45
  s_add_u32 s8, s86, s44
  s_addc_u32 s9, s87, 0
  s_add_u32 s8, s8, 0x400000
  s_addc_u32 s9, s9, 0
  s_mov_b32 s10, 0x70000
  s_mov_b32 s11, 0x20000
  s_mul_i32 s44, s56, 28
  s_mul_i32 s45, s58, 7
  s_add_u32 s44, s44, s45
  v_and_b32 v26, 7, v1
  v_min_u32 v26, 6, v26
  v_add_u32 v26, s44, v26
  v_lshlrev_b32 v26, 7, v26
  v_bfe_u32 v18, v1, 3, 1
  v_lshl_add_u32 v26, v18, 2, v26
  s_mov_b32 s101, 0x80000
  s_mov_b32 s47, 0
  s_mov_b32 s97, 0x7f
  v_mov_b32 v30, 0
  v_mov_b32 v16, 0x27ff0
  s_cmp_eq_u32 s3, 0
  s_cselect_b32 s44, 0, 0x80000000
  v_or_b32 v26, s44, v26
  v_add_u32 v18, 81920, v12
  v_add_u32 v19, 81920, v13
  v_add_u32 v20, 81920, v14
  v_add_u32 v21, 81920, v15
  s_bitset0_b32 s97, s98
  s_waitcnt vmcnt(16) lgkmcnt(0)
  s_barrier
  ds_read_b128 a[128:131], v18 offset:0
  ds_read_b128 a[132:135], v19 offset:0
  ds_read_b128 a[136:139], v20 offset:0
  ds_read_b128 a[140:143], v21 offset:0
  ds_read_b128 a[144:147], v18 offset:16384
  ds_read_b128 a[148:151], v19 offset:16384
  ds_read_b128 a[152:155], v20 offset:16384
  ds_read_b128 a[156:159], v21 offset:16384
  ds_read_b128 a[160:163], v18 offset:32768
  ds_read_b128 a[164:167], v19 offset:32768
  ds_read_b128 a[168:171], v20 offset:32768
  ds_read_b128 a[172:175], v21 offset:32768
  ds_read_b128 a[176:179], v18 offset:49152
  ds_read_b128 a[180:183], v19 offset:49152
  ds_read_b128 a[184:187], v20 offset:49152
  ds_read_b128 a[188:191], v21 offset:49152
  ds_read_b64_tr_b16 a[0:1], v4 offset:0
  ds_read_b64_tr_b16 a[2:3], v4 offset:4096
  ds_read_b64_tr_b16 a[4:5], v5 offset:0
  ds_read_b64_tr_b16 a[6:7], v5 offset:4096
  ds_read_b64_tr_b16 a[8:9], v6 offset:0
  ds_read_b64_tr_b16 a[10:11], v6 offset:4096
  ds_read_b64_tr_b16 a[12:13], v7 offset:0
  ds_read_b64_tr_b16 a[14:15], v7 offset:4096
  ds_read_b64_tr_b16 a[16:17], v8 offset:0
  ds_read_b64_tr_b16 a[18:19], v8 offset:4096
  ds_read_b64_tr_b16 a[20:21], v9 offset:0
  ds_read_b64_tr_b16 a[22:23], v9 offset:4096
  ds_read_b64_tr_b16 a[24:25], v10 offset:0
  ds_read_b64_tr_b16 a[26:27], v10 offset:4096
  ds_read_b64_tr_b16 a[28:29], v11 offset:0
  ds_read_b64_tr_b16 a[30:31], v11 offset:4096
  s_waitcnt lgkmcnt(0)
  s_barrier
  v_mfma_f32_16x16x32_bf16 v[32:35], a[0:3], a[128:131], 0
  s_mul_i32 s55, s3, 12288
  s_add_u32 s55, s55, 0x8000
  ds_read_b64_tr_b16 a[32:33], v4 offset:8192
  v_mfma_f32_16x16x32_bf16 v[64:67], a[0:3], a[132:135], 0
  s_lshl_b32 s54, s56, 8
  s_lshl_b32 s44, s3, 6
  s_add_u32 s54, s54, s44
  s_lshl_b32 s44, s58, 4
  s_add_u32 s54, s54, s44
  ds_read_b64_tr_b16 a[34:35], v4 offset:12288
  v_mfma_f32_16x16x32_bf16 v[96:99], a[0:3], a[136:139], 0
  v_lshrrev_b32 v18, 4, v1
  v_and_b32 v19, 15, v1
  s_cmp_ge_u32 s56, 4
  s_cselect_b64 s[62:63], -1, 0
  v_mov_b32 v28, 0x400
  v_mfma_f32_16x16x32_bf16 v[128:131], a[0:3], a[140:143], 0
  v_add_u32 v20, 0, v18
  v_xor_b32 v21, v20, v19
  v_lshlrev_b32 v21, 4, v21
  v_add_u32 v21, 4096, v21
  v_add_u32 v20, s54, v20
  ds_read_b64_tr_b16 a[36:37], v5 offset:8192
  v_mfma_f32_16x16x32_bf16 v[132:135], a[4:7], a[140:143], 0
  v_cmp_eq_u32 vcc, v20, v28
  v_sub_u32 v160, 0xc00, v20
  v_and_b32 v164, 0x3ff, v20
  v_cndmask_b32 v160, v20, v160, s[62:63]
  v_mfma_f32_16x16x32_bf16 v[100:103], a[4:7], a[136:139], 0
  v_cndmask_b32 v160, v160, v28, vcc
  v_cndmask_b32 v164, v164, v28, vcc
  ds_read_b64_tr_b16 a[38:39], v5 offset:12288
  v_mfma_f32_16x16x32_bf16 v[68:71], a[4:7], a[132:135], 0
  v_lshlrev_b32 v160, 11, v160
  v_lshl_add_u32 v188, v19, 4, v160
  v_add_u32 v160, v160, v21
  v_mfma_f32_16x16x32_bf16 v[36:39], a[4:7], a[128:131], 0
  ds_read_b64_tr_b16 a[40:41], v6 offset:8192
  v_mul_u32_u24 v164, 1152, v164
  v_add_u32 v164, v164, v21
  v_mfma_f32_16x16x32_bf16 v[40:43], a[8:11], a[128:131], 0
  v_add_u32 v20, 4, v18
  v_xor_b32 v21, v20, v19
  v_lshlrev_b32 v21, 4, v21
  v_add_u32 v21, 3072, v21
  v_add_u32 v20, s54, v20
  v_mfma_f32_16x16x32_bf16 v[72:75], a[8:11], a[132:135], 0
  ds_read_b64_tr_b16 a[42:43], v6 offset:12288
  v_cmp_eq_u32 vcc, v20, v28
  v_sub_u32 v161, 0xc00, v20
  v_and_b32 v165, 0x3ff, v20
  v_cndmask_b32 v161, v20, v161, s[62:63]
  v_mfma_f32_16x16x32_bf16 v[104:107], a[8:11], a[136:139], 0
  v_cndmask_b32 v161, v161, v28, vcc
  v_cndmask_b32 v165, v165, v28, vcc
  v_mfma_f32_16x16x32_bf16 v[136:139], a[8:11], a[140:143], 0
  ds_read_b64_tr_b16 a[44:45], v7 offset:8192
  v_lshlrev_b32 v161, 11, v161
  v_lshl_add_u32 v189, v19, 4, v161
  v_add_u32 v161, v161, v21
  v_mfma_f32_16x16x32_bf16 v[140:143], a[12:15], a[140:143], 0
  ds_read_b64_tr_b16 a[46:47], v7 offset:12288
  v_mfma_f32_16x16x32_bf16 v[108:111], a[12:15], a[136:139], 0
  v_mul_u32_u24 v165, 1152, v165
  v_add_u32 v165, v165, v21
  v_add_u32 v20, 8, v18
  v_xor_b32 v21, v20, v19
  v_lshlrev_b32 v21, 4, v21
  v_add_u32 v21, 2048, v21
  v_add_u32 v20, s54, v20
  v_mfma_f32_16x16x32_bf16 v[76:79], a[12:15], a[132:135], 0
  ds_read_b64_tr_b16 a[48:49], v8 offset:8192
  v_cmp_eq_u32 vcc, v20, v28
  v_sub_u32 v162, 0xc00, v20
  v_and_b32 v166, 0x3ff, v20
  v_cndmask_b32 v162, v20, v162, s[62:63]
  v_mfma_f32_16x16x32_bf16 v[44:47], a[12:15], a[128:131], 0
  v_cndmask_b32 v162, v162, v28, vcc
  v_cndmask_b32 v166, v166, v28, vcc
  v_mfma_f32_16x16x32_bf16 v[48:51], a[16:19], a[128:131], 0
  ds_read_b64_tr_b16 a[50:51], v8 offset:12288
  v_lshlrev_b32 v162, 11, v162
  v_lshl_add_u32 v190, v19, 4, v162
  v_add_u32 v162, v162, v21
  v_mfma_f32_16x16x32_bf16 v[80:83], a[16:19], a[132:135], 0
  ds_read_b64_tr_b16 a[52:53], v9 offset:8192
  v_mfma_f32_16x16x32_bf16 v[112:115], a[16:19], a[136:139], 0
  v_mul_u32_u24 v166, 1152, v166
  v_add_u32 v166, v166, v21
  v_add_u32 v20, 12, v18
  v_xor_b32 v21, v20, v19
  v_lshlrev_b32 v21, 4, v21
  v_add_u32 v21, 1024, v21
  v_add_u32 v20, s54, v20
  v_mfma_f32_16x16x32_bf16 v[144:147], a[16:19], a[140:143], 0
  ds_read_b64_tr_b16 a[54:55], v9 offset:12288
  v_mfma_f32_16x16x32_bf16 v[148:151], a[20:23], a[140:143], 0
  v_cmp_eq_u32 vcc, v20, v28
  v_sub_u32 v163, 0xc00, v20
  v_and_b32 v167, 0x3ff, v20
  v_cndmask_b32 v163, v20, v163, s[62:63]
  v_cndmask_b32 v163, v163, v28, vcc
  v_cndmask_b32 v167, v167, v28, vcc
  v_mfma_f32_16x16x32_bf16 v[116:119], a[20:23], a[136:139], 0
  ds_read_b64_tr_b16 a[56:57], v10 offset:8192
  v_mfma_f32_16x16x32_bf16 v[84:87], a[20:23], a[132:135], 0
  v_lshlrev_b32 v163, 11, v163
  v_lshl_add_u32 v191, v19, 4, v163
  v_add_u32 v163, v163, v21
  ds_read_b64_tr_b16 a[58:59], v10 offset:12288
  v_mfma_f32_16x16x32_bf16 v[52:55], a[20:23], a[128:131], 0
  v_mul_u32_u24 v167, 1152, v167
  v_add_u32 v167, v167, v21
  v_mfma_f32_16x16x32_bf16 v[56:59], a[24:27], a[128:131], 0
  s_lshl_b32 s61, s57, 8
  s_sub_u32 s45, 4198400, s61
  ds_read_b64_tr_b16 a[60:61], v11 offset:8192
  v_mfma_f32_16x16x32_bf16 v[88:91], a[24:27], a[132:135], 0
  s_add_u32 s12, s64, s61
  s_addc_u32 s13, s65, 0
  v_mfma_f32_16x16x32_bf16 v[120:123], a[24:27], a[136:139], 0
  s_sub_u32 s12, s12, 0x1000
  s_subb_u32 s13, s13, 0
  ds_read_b64_tr_b16 a[62:63], v11 offset:12288
  v_mfma_f32_16x16x32_bf16 v[152:155], a[24:27], a[140:143], 0
  s_mov_b32 s14, s45
  s_mov_b32 s15, 0x20000
  v_mfma_f32_16x16x32_bf16 v[156:159], a[28:31], a[140:143], 0
  v_mfma_f32_16x16x32_bf16 v[124:127], a[28:31], a[136:139], 0
  v_mfma_f32_16x16x32_bf16 v[92:95], a[28:31], a[132:135], 0
  v_mfma_f32_16x16x32_bf16 v[60:63], a[28:31], a[128:131], 0
  s_waitcnt lgkmcnt(0)
  s_barrier
  v_mfma_f32_16x16x32_bf16 v[32:35], a[32:35], a[144:147], v[32:35]
  s_add_u32 m0, s55, 0
  s_nop 0
  buffer_load_dwordx4 v160, s[12:15], 0 offen offset:0 lds
  buffer_load_dwordx4 v161, s[12:15], 0 offen offset:1024 lds
  buffer_load_dwordx4 v162, s[12:15], 0 offen offset:2048 lds
  buffer_load_dwordx4 v163, s[12:15], 0 offen offset:3072 lds
  ds_read_b64_tr_b16 a[0:1], v4 offset:16384
  v_mfma_f32_16x16x32_bf16 v[64:67], a[32:35], a[148:151], v[64:67]
  s_sub_u32 s48, 1794, s61
  s_cmp_ge_u32 s57, 4
  s_cselect_b32 s44, s48, s61
  s_cselect_b32 s48, 248, 0
  s_cselect_b32 s49, -1, 0
  v_mfma_f32_16x16x32_bf16 v[96:99], a[32:35], a[152:155], v[96:99]
  ds_read_b64_tr_b16 a[2:3], v4 offset:20480
  s_sub_u32 s45, 1184896, s44
  v_mfma_f32_16x16x32_bf16 v[128:131], a[32:35], a[156:159], v[128:131]
  s_add_u32 s12, s86, s44
  s_addc_u32 s13, s87, 0
  v_mfma_f32_16x16x32_bf16 v[132:135], a[36:39], a[156:159], v[132:135]
  ds_read_b64_tr_b16 a[4:5], v5 offset:16384
  s_add_u32 s12, s12, 0x16ff000
  s_addc_u32 s13, s13, 0
  v_mfma_f32_16x16x32_bf16 v[100:103], a[36:39], a[152:155], v[100:103]
  ds_read_b64_tr_b16 a[6:7], v5 offset:20480
  v_mfma_f32_16x16x32_bf16 v[68:71], a[36:39], a[148:151], v[68:71]
  s_mov_b32 s14, s45
  s_mov_b32 s15, 0x20000
  s_add_u32 s16, s86, s44
  s_addc_u32 s17, s87, 0
  v_mfma_f32_16x16x32_bf16 v[36:39], a[36:39], a[144:147], v[36:39]
  ds_read_b64_tr_b16 a[8:9], v6 offset:16384
  v_mfma_f32_16x16x32_bf16 v[40:43], a[40:43], a[144:147], v[40:43]
  s_add_u32 s16, s16, 0x18ff000
  s_addc_u32 s17, s17, 0
  s_mov_b32 s18, s45
  s_mov_b32 s19, 0x20000
  v_mfma_f32_16x16x32_bf16 v[72:75], a[40:43], a[148:151], v[72:75]
  ds_read_b64_tr_b16 a[10:11], v6 offset:20480
  v_mfma_f32_16x16x32_bf16 v[104:107], a[40:43], a[152:155], v[104:107]
  s_xor_b32 s62, s62, s49
  s_cmp_lg_u32 s62, 0
  s_cselect_b32 s62, 1.0, -1.0
  s_mov_b32 s63, s62
  ds_read_b64_tr_b16 a[12:13], v7 offset:16384
  v_mfma_f32_16x16x32_bf16 v[136:139], a[40:43], a[156:159], v[136:139]
  v_and_b32 v18, 15, v1
  v_lshrrev_b32 v19, 5, v1
  v_xor_b32 v19, v19, v18
  v_mfma_f32_16x16x32_bf16 v[140:143], a[44:47], a[156:159], v[140:143]
  v_lshlrev_b32 v19, 4, v19
  v_lshl_add_u32 v19, v18, 8, v19
  v_bfe_u32 v20, v1, 4, 1
  v_lshl_add_u32 v19, v20, 3, v19
  ds_read_b64_tr_b16 a[14:15], v7 offset:20480
  v_mfma_f32_16x16x32_bf16 v[108:111], a[44:47], a[152:155], v[108:111]
  v_xor_b32 v20, 0, v19
  v_add_u32 v168, s55, v20
  v_mfma_f32_16x16x32_bf16 v[76:79], a[44:47], a[148:151], v[76:79]
  v_xor_b32 v20, s48, v20
  v_add_u32 v176, s55, v20
  ds_read_b64_tr_b16 a[16:17], v8 offset:16384
  v_mfma_f32_16x16x32_bf16 v[44:47], a[44:47], a[144:147], v[44:47]
  v_xor_b32 v20, 32, v19
  v_add_u32 v169, s55, v20
  v_mfma_f32_16x16x32_bf16 v[48:51], a[48:51], a[144:147], v[48:51]
  ds_read_b64_tr_b16 a[18:19], v8 offset:20480
  v_xor_b32 v20, s48, v20
  v_add_u32 v177, s55, v20
  v_mfma_f32_16x16x32_bf16 v[80:83], a[48:51], a[148:151], v[80:83]
  v_xor_b32 v20, 64, v19
  v_add_u32 v170, s55, v20
  v_mfma_f32_16x16x32_bf16 v[112:115], a[48:51], a[152:155], v[112:115]
  ds_read_b64_tr_b16 a[20:21], v9 offset:16384
  v_xor_b32 v20, s48, v20
  v_add_u32 v178, s55, v20
  v_mfma_f32_16x16x32_bf16 v[144:147], a[48:51], a[156:159], v[144:147]
  ds_read_b64_tr_b16 a[22:23], v9 offset:20480
  v_mfma_f32_16x16x32_bf16 v[148:151], a[52:55], a[156:159], v[148:151]
  v_xor_b32 v20, 96, v19
  v_add_u32 v171, s55, v20
  v_xor_b32 v20, s48, v20
  v_add_u32 v179, s55, v20
  v_mfma_f32_16x16x32_bf16 v[116:119], a[52:55], a[152:155], v[116:119]
  ds_read_b64_tr_b16 a[24:25], v10 offset:16384
  v_mfma_f32_16x16x32_bf16 v[84:87], a[52:55], a[148:151], v[84:87]
  v_xor_b32 v20, 128, v19
  v_add_u32 v172, s55, v20
  v_xor_b32 v20, s48, v20
  v_add_u32 v180, s55, v20
  v_mfma_f32_16x16x32_bf16 v[52:55], a[52:55], a[144:147], v[52:55]
  ds_read_b64_tr_b16 a[26:27], v10 offset:20480
  v_mfma_f32_16x16x32_bf16 v[56:59], a[56:59], a[144:147], v[56:59]
  v_xor_b32 v20, 160, v19
  v_add_u32 v173, s55, v20
  ds_read_b64_tr_b16 a[28:29], v11 offset:16384
  v_mfma_f32_16x16x32_bf16 v[88:91], a[56:59], a[148:151], v[88:91]
  v_xor_b32 v20, s48, v20
  v_add_u32 v181, s55, v20
  v_mfma_f32_16x16x32_bf16 v[120:123], a[56:59], a[152:155], v[120:123]
  v_xor_b32 v20, 192, v19
  v_add_u32 v174, s55, v20
  ds_read_b64_tr_b16 a[30:31], v11 offset:20480
  v_mfma_f32_16x16x32_bf16 v[152:155], a[56:59], a[156:159], v[152:155]
  v_xor_b32 v20, s48, v20
  v_add_u32 v182, s55, v20
  v_mfma_f32_16x16x32_bf16 v[156:159], a[60:63], a[156:159], v[156:159]
  v_mfma_f32_16x16x32_bf16 v[124:127], a[60:63], a[152:155], v[124:127]
  v_mfma_f32_16x16x32_bf16 v[92:95], a[60:63], a[148:151], v[92:95]
  v_mfma_f32_16x16x32_bf16 v[60:63], a[60:63], a[144:147], v[60:63]
  s_waitcnt vmcnt(0) lgkmcnt(0)
  s_barrier
  s_cmp_lg_u32 s3, 0
  s_cbranch_scc1 p2_7
  s_lshl_b32 s4, s43, 7
  s_add_u32 s5, s100, 2
  v_lshl_add_u32 v2, v1, 2, s4
  v_mov_b32 v3, s5
  s_mov_b64 exec, 0xffffffff
  buffer_store_dword v3, v2, s[28:31], 0 offen sc1
  s_mov_b64 exec, -1
p2_7:
  buffer_load_dword v30, v26, s[28:31], 0 offen sc1
  v_mfma_f32_16x16x32_bf16 v[32:35], a[0:3], a[160:163], v[32:35]
  v_xor_b32 v20, 224, v19
  v_add_u32 v175, s55, v20
  ds_read_b64_tr_b16 a[32:33], v4 offset:24576
  v_mfma_f32_16x16x32_bf16 v[64:67], a[0:3], a[164:167], v[64:67]
  v_xor_b32 v20, s48, v20
  v_add_u32 v183, s55, v20
  v_mfma_f32_16x16x32_bf16 v[96:99], a[0:3], a[168:171], v[96:99]
  ds_read_b64_tr_b16 a[34:35], v4 offset:28672
  v_lshrrev_b32 v18, 4, v1
  v_and_b32 v19, 15, v1
  v_mfma_f32_16x16x32_bf16 v[128:131], a[0:3], a[172:175], v[128:131]
  v_add_u32 v21, 0, v18
  v_xor_b32 v20, v21, v19
  v_lshlrev_b32 v20, 4, v20
  v_mfma_f32_16x16x32_bf16 v[132:135], a[4:7], a[172:175], v[132:135]
  ds_read_b64_tr_b16 a[36:37], v5 offset:24576
  v_lshl_add_u32 v20, v21, 8, v20
  v_add_u32 v184, s55, v20
  v_mfma_f32_16x16x32_bf16 v[100:103], a[4:7], a[168:171], v[100:103]
  ds_read_b64_tr_b16 a[38:39], v5 offset:28672
  v_mfma_f32_16x16x32_bf16 v[68:71], a[4:7], a[164:167], v[68:71]
  v_add_u32 v21, 4, v18
  v_xor_b32 v20, v21, v19
  v_lshlrev_b32 v20, 4, v20
  v_lshl_add_u32 v20, v21, 8, v20
  v_add_u32 v185, s55, v20
  v_mfma_f32_16x16x32_bf16 v[36:39], a[4:7], a[160:163], v[36:39]
  ds_read_b64_tr_b16 a[40:41], v6 offset:24576
  v_mfma_f32_16x16x32_bf16 v[40:43], a[8:11], a[160:163], v[40:43]
  v_add_u32 v21, 8, v18
  v_xor_b32 v20, v21, v19
  v_lshlrev_b32 v20, 4, v20
  v_lshl_add_u32 v20, v21, 8, v20
  v_add_u32 v186, s55, v20
  v_mfma_f32_16x16x32_bf16 v[72:75], a[8:11], a[164:167], v[72:75]
  ds_read_b64_tr_b16 a[42:43], v6 offset:28672
  v_mfma_f32_16x16x32_bf16 v[104:107], a[8:11], a[168:171], v[104:107]
  v_add_u32 v21, 12, v18
  v_xor_b32 v20, v21, v19
  v_lshlrev_b32 v20, 4, v20
  ds_read_b64_tr_b16 a[44:45], v7 offset:24576
  v_mfma_f32_16x16x32_bf16 v[136:139], a[8:11], a[172:175], v[136:139]
  v_lshl_add_u32 v20, v21, 8, v20
  v_add_u32 v187, s55, v20
  v_mfma_f32_16x16x32_bf16 v[140:143], a[12:15], a[172:175], v[140:143]
  s_lshl_b32 s44, s56, 3
  s_add_u32 s44, s44, s57
  s_mul_i32 s44, s44, 196608
  s_lshl_b32 s45, s3, 12
  s_add_u32 s44, s44, s45
  ds_read_b64_tr_b16 a[46:47], v7 offset:28672
  v_mfma_f32_16x16x32_bf16 v[108:111], a[12:15], a[168:171], v[108:111]
  s_add_u32 s24, s86, s44
  s_addc_u32 s25, s87, 0
  v_mfma_f32_16x16x32_bf16 v[76:79], a[12:15], a[164:167], v[76:79]
  s_add_u32 s24, s24, 0x2000000
  s_addc_u32 s25, s25, 0
  ds_read_b64_tr_b16 a[48:49], v8 offset:24576
  v_mfma_f32_16x16x32_bf16 v[44:47], a[12:15], a[160:163], v[44:47]
  s_mov_b32 s26, 0x30000
  s_mov_b32 s27, 0x20000
  v_mfma_f32_16x16x32_bf16 v[48:51], a[16:19], a[160:163], v[48:51]
  ds_read_b64_tr_b16 a[50:51], v8 offset:28672
  s_add_u32 s50, s58, 1
  s_and_b32 s50, s50, 3
  s_mul_i32 s50, s50, 49152
  s_add_u32 s50, s50, 0
  v_mfma_f32_16x16x32_bf16 v[80:83], a[16:19], a[164:167], v[80:83]
  s_add_u32 s51, s58, 2
  s_and_b32 s51, s51, 3
  s_mul_i32 s51, s51, 49152
  s_add_u32 s51, s51, 16384
  v_mfma_f32_16x16x32_bf16 v[112:115], a[16:19], a[168:171], v[112:115]
  ds_read_b64_tr_b16 a[52:53], v9 offset:24576
  s_add_u32 s52, s58, 3
  s_and_b32 s52, s52, 3
  s_mul_i32 s52, s52, 49152
  s_add_u32 s52, s52, 32768
  v_mfma_f32_16x16x32_bf16 v[144:147], a[16:19], a[172:175], v[144:147]
  ds_read_b64_tr_b16 a[54:55], v9 offset:28672
  v_mfma_f32_16x16x32_bf16 v[148:151], a[20:23], a[172:175], v[148:151]
  s_mul_i32 s53, s58, 49152
  v_lshlrev_b32 v29, 4, v1
  v_and_b32 v22, 31, v1
  v_add_u32 v22, 224, v22
  v_lshlrev_b32 v22, 7, v22
  v_lshrrev_b32 v23, 5, v1
  v_lshl_add_u32 v22, v23, 2, v22
  v_mfma_f32_16x16x32_bf16 v[116:119], a[20:23], a[168:171], v[116:119]
  ds_read_b64_tr_b16 a[56:57], v10 offset:24576
  v_mfma_f32_16x16x32_bf16 v[84:87], a[20:23], a[164:167], v[84:87]
  s_cmp_lt_u32 s42, 4
  s_cselect_b32 s44, 8, 7
  v_lshrrev_b32 v23, 1, v1
  v_min_u32 v23, 2, v23
  v_add_u32 v23, 1, v23
  v_add_u32 v23, s58, v23
  v_and_b32 v23, 3, v23
  v_mfma_f32_16x16x32_bf16 v[52:55], a[20:23], a[160:163], v[52:55]
  ds_read_b64_tr_b16 a[58:59], v10 offset:28672
  v_mfma_f32_16x16x32_bf16 v[56:59], a[24:27], a[160:163], v[56:59]
  s_mul_i32 s45, s58, s44
  s_sub_u32 s45, s43, s45
  v_mul_u32_u24 v23, s44, v23
  ds_read_b64_tr_b16 a[60:61], v11 offset:24576
  v_mfma_f32_16x16x32_bf16 v[88:91], a[24:27], a[164:167], v[88:91]
  v_add_u32 v23, s45, v23
  v_lshlrev_b32 v23, 7, v23
  v_mfma_f32_16x16x32_bf16 v[120:123], a[24:27], a[168:171], v[120:123]
  s_lshl_b32 s44, s3, 3
  s_add_u32 s44, s44, 16
  v_and_b32 v27, 1, v1
  v_lshl_add_u32 v27, v27, 2, s44
  v_add_u32 v23, v27, v23
  ds_read_b64_tr_b16 a[62:63], v11 offset:28672
  v_mfma_f32_16x16x32_bf16 v[152:155], a[24:27], a[172:175], v[152:155]
  s_lshl_b32 s45, s43, 7
  v_add_u32 v27, s45, v27
  v_mfma_f32_16x16x32_bf16 v[156:159], a[28:31], a[172:175], v[156:159]
  v_mfma_f32_16x16x32_bf16 v[124:127], a[28:31], a[168:171], v[124:127]
  v_mfma_f32_16x16x32_bf16 v[92:95], a[28:31], a[164:167], v[92:95]
  v_mfma_f32_16x16x32_bf16 v[60:63], a[28:31], a[160:163], v[60:63]
  s_waitcnt vmcnt(0) lgkmcnt(0)
  s_cmp_lg_u32 s3, 0
  s_cbranch_scc1 tpx_11
  s_cmp_eq_u32 s47, 0x7f
  s_cbranch_scc1 tpd_9
  s_branch tpc_10
tp_8:
  buffer_load_dword v30, v26, s[28:31], 0 offen sc1
  s_waitcnt vmcnt(0)
tpc_10:
  v_subrev_u32 v30, s100, v30
  v_subrev_u32 v30, 2, v30
  v_cmp_lt_u32 vcc, 7, v30
  s_lshr_b32 s4, vcc_lo, 8
  s_or_b32 s4, s4, vcc_lo
  s_sub_u32 s101, s101, 1
  s_cselect_b32 s4, 0, s4
  s_andn2_b32 s4, 0x7f, s4
  s_or_b32 s47, s47, s4
  s_and_b32 s4, s47, s97
  s_cbranch_scc0 tp_8
tpd_9:
  s_and_b32 s4, s47, s97
  s_ff1_i32_b32 s4, s4
  s_bitset0_b32 s97, s4
  v_mov_b32 v17, s4
  ds_write_b32 v16, v17 offset:4
  s_waitcnt lgkmcnt(0)
tpx_11:
  s_barrier
  ds_read_b32 v17, v16 offset:4
  s_waitcnt lgkmcnt(0)
  v_readfirstlane_b32 s99, v17
  v_mfma_f32_16x16x32_bf16 v[32:35], a[32:35], a[176:179], v[32:35]
  s_lshl_b32 s59, s99, 18
  s_add_u32 s59, s59, s96
  s_lshl_b32 s32, s99, 16
  v_mfma_f32_16x16x32_bf16 v[64:67], a[32:35], a[180:183], v[64:67]
  s_add_u32 m0, s60, 0
  v_mfma_f32_16x16x32_bf16 v[96:99], a[32:35], a[184:187], v[96:99]
  buffer_load_dwordx4 v24, s[20:23], s59 offen offset:0 lds
  v_mfma_f32_16x16x32_bf16 v[128:131], a[32:35], a[188:191], v[128:131]
  buffer_load_dwordx4 v25, s[20:23], s59 offen offset:1024 lds
  s_add_u32 s59, s59, 65536
  v_mfma_f32_16x16x32_bf16 v[132:135], a[36:39], a[188:191], v[132:135]
  buffer_load_dwordx4 a[128:131], v12, s[8:11], s32 offen
  v_mfma_f32_16x16x32_bf16 v[100:103], a[36:39], a[184:187], v[100:103]
  buffer_load_dwordx4 a[132:135], v13, s[8:11], s32 offen
  v_mfma_f32_16x16x32_bf16 v[68:71], a[36:39], a[180:183], v[68:71]
  buffer_load_dwordx4 a[136:139], v14, s[8:11], s32 offen
  v_mfma_f32_16x16x32_bf16 v[36:39], a[36:39], a[176:179], v[36:39]
  buffer_load_dwordx4 a[140:143], v15, s[8:11], s32 offen
  s_add_u32 s32, s32, 16384
  v_mfma_f32_16x16x32_bf16 v[40:43], a[40:43], a[176:179], v[40:43]
  s_add_u32 m0, s60, 8192
  v_mfma_f32_16x16x32_bf16 v[72:75], a[40:43], a[180:183], v[72:75]
  v_mfma_f32_16x16x32_bf16 v[104:107], a[40:43], a[184:187], v[104:107]
  buffer_load_dwordx4 v24, s[20:23], s59 offen offset:0 lds
  v_mfma_f32_16x16x32_bf16 v[136:139], a[40:43], a[188:191], v[136:139]
  buffer_load_dwordx4 v25, s[20:23], s59 offen offset:1024 lds
  s_add_u32 s59, s59, 65536
  v_mfma_f32_16x16x32_bf16 v[140:143], a[44:47], a[188:191], v[140:143]
  buffer_load_dwordx4 a[144:147], v12, s[8:11], s32 offen
  v_mfma_f32_16x16x32_bf16 v[108:111], a[44:47], a[184:187], v[108:111]
  buffer_load_dwordx4 a[148:151], v13, s[8:11], s32 offen
  v_mfma_f32_16x16x32_bf16 v[76:79], a[44:47], a[180:183], v[76:79]
  buffer_load_dwordx4 a[152:155], v14, s[8:11], s32 offen
  v_mfma_f32_16x16x32_bf16 v[44:47], a[44:47], a[176:179], v[44:47]
  buffer_load_dwordx4 a[156:159], v15, s[8:11], s32 offen
  s_add_u32 s32, s32, 16384
  v_mfma_f32_16x16x32_bf16 v[48:51], a[48:51], a[176:179], v[48:51]
  s_add_u32 m0, s60, 16384
  v_mfma_f32_16x16x32_bf16 v[80:83], a[48:51], a[180:183], v[80:83]
  buffer_load_dwordx4 v24, s[20:23], s59 offen offset:0 lds
  v_mfma_f32_16x16x32_bf16 v[112:115], a[48:51], a[184:187], v[112:115]
  v_mfma_f32_16x16x32_bf16 v[144:147], a[48:51], a[188:191], v[144:147]
  buffer_load_dwordx4 v25, s[20:23], s59 offen offset:1024 lds
  s_add_u32 s59, s59, 65536
  v_mfma_f32_16x16x32_bf16 v[148:151], a[52:55], a[188:191], v[148:151]
  buffer_load_dwordx4 a[160:163], v12, s[8:11], s32 offen
  v_mfma_f32_16x16x32_bf16 v[116:119], a[52:55], a[184:187], v[116:119]
  buffer_load_dwordx4 a[164:167], v13, s[8:11], s32 offen
  v_mfma_f32_16x16x32_bf16 v[84:87], a[52:55], a[180:183], v[84:87]
  buffer_load_dwordx4 a[168:171], v14, s[8:11], s32 offen
  v_mfma_f32_16x16x32_bf16 v[52:55], a[52:55], a[176:179], v[52:55]
  buffer_load_dwordx4 a[172:175], v15, s[8:11], s32 offen
  s_add_u32 s32, s32, 16384
  v_mfma_f32_16x16x32_bf16 v[56:59], a[56:59], a[176:179], v[56:59]
  s_add_u32 m0, s60, 24576
  v_mfma_f32_16x16x32_bf16 v[88:91], a[56:59], a[180:183], v[88:91]
  buffer_load_dwordx4 v24, s[20:23], s59 offen offset:0 lds
  v_mfma_f32_16x16x32_bf16 v[120:123], a[56:59], a[184:187], v[120:123]
  buffer_load_dwordx4 v25, s[20:23], s59 offen offset:1024 lds
  s_add_u32 s59, s59, 65536
  v_mfma_f32_16x16x32_bf16 v[152:155], a[56:59], a[188:191], v[152:155]
  v_mfma_f32_16x16x32_bf16 v[156:159], a[60:63], a[188:191], v[156:159]
  v_mfma_f32_16x16x32_bf16 v[124:127], a[60:63], a[184:187], v[124:127]
  v_mfma_f32_16x16x32_bf16 v[92:95], a[60:63], a[180:183], v[92:95]
  v_mfma_f32_16x16x32_bf16 v[60:63], a[60:63], a[176:179], v[60:63]
  s_mov_b32 s46, 5
  s_branch L_k2
L_fft:
  s_and_b32 s54, s41, 1
  s_lshr_b32 s55, s41, 1
  s_mul_i32 s35, s3, 2048
  s_add_u32 s35, s35, 16384
  s_mov_b32 s33, 0
  v_lshrrev_b32 v19, 4, v1
  v_and_b32 v20, 15, v1
  s_mov_b32 s40, 2048
  s_mul_i32 s39, s3, 16384
  v_add_u32 v21, 0, v19
  v_mul_lo_u32 v18, v21, s40
  v_add_u32 v18, s39, v18
  v_lshlrev_b32 v21, 1, v21
  v_xor_b32 v21, v21, v20
  v_lshl_add_u32 v18, v21, 4, v18
  v_add_u32 v13, 4096, v18
  v_add_u32 v21, 4, v19
  v_mul_lo_u32 v18, v21, s40
  v_add_u32 v18, s39, v18
  v_lshlrev_b32 v21, 1, v21
  v_xor_b32 v21, v21, v20
  v_lshl_add_u32 v18, v21, 4, v18
  v_add_u32 v14, 3072, v18
  s_cmp_eq_u32 s54, 0
  s_cselect_b32 s96, s70, s72
  s_cselect_b32 s97, s71, s73
  s_cselect_b32 s98, s66, s68
  s_cselect_b32 s99, s67, s69
  s_lshl_b32 s46, s55, 8
  s_sub_u32 s47, 1052672, s46
  s_add_u32 s12, s96, s46
  s_addc_u32 s13, s97, 0
  s_sub_u32 s12, s12, 0x1000
  s_subb_u32 s13, s13, 0
  s_mov_b32 s14, s47
  s_mov_b32 s15, 0x20000
  s_lshl_b32 s63, s42, 1
  s_add_u32 s63, s63, s37
  s_and_b32 s63, s63, 3
  v_lshlrev_b32 v18, 4, v1
  s_mul_i32 s39, s37, 8192
  v_add_u32 v2, s39, v18
  v_add_u32 v3, 49152, v2
  s_mul_i32 s34, s3, 4096
  s_mov_b32 s32, 0
  v_bfe_u32 v19, v1, 2, 2
  v_lshlrev_b32 v19, 8, v19
  v_lshrrev_b32 v20, 4, v1
  v_lshl_add_u32 v19, v20, 6, v19
  v_and_b32 v20, 3, v1
  v_lshl_add_u32 v19, v20, 4, v19
  v_add_u32 v12, s34, v19
  v_add_u32 v17, 98304, v18
  v_bfe_u32 v19, v1, 2, 3
  v_lshrrev_b32 v20, 5, v1
  v_mul_u32_u24 v20, 2048, v20
  v_lshl_add_u32 v20, v19, 8, v20
  v_and_b32 v21, 3, v1
  v_lshl_add_u32 v20, v21, 3, v20
  v_add_u32 v20, 16384, v20
  s_lshl_b32 s39, s38, 2
  s_add_u32 s40, s39, 0
  v_xor_b32 v21, s40, v19
  v_lshl_add_u32 v4, v21, 5, v20
  v_add_u32 v8, 49152, v4
  s_add_u32 s40, s39, 1
  v_xor_b32 v21, s40, v19
  v_lshl_add_u32 v5, v21, 5, v20
  v_add_u32 v9, 49152, v5
  s_add_u32 s40, s39, 2
  v_xor_b32 v21, s40, v19
  v_lshl_add_u32 v6, v21, 5, v20
  v_add_u32 v10, 49152, v6
  s_add_u32 s40, s39, 3
  v_xor_b32 v21, s40, v19
  v_lshl_add_u32 v7, v21, 5, v20
  v_add_u32 v11, 49152, v7
  s_and_b32 s40, s63, 3
  s_add_u32 s40, s40, s39
  v_xor_b32 v21, s40, v19
  v_lshl_add_u32 v22, v21, 5, v20
  s_lshr_b32 s40, s63, 2
  s_lshl_b32 s40, s40, 11
  v_add_u32 v22, s40, v22
  v_add_u32 v23, 49152, v22
  v_lshlrev_b32 v32, 7, v1
  v_add_u32 v33, 0x2000, v32
  v_add_u32 v34, 0x4000, v32
  v_add_u32 v35, 0x6000, v32
  s_waitcnt vmcnt(0)
  s_mov_b32 s5, 0x80000
  v_mov_b32 v18, 0
tg_13:
  v_readfirstlane_b32 s100, v30
  s_sub_u32 s5, s5, 1
  s_cbranch_scc1 tgd_14
  s_cmp_lg_u32 s100, 0
  s_cbranch_scc1 tgd_14
  s_sleep 1
  buffer_load_dword v30, v18, s[28:31], 0 offen sc1
  s_waitcnt vmcnt(0)
  s_branch tg_13
tgd_14:
  s_add_u32 s28, s86, 0x1e00000
  s_addc_u32 s29, s87, 0
  s_mov_b32 s30, 0x8000
  s_mov_b32 s31, 0x20000
  s_barrier
  s_cmp_lg_u32 s3, 0
  s_cbranch_scc1 pub_12
  s_lshl_b32 s4, s43, 7
  s_add_u32 s5, s100, 1
  v_lshl_add_u32 v18, v1, 2, s4
  v_mov_b32 v19, s5
  s_mov_b64 exec, 0xffffffff
  buffer_store_dword v19, v18, s[28:31], 0 offen sc1
  s_mov_b64 exec, -1
pub_12:
  s_add_u32 m0, s35, 0
  s_nop 0
  buffer_load_dwordx4 v13, s[12:15], s33 offen offset:0 lds
  buffer_load_dwordx4 v14, s[12:15], s33 offen offset:1024 lds
  s_add_u32 s33, s33, 65536
  s_add_u32 m0, s35, 24576
  s_nop 0
  buffer_load_dwordx4 v13, s[12:15], s33 offen offset:0 lds
  buffer_load_dwordx4 v14, s[12:15], s33 offen offset:1024 lds
  s_add_u32 s33, s33, 65536
  s_add_u32 m0, s35, 49152
  s_nop 0
  buffer_load_dwordx4 v13, s[12:15], s33 offen offset:0 lds
  buffer_load_dwordx4 v14, s[12:15], s33 offen offset:1024 lds
  s_add_u32 s33, s33, 65536
  s_add_u32 m0, s35, 73728
  s_nop 0
  buffer_load_dwordx4 v13, s[12:15], s33 offen offset:0 lds
  buffer_load_dwordx4 v14, s[12:15], s33 offen offset:1024 lds
  s_add_u32 s33, s33, 65536
  s_cmp_lg_u32 s3, 3
  s_cbranch_scc1 L_f_nw
  s_lshl_b32 s61, s55, 2
  s_add_u32 s61, s61, s42
  s_lshl_b32 s61, s61, 6
  s_add_u32 s62, s61, 1024
  s_mov_b32 s8, s96
  s_mov_b32 s9, s97
  s_mov_b32 s10, 0x100000
  s_mov_b32 s11, 0x20000
  v_add_u32 v26, s62, v1
  v_lshrrev_b32 v27, 3, v26
  v_lshlrev_b32 v28, 3, v27
  v_sub_u32 v26, v26, v28
  s_mov_b32 s4, 2048
  v_mul_lo_u32 v27, v27, s4
  v_lshl_add_u32 v26, v26, 7, v27
  buffer_load_dword v29, v26, s[8:11], 0 offen
  v_add_u32 v26, 262144, v26
  buffer_load_dword v29, v26, s[8:11], 0 offen
  v_add_u32 v26, 262144, v26
  buffer_load_dword v29, v26, s[8:11], 0 offen
L_f_nw:
  s_cmp_lg_u32 s3, 0
  s_cbranch_scc1 polld_16
  s_mov_b32 s5, 0x80000
poll_15:
  buffer_load_dwordx2 v[40:41], v32, s[28:31], 0 offen sc1
  buffer_load_dwordx2 v[42:43], v33, s[28:31], 0 offen sc1
  buffer_load_dwordx2 v[44:45], v34, s[28:31], 0 offen sc1
  buffer_load_dwordx2 v[46:47], v35, s[28:31], 0 offen sc1
  s_waitcnt vmcnt(0)
  v_subrev_u32 v40, s100, v40
  v_subrev_u32 v40, 1, v40
  v_subrev_u32 v41, s100, v41
  v_subrev_u32 v41, 1, v41
  v_max_u32 v40, v40, v41
  v_subrev_u32 v42, s100, v42
  v_subrev_u32 v42, 1, v42
  v_max_u32 v40, v40, v42
  v_subrev_u32 v43, s100, v43
  v_subrev_u32 v43, 1, v43
  v_max_u32 v40, v40, v43
  v_subrev_u32 v44, s100, v44
  v_subrev_u32 v44, 1, v44
  v_max_u32 v40, v40, v44
  v_subrev_u32 v45, s100, v45
  v_subrev_u32 v45, 1, v45
  v_max_u32 v40, v40, v45
  v_subrev_u32 v46, s100, v46
  v_subrev_u32 v46, 1, v46
  v_max_u32 v40, v40, v46
  v_subrev_u32 v47, s100, v47
  v_subrev_u32 v47, 1, v47
  v_max_u32 v40, v40, v47
  v_cmp_lt_u32 vcc, 7, v40
  s_sub_u32 s5, s5, 1
  s_cbranch_scc1 polld_16
  s_cbranch_vccz polld_16
  s_sleep 1
  s_branch poll_15
polld_16:
  s_barrier
  s_mul_i32 s46, s54, 2097152
  s_lshl_b32 s47, s42, 18
  s_add_u32 s46, s46, s47
  s_add_u32 s8, s86, s46
  s_addc_u32 s9, s87, 0
  s_add_u32 s8, s8, 0x1200000
  s_addc_u32 s9, s9, 0
  s_mov_b32 s10, 0x40000
  s_mov_b32 s11, 0x20000
  s_add_u32 s16, s86, 0x1300000
  s_addc_u32 s17, s87, 0
  s_mov_b32 s18, 0x400
  s_mov_b32 s19, 0x20000
  v_lshlrev_b32 v24, 4, v1
  buffer_load_dwordx4 v[40:43], v24, s[16:19], 0 offen sc1
  s_add_u32 m0, s34, 0
  s_nop 0
  buffer_load_dwordx4 v12, s[8:11], s32 offen offset:0 lds
  buffer_load_dwordx4 v12, s[8:11], s32 offen offset:1024 lds
  buffer_load_dwordx4 v12, s[8:11], s32 offen offset:2048 lds
  buffer_load_dwordx4 v12, s[8:11], s32 offen offset:3072 lds
  s_add_u32 s32, s32, 16384
  s_add_u32 m0, s34, 24576
  s_nop 0
  buffer_load_dwordx4 v12, s[8:11], s32 offen offset:0 lds
  buffer_load_dwordx4 v12, s[8:11], s32 offen offset:1024 lds
  buffer_load_dwordx4 v12, s[8:11], s32 offen offset:2048 lds
  buffer_load_dwordx4 v12, s[8:11], s32 offen offset:3072 lds
  s_add_u32 s32, s32, 16384
  s_add_u32 m0, s34, 49152
  s_nop 0
  buffer_load_dwordx4 v12, s[8:11], s32 offen offset:0 lds
  buffer_load_dwordx4 v12, s[8:11], s32 offen offset:1024 lds
  buffer_load_dwordx4 v12, s[8:11], s32 offen offset:2048 lds
  buffer_load_dwordx4 v12, s[8:11], s32 offen offset:3072 lds
  s_add_u32 s32, s32, 16384
  s_add_u32 m0, s34, 73728
  s_nop 0
  buffer_load_dwordx4 v12, s[8:11], s32 offen offset:0 lds
  buffer_load_dwordx4 v12, s[8:11], s32 offen offset:1024 lds
  buffer_load_dwordx4 v12, s[8:11], s32 offen offset:2048 lds
  buffer_load_dwordx4 v12, s[8:11], s32 offen offset:3072 lds
  s_add_u32 s32, s32, 16384
  v_lshlrev_b32 v24, 8, v1
  v_add_u32 v24, 98304, v24
  s_waitcnt vmcnt(16)
  ds_write_b128 v24, v[40:43]
  s_waitcnt vmcnt(12) lgkmcnt(0)
  s_barrier
  ds_read_b128 a[0:3], v2 offset:0
  ds_read_b64_tr_b16 a[32:33], v4 offset:0
  ds_read_b64_tr_b16 a[34:35], v4 offset:4096
  ds_read_b128 a[4:7], v2 offset:1024
  ds_read_b64_tr_b16 a[36:37], v5 offset:0
  ds_read_b64_tr_b16 a[38:39], v5 offset:4096
  ds_read_b128 a[8:11], v2 offset:2048
  ds_read_b64_tr_b16 a[40:41], v6 offset:0
  ds_read_b64_tr_b16 a[42:43], v6 offset:4096
  ds_read_b128 a[12:15], v2 offset:3072
  ds_read_b64_tr_b16 a[44:45], v7 offset:0
  ds_read_b64_tr_b16 a[46:47], v7 offset:4096
  ds_read_b128 a[16:19], v2 offset:4096
  ds_read_b64_tr_b16 a[52:53], v22 offset:0
  ds_read_b64_tr_b16 a[54:55], v22 offset:4096
  ds_read_b128 a[20:23], v2 offset:5120
  ds_read_b128 a[24:27], v2 offset:6144
  ds_read_b128 a[28:31], v2 offset:7168
  ds_read_b128 a[48:51], v17
  v_add_u32 v17, 1024, v17
  s_waitcnt vmcnt(8) lgkmcnt(0)
  s_barrier
  v_mfma_f32_16x16x32_bf16 v[32:35], a[0:3], a[32:35], 0
  s_add_u32 m0, s34, 0
  v_mfma_f32_16x16x32_bf16 v[36:39], a[4:7], a[32:35], 0
  buffer_load_dwordx4 v12, s[8:11], s32 offen offset:0 lds
  v_mfma_f32_16x16x32_bf16 v[40:43], a[8:11], a[32:35], 0
  ds_read_b128 a[56:59], v2 offset:24576
  v_mfma_f32_16x16x32_bf16 v[44:47], a[12:15], a[32:35], 0
  ds_read_b64_tr_b16 a[88:89], v4 offset:24576
  v_mfma_f32_16x16x32_bf16 v[48:51], a[16:19], a[32:35], 0
  ds_read_b64_tr_b16 a[90:91], v4 offset:28672
  v_mfma_f32_16x16x32_bf16 v[52:55], a[20:23], a[32:35], 0
  ds_read_b128 a[60:63], v2 offset:25600
  v_mfma_f32_16x16x32_bf16 v[56:59], a[24:27], a[32:35], 0
  buffer_load_dwordx4 v12, s[8:11], s32 offen offset:1024 lds
  v_mfma_f32_16x16x32_bf16 v[60:63], a[28:31], a[32:35], 0
  ds_read_b64_tr_b16 a[92:93], v5 offset:24576
  v_mfma_f32_16x16x32_bf16 v[92:95], a[28:31], a[36:39], 0
  ds_read_b64_tr_b16 a[94:95], v5 offset:28672
  v_mfma_f32_16x16x32_bf16 v[88:91], a[24:27], a[36:39], 0
  ds_read_b128 a[64:67], v2 offset:26624
  v_mfma_f32_16x16x32_bf16 v[84:87], a[20:23], a[36:39], 0
  buffer_load_dwordx4 v12, s[8:11], s32 offen offset:2048 lds
  v_mfma_f32_16x16x32_bf16 v[80:83], a[16:19], a[36:39], 0
  ds_read_b64_tr_b16 a[96:97], v6 offset:24576
  v_mfma_f32_16x16x32_bf16 v[76:79], a[12:15], a[36:39], 0
  ds_read_b64_tr_b16 a[98:99], v6 offset:28672
  v_mfma_f32_16x16x32_bf16 v[72:75], a[8:11], a[36:39], 0
  ds_read_b128 a[68:71], v2 offset:27648
  v_mfma_f32_16x16x32_bf16 v[68:71], a[4:7], a[36:39], 0
  buffer_load_dwordx4 v12, s[8:11], s32 offen offset:3072 lds
  s_add_u32 s32, s32, 16384
  v_mfma_f32_16x16x32_bf16 v[64:67], a[0:3], a[36:39], 0
  ds_read_b64_tr_b16 a[100:101], v7 offset:24576
  v_mfma_f32_16x16x32_bf16 v[96:99], a[0:3], a[40:43], 0
  ds_read_b64_tr_b16 a[102:103], v7 offset:28672
  v_mfma_f32_16x16x32_bf16 v[100:103], a[4:7], a[40:43], 0
  ds_read_b128 a[72:75], v2 offset:28672
  v_mfma_f32_16x16x32_bf16 v[104:107], a[8:11], a[40:43], 0
  ds_read_b64_tr_b16 a[108:109], v22 offset:24576
  v_mfma_f32_16x16x32_bf16 v[108:111], a[12:15], a[40:43], 0
  s_add_u32 m0, s35, 0
  v_mfma_f32_16x16x32_bf16 v[112:115], a[16:19], a[40:43], 0
  buffer_load_dwordx4 v13, s[12:15], s33 offen offset:0 lds
  v_mfma_f32_16x16x32_bf16 v[116:119], a[20:23], a[40:43], 0
  ds_read_b64_tr_b16 a[110:111], v22 offset:28672
  v_mfma_f32_16x16x32_bf16 v[120:123], a[24:27], a[40:43], 0
  ds_read_b128 a[76:79], v2 offset:29696
  v_mfma_f32_16x16x32_bf16 v[124:127], a[28:31], a[40:43], 0
  ds_read_b128 a[80:83], v2 offset:30720
  v_mfma_f32_16x16x32_bf16 v[156:159], a[28:31], a[44:47], 0
  buffer_load_dwordx4 v14, s[12:15], s33 offen offset:1024 lds
  s_add_u32 s33, s33, 65536
  v_mfma_f32_16x16x32_bf16 v[152:155], a[24:27], a[44:47], 0
  ds_read_b128 a[84:87], v2 offset:31744
  v_mfma_f32_16x16x32_bf16 v[148:151], a[20:23], a[44:47], 0
  ds_read_b128 a[104:107], v17
  v_mfma_f32_16x16x32_bf16 v[144:147], a[16:19], a[44:47], 0
  v_add_u32 v17, 1024, v17
  v_mfma_f32_16x16x32_bf16 v[140:143], a[12:15], a[44:47], 0
  v_mfma_f32_16x16x32_bf16 v[136:139], a[8:11], a[44:47], 0
  v_mfma_f32_16x16x32_bf16 v[132:135], a[4:7], a[44:47], 0
  v_mfma_f32_16x16x32_bf16 v[128:131], a[0:3], a[44:47], 0
  v_mfma_f32_16x16x32_bf16 v[160:163], a[48:51], a[52:55], 0
  s_waitcnt vmcnt(10) lgkmcnt(0)
  s_barrier
  v_mfma_f32_16x16x32_bf16 v[32:35], a[56:59], a[88:91], v[32:35]
  s_add_u32 m0, s34, 24576
  v_mfma_f32_16x16x32_bf16 v[36:39], a[60:63], a[88:91], v[36:39]
  buffer_load_dwordx4 v12, s[8:11], s32 offen offset:0 lds
  v_mfma_f32_16x16x32_bf16 v[40:43], a[64:67], a[88:91], v[40:43]
  ds_read_b128 a[0:3], v3 offset:0
  v_mfma_f32_16x16x32_bf16 v[44:47], a[68:71], a[88:91], v[44:47]
  ds_read_b64_tr_b16 a[32:33], v8 offset:0
  v_mfma_f32_16x16x32_bf16 v[48:51], a[72:75], a[88:91], v[48:51]
  ds_read_b64_tr_b16 a[34:35], v8 offset:4096
  v_mfma_f32_16x16x32_bf16 v[52:55], a[76:79], a[88:91], v[52:55]
  ds_read_b128 a[4:7], v3 offset:1024
  v_mfma_f32_16x16x32_bf16 v[56:59], a[80:83], a[88:91], v[56:59]
  buffer_load_dwordx4 v12, s[8:11], s32 offen offset:1024 lds
  v_mfma_f32_16x16x32_bf16 v[60:63], a[84:87], a[88:91], v[60:63]
  ds_read_b64_tr_b16 a[36:37], v9 offset:0
  v_mfma_f32_16x16x32_bf16 v[92:95], a[84:87], a[92:95], v[92:95]
  ds_read_b64_tr_b16 a[38:39], v9 offset:4096
  v_mfma_f32_16x16x32_bf16 v[88:91], a[80:83], a[92:95], v[88:91]
  ds_read_b128 a[8:11], v3 offset:2048
  v_mfma_f32_16x16x32_bf16 v[84:87], a[76:79], a[92:95], v[84:87]
  buffer_load_dwordx4 v12, s[8:11], s32 offen offset:2048 lds
  v_mfma_f32_16x16x32_bf16 v[80:83], a[72:75], a[92:95], v[80:83]
  ds_read_b64_tr_b16 a[40:41], v10 offset:0
  v_mfma_f32_16x16x32_bf16 v[76:79], a[68:71], a[92:95], v[76:79]
  ds_read_b64_tr_b16 a[42:43], v10 offset:4096
  v_mfma_f32_16x16x32_bf16 v[72:75], a[64:67], a[92:95], v[72:75]
  ds_read_b128 a[12:15], v3 offset:3072
  v_mfma_f32_16x16x32_bf16 v[68:71], a[60:63], a[92:95], v[68:71]
  buffer_load_dwordx4 v12, s[8:11], s32 offen offset:3072 lds
  s_add_u32 s32, s32, 16384
  v_mfma_f32_16x16x32_bf16 v[64:67], a[56:59], a[92:95], v[64:67]
  ds_read_b64_tr_b16 a[44:45], v11 offset:0
  v_mfma_f32_16x16x32_bf16 v[96:99], a[56:59], a[96:99], v[96:99]
  ds_read_b64_tr_b16 a[46:47], v11 offset:4096
  v_mfma_f32_16x16x32_bf16 v[100:103], a[60:63], a[96:99], v[100:103]
  ds_read_b128 a[16:19], v3 offset:4096
  v_mfma_f32_16x16x32_bf16 v[104:107], a[64:67], a[96:99], v[104:107]
  ds_read_b64_tr_b16 a[52:53], v23 offset:0
  v_mfma_f32_16x16x32_bf16 v[108:111], a[68:71], a[96:99], v[108:111]
  s_add_u32 m0, s35, 24576
  v_mfma_f32_16x16x32_bf16 v[112:115], a[72:75], a[96:99], v[112:115]
  buffer_load_dwordx4 v13, s[12:15], s33 offen offset:0 lds
  v_mfma_f32_16x16x32_bf16 v[116:119], a[76:79], a[96:99], v[116:119]
  ds_read_b64_tr_b16 a[54:55], v23 offset:4096
  v_mfma_f32_16x16x32_bf16 v[120:123], a[80:83], a[96:99], v[120:123]
  ds_read_b128 a[20:23], v3 offset:5120
  v_mfma_f32_16x16x32_bf16 v[124:127], a[84:87], a[96:99], v[124:127]
  ds_read_b128 a[24:27], v3 offset:6144
  v_mfma_f32_16x16x32_bf16 v[156:159], a[84:87], a[100:103], v[156:159]
  buffer_load_dwordx4 v14, s[12:15], s33 offen offset:1024 lds
  s_add_u32 s33, s33, 65536
  v_mfma_f32_16x16x32_bf16 v[152:155], a[80:83], a[100:103], v[152:155]
  ds_read_b128 a[28:31], v3 offset:7168
  v_mfma_f32_16x16x32_bf16 v[148:151], a[76:79], a[100:103], v[148:151]
  ds_read_b128 a[48:51], v17
  v_mfma_f32_16x16x32_bf16 v[144:147], a[72:75], a[100:103], v[144:147]
  v_add_u32 v17, 1024, v17
  v_mfma_f32_16x16x32_bf16 v[140:143], a[68:71], a[100:103], v[140:143]
  v_mfma_f32_16x16x32_bf16 v[136:139], a[64:67], a[100:103], v[136:139]
  v_mfma_f32_16x16x32_bf16 v[132:135], a[60:63], a[100:103], v[132:135]
  v_mfma_f32_16x16x32_bf16 v[128:131], a[56:59], a[100:103], v[128:131]
  v_mfma_f32_16x16x32_bf16 v[160:163], a[104:107], a[108:111], v[160:163]
  s_waitcnt vmcnt(12) lgkmcnt(0)
  s_barrier
  v_mfma_f32_16x16x32_bf16 v[32:35], a[0:3], a[32:35], v[32:35]
  s_add_u32 m0, s34, 49152
  v_mfma_f32_16x16x32_bf16 v[36:39], a[4:7], a[32:35], v[36:39]
  buffer_load_dwordx4 v12, s[8:11], s32 offen offset:0 lds
  v_mfma_f32_16x16x32_bf16 v[40:43], a[8:11], a[32:35], v[40:43]
  ds_read_b128 a[56:59], v3 offset:24576
  v_mfma_f32_16x16x32_bf16 v[44:47], a[12:15], a[32:35], v[44:47]
  ds_read_b64_tr_b16 a[88:89], v8 offset:24576
  v_mfma_f32_16x16x32_bf16 v[48:51], a[16:19], a[32:35], v[48:51]
  ds_read_b64_tr_b16 a[90:91], v8 offset:28672
  v_mfma_f32_16x16x32_bf16 v[52:55], a[20:23], a[32:35], v[52:55]
  ds_read_b128 a[60:63], v3 offset:25600
  v_mfma_f32_16x16x32_bf16 v[56:59], a[24:27], a[32:35], v[56:59]
  buffer_load_dwordx4 v12, s[8:11], s32 offen offset:1024 lds
  v_mfma_f32_16x16x32_bf16 v[60:63], a[28:31], a[32:35], v[60:63]
  ds_read_b64_tr_b16 a[92:93], v9 offset:24576
  v_mfma_f32_16x16x32_bf16 v[92:95], a[28:31], a[36:39], v[92:95]
  ds_read_b64_tr_b16 a[94:95], v9 offset:28672
  v_mfma_f32_16x16x32_bf16 v[88:91], a[24:27], a[36:39], v[88:91]
  ds_read_b128 a[64:67], v3 offset:26624
  v_mfma_f32_16x16x32_bf16 v[84:87], a[20:23], a[36:39], v[84:87]
  buffer_load_dwordx4 v12, s[8:11], s32 offen offset:2048 lds
  v_mfma_f32_16x16x32_bf16 v[80:83], a[16:19], a[36:39], v[80:83]
  ds_read_b64_tr_b16 a[96:97], v10 offset:24576
  v_mfma_f32_16x16x32_bf16 v[76:79], a[12:15], a[36:39], v[76:79]
  ds_read_b64_tr_b16 a[98:99], v10 offset:28672
  v_mfma_f32_16x16x32_bf16 v[72:75], a[8:11], a[36:39], v[72:75]
  ds_read_b128 a[68:71], v3 offset:27648
  v_mfma_f32_16x16x32_bf16 v[68:71], a[4:7], a[36:39], v[68:71]
  buffer_load_dwordx4 v12, s[8:11], s32 offen offset:3072 lds
  s_add_u32 s32, s32, 16384
  v_mfma_f32_16x16x32_bf16 v[64:67], a[0:3], a[36:39], v[64:67]
  ds_read_b64_tr_b16 a[100:101], v11 offset:24576
  v_mfma_f32_16x16x32_bf16 v[96:99], a[0:3], a[40:43], v[96:99]
  ds_read_b64_tr_b16 a[102:103], v11 offset:28672
  v_mfma_f32_16x16x32_bf16 v[100:103], a[4:7], a[40:43], v[100:103]
  ds_read_b128 a[72:75], v3 offset:28672
  v_mfma_f32_16x16x32_bf16 v[104:107], a[8:11], a[40:43], v[104:107]
  ds_read_b64_tr_b16 a[108:109], v23 offset:24576
  v_mfma_f32_16x16x32_bf16 v[108:111], a[12:15], a[40:43], v[108:111]
  s_add_u32 m0, s35, 49152
  v_mfma_f32_16x16x32_bf16 v[112:115], a[16:19], a[40:43], v[112:115]
  buffer_load_dwordx4 v13, s[12:15], s33 offen offset:0 lds
  v_mfma_f32_16x16x32_bf16 v[116:119], a[20:23], a[40:43], v[116:119]
  ds_read_b64_tr_b16 a[110:111], v23 offset:28672
  v_mfma_f32_16x16x32_bf16 v[120:123], a[24:27], a[40:43], v[120:123]
  ds_read_b128 a[76:79], v3 offset:29696
  v_mfma_f32_16x16x32_bf16 v[124:127], a[28:31], a[40:43], v[124:127]
  ds_read_b128 a[80:83], v3 offset:30720
  v_mfma_f32_16x16x32_bf16 v[156:159], a[28:31], a[44:47], v[156:159]
  buffer_load_dwordx4 v14, s[12:15], s33 offen offset:1024 lds
  s_add_u32 s33, s33, 65536
  v_mfma_f32_16x16x32_bf16 v[152:155], a[24:27], a[44:47], v[152:155]
  ds_read_b128 a[84:87], v3 offset:31744
  v_mfma_f32_16x16x32_bf16 v[148:151], a[20:23], a[44:47], v[148:151]
  ds_read_b128 a[104:107], v17
  v_mfma_f32_16x16x32_bf16 v[144:147], a[16:19], a[44:47], v[144:147]
  v_add_u32 v17, 1024, v17
  v_mfma_f32_16x16x32_bf16 v[140:143], a[12:15], a[44:47], v[140:143]
  v_mfma_f32_16x16x32_bf16 v[136:139], a[8:11], a[44:47], v[136:139]
  v_mfma_f32_16x16x32_bf16 v[132:135], a[4:7], a[44:47], v[132:135]
  v_mfma_f32_16x16x32_bf16 v[128:131], a[0:3], a[44:47], v[128:131]
  v_mfma_f32_16x16x32_bf16 v[160:163], a[48:51], a[52:55], v[160:163]
  s_waitcnt vmcnt(12) lgkmcnt(0)
  s_barrier
  v_mfma_f32_16x16x32_bf16 v[32:35], a[56:59], a[88:91], v[32:35]
  s_add_u32 m0, s34, 73728
  v_mfma_f32_16x16x32_bf16 v[36:39], a[60:63], a[88:91], v[36:39]
  buffer_load_dwordx4 v12, s[8:11], s32 offen offset:0 lds
  v_mfma_f32_16x16x32_bf16 v[40:43], a[64:67], a[88:91], v[40:43]
  ds_read_b128 a[0:3], v2 offset:0
  v_mfma_f32_16x16x32_bf16 v[44:47], a[68:71], a[88:91], v[44:47]
  ds_read_b64_tr_b16 a[32:33], v4 offset:0
  v_mfma_f32_16x16x32_bf16 v[48:51], a[72:75], a[88:91], v[48:51]
  ds_read_b64_tr_b16 a[34:35], v4 offset:4096
  v_mfma_f32_16x16x32_bf16 v[52:55], a[76:79], a[88:91], v[52:55]
  ds_read_b128 a[4:7], v2 offset:1024
  v_mfma_f32_16x16x32_bf16 v[56:59], a[80:83], a[88:91], v[56:59]
  buffer_load_dwordx4 v12, s[8:11], s32 offen offset:1024 lds
  v_mfma_f32_16x16x32_bf16 v[60:63], a[84:87], a[88:91], v[60:63]
  ds_read_b64_tr_b16 a[36:37], v5 offset:0
  v_mfma_f32_16x16x32_bf16 v[92:95], a[84:87], a[92:95], v[92:95]
  ds_read_b64_tr_b16 a[38:39], v5 offset:4096
  v_mfma_f32_16x16x32_bf16 v[88:91], a[80:83], a[92:95], v[88:91]
  ds_read_b128 a[8:11], v2 offset:2048
  v_mfma_f32_16x16x32_bf16 v[84:87], a[76:79], a[92:95], v[84:87]
  buffer_load_dwordx4 v12, s[8:11], s32 offen offset:2048 lds
  v_mfma_f32_16x16x32_bf16 v[80:83], a[72:75], a[92:95], v[80:83]
  ds_read_b64_tr_b16 a[40:41], v6 offset:0
  v_mfma_f32_16x16x32_bf16 v[76:79], a[68:71], a[92:95], v[76:79]
  ds_read_b64_tr_b16 a[42:43], v6 offset:4096
  v_mfma_f32_16x16x32_bf16 v[72:75], a[64:67], a[92:95], v[72:75]
  ds_read_b128 a[12:15], v2 offset:3072
  v_mfma_f32_16x16x32_bf16 v[68:71], a[60:63], a[92:95], v[68:71]
  buffer_load_dwordx4 v12, s[8:11], s32 offen offset:3072 lds
  s_add_u32 s32, s32, 16384
  v_mfma_f32_16x16x32_bf16 v[64:67], a[56:59], a[92:95], v[64:67]
  ds_read_b64_tr_b16 a[44:45], v7 offset:0
  v_mfma_f32_16x16x32_bf16 v[96:99], a[56:59], a[96:99], v[96:99]
  ds_read_b64_tr_b16 a[46:47], v7 offset:4096
  v_mfma_f32_16x16x32_bf16 v[100:103], a[60:63], a[96:99], v[100:103]
  ds_read_b128 a[16:19], v2 offset:4096
  v_mfma_f32_16x16x32_bf16 v[104:107], a[64:67], a[96:99], v[104:107]
  ds_read_b64_tr_b16 a[52:53], v22 offset:0
  v_mfma_f32_16x16x32_bf16 v[108:111], a[68:71], a[96:99], v[108:111]
  s_add_u32 m0, s35, 73728
  v_mfma_f32_16x16x32_bf16 v[112:115], a[72:75], a[96:99], v[112:115]
  buffer_load_dwordx4 v13, s[12:15], s33 offen offset:0 lds
  v_mfma_f32_16x16x32_bf16 v[116:119], a[76:79], a[96:99], v[116:119]
  ds_read_b64_tr_b16 a[54:55], v22 offset:4096
  v_mfma_f32_16x16x32_bf16 v[120:123], a[80:83], a[96:99], v[120:123]
  ds_read_b128 a[20:23], v2 offset:5120
  v_mfma_f32_16x16x32_bf16 v[124:127], a[84:87], a[96:99], v[124:127]
  ds_read_b128 a[24:27], v2 offset:6144
  v_mfma_f32_16x16x32_bf16 v[156:159], a[84:87], a[100:103], v[156:159]
  buffer_load_dwordx4 v14, s[12:15], s33 offen offset:1024 lds
  s_add_u32 s33, s33, 65536
  v_mfma_f32_16x16x32_bf16 v[152:155], a[80:83], a[100:103], v[152:155]
  ds_read_b128 a[28:31], v2 offset:7168
  v_mfma_f32_16x16x32_bf16 v[148:151], a[76:79], a[100:103], v[148:151]
  ds_read_b128 a[48:51], v17
  v_mfma_f32_16x16x32_bf16 v[144:147], a[72:75], a[100:103], v[144:147]
  v_add_u32 v17, 1024, v17
  v_mfma_f32_16x16x32_bf16 v[140:143], a[68:71], a[100:103], v[140:143]
  v_mfma_f32_16x16x32_bf16 v[136:139], a[64:67], a[100:103], v[136:139]
  v_mfma_f32_16x16x32_bf16 v[132:135], a[60:63], a[100:103], v[132:135]
  v_mfma_f32_16x16x32_bf16 v[128:131], a[56:59], a[100:103], v[128:131]
  v_mfma_f32_16x16x32_bf16 v[160:163], a[104:107], a[108:111], v[160:163]
  s_mov_b32 s36, 2
L_f1:
  s_waitcnt vmcnt(12) lgkmcnt(0)
  s_barrier
  v_mfma_f32_16x16x32_bf16 v[32:35], a[0:3], a[32:35], v[32:35]
  s_add_u32 m0, s34, 0
  v_mfma_f32_16x16x32_bf16 v[36:39], a[4:7], a[32:35], v[36:39]
  buffer_load_dwordx4 v12, s[8:11], s32 offen offset:0 lds
  v_mfma_f32_16x16x32_bf16 v[40:43], a[8:11], a[32:35], v[40:43]
  ds_read_b128 a[56:59], v2 offset:24576
  v_mfma_f32_16x16x32_bf16 v[44:47], a[12:15], a[32:35], v[44:47]
  ds_read_b64_tr_b16 a[88:89], v4 offset:24576
  v_mfma_f32_16x16x32_bf16 v[48:51], a[16:19], a[32:35], v[48:51]
  ds_read_b64_tr_b16 a[90:91], v4 offset:28672
  v_mfma_f32_16x16x32_bf16 v[52:55], a[20:23], a[32:35], v[52:55]
  ds_read_b128 a[60:63], v2 offset:25600
  v_mfma_f32_16x16x32_bf16 v[56:59], a[24:27], a[32:35], v[56:59]
  buffer_load_dwordx4 v12, s[8:11], s32 offen offset:1024 lds
  v_mfma_f32_16x16x32_bf16 v[60:63], a[28:31], a[32:35], v[60:63]
  ds_read_b64_tr_b16 a[92:93], v5 offset:24576
  v_mfma_f32_16x16x32_bf16 v[92:95], a[28:31], a[36:39], v[92:95]
  ds_read_b64_tr_b16 a[94:95], v5 offset:28672
  v_mfma_f32_16x16x32_bf16 v[88:91], a[24:27], a[36:39], v[88:91]
  ds_read_b128 a[64:67], v2 offset:26624
  v_mfma_f32_16x16x32_bf16 v[84:87], a[20:23], a[36:39], v[84:87]
  buffer_load_dwordx4 v12, s[8:11], s32 offen offset:2048 lds
  v_mfma_f32_16x16x32_bf16 v[80:83], a[16:19], a[36:39], v[80:83]
  ds_read_b64_tr_b16 a[96:97], v6 offset:24576
  v_mfma_f32_16x16x32_bf16 v[76:79], a[12:15], a[36:39], v[76:79]
  ds_read_b64_tr_b16 a[98:99], v6 offset:28672
  v_mfma_f32_16x16x32_bf16 v[72:75], a[8:11], a[36:39], v[72:75]
  ds_read_b128 a[68:71], v2 offset:27648
  v_mfma_f32_16x16x32_bf16 v[68:71], a[4:7], a[36:39], v[68:71]
  buffer_load_dwordx4 v12, s[8:11], s32 offen offset:3072 lds
  s_add_u32 s32, s32, 16384
  v_mfma_f32_16x16x32_bf16 v[64:67], a[0:3], a[36:39], v[64:67]
  ds_read_b64_tr_b16 a[100:101], v7 offset:24576
  v_mfma_f32_16x16x32_bf16 v[96:99], a[0:3], a[40:43], v[96:99]
  ds_read_b64_tr_b16 a[102:103], v7 offset:28672
  v_mfma_f32_16x16x32_bf16 v[100:103], a[4:7], a[40:43], v[100:103]
  ds_read_b128 a[72:75], v2 offset:28672
  v_mfma_f32_16x16x32_bf16 v[104:107], a[8:11], a[40:43], v[104:107]
  ds_read_b64_tr_b16 a[108:109], v22 offset:24576
  v_mfma_f32_16x16x32_bf16 v[108:111], a[12:15], a[40:43], v[108:111]
  s_add_u32 m0, s35, 0
  v_mfma_f32_16x16x32_bf16 v[112:115], a[16:19], a[40:43], v[112:115]
  buffer_load_dwordx4 v13, s[12:15], s33 offen offset:0 lds
  v_mfma_f32_16x16x32_bf16 v[116:119], a[20:23], a[40:43], v[116:119]
  ds_read_b64_tr_b16 a[110:111], v22 offset:28672
  v_mfma_f32_16x16x32_bf16 v[120:123], a[24:27], a[40:43], v[120:123]
  ds_read_b128 a[76:79], v2 offset:29696
  v_mfma_f32_16x16x32_bf16 v[124:127], a[28:31], a[40:43], v[124:127]
  ds_read_b128 a[80:83], v2 offset:30720
  v_mfma_f32_16x16x32_bf16 v[156:159], a[28:31], a[44:47], v[156:159]
  buffer_load_dwordx4 v14, s[12:15], s33 offen offset:1024 lds
  s_add_u32 s33, s33, 65536
  v_mfma_f32_16x16x32_bf16 v[152:155], a[24:27], a[44:47], v[152:155]
  ds_read_b128 a[84:87], v2 offset:31744
  v_mfma_f32_16x16x32_bf16 v[148:151], a[20:23], a[44:47], v[148:151]
  ds_read_b128 a[104:107], v17
  v_mfma_f32_16x16x32_bf16 v[144:147], a[16:19], a[44:47], v[144:147]
  v_add_u32 v17, 1024, v17
  v_mfma_f32_16x16x32_bf16 v[140:143], a[12:15], a[44:47], v[140:143]
  v_mfma_f32_16x16x32_bf16 v[136:139], a[8:11], a[44:47], v[136:139]
  v_mfma_f32_16x16x32_bf16 v[132:135], a[4:7], a[44:47], v[132:135]
  v_mfma_f32_16x16x32_bf16 v[128:131], a[0:3], a[44:47], v[128:131]
  v_mfma_f32_16x16x32_bf16 v[160:163], a[48:51], a[52:55], v[160:163]
  s_waitcnt vmcnt(12) lgkmcnt(0)
  s_barrier
  v_mfma_f32_16x16x32_bf16 v[32:35], a[56:59], a[88:91], v[32:35]
  s_add_u32 m0, s34, 24576
  v_mfma_f32_16x16x32_bf16 v[36:39], a[60:63], a[88:91], v[36:39]
  buffer_load_dwordx4 v12, s[8:11], s32 offen offset:0 lds
  v_mfma_f32_16x16x32_bf16 v[40:43], a[64:67], a[88:91], v[40:43]
  ds_read_b128 a[0:3], v3 offset:0
  v_mfma_f32_16x16x32_bf16 v[44:47], a[68:71], a[88:91], v[44:47]
  ds_read_b64_tr_b16 a[32:33], v8 offset:0
  v_mfma_f32_16x16x32_bf16 v[48:51], a[72:75], a[88:91], v[48:51]
  ds_read_b64_tr_b16 a[34:35], v8 offset:4096
  v_mfma_f32_16x16x32_bf16 v[52:55], a[76:79], a[88:91], v[52:55]
  ds_read_b128 a[4:7], v3 offset:1024
  v_mfma_f32_16x16x32_bf16 v[56:59], a[80:83], a[88:91], v[56:59]
  buffer_load_dwordx4 v12, s[8:11], s32 offen offset:1024 lds
  v_mfma_f32_16x16x32_bf16 v[60:63], a[84:87], a[88:91], v[60:63]
  ds_read_b64_tr_b16 a[36:37], v9 offset:0
  v_mfma_f32_16x16x32_bf16 v[92:95], a[84:87], a[92:95], v[92:95]
  ds_read_b64_tr_b16 a[38:39], v9 offset:4096
  v_mfma_f32_16x16x32_bf16 v[88:91], a[80:83], a[92:95], v[88:91]
  ds_read_b128 a[8:11], v3 offset:2048
  v_mfma_f32_16x16x32_bf16 v[84:87], a[76:79], a[92:95], v[84:87]
  buffer_load_dwordx4 v12, s[8:11], s32 offen offset:2048 lds
  v_mfma_f32_16x16x32_bf16 v[80:83], a[72:75], a[92:95], v[80:83]
  ds_read_b64_tr_b16 a[40:41], v10 offset:0
  v_mfma_f32_16x16x32_bf16 v[76:79], a[68:71], a[92:95], v[76:79]
  ds_read_b64_tr_b16 a[42:43], v10 offset:4096
  v_mfma_f32_16x16x32_bf16 v[72:75], a[64:67], a[92:95], v[72:75]
  ds_read_b128 a[12:15], v3 offset:3072
  v_mfma_f32_16x16x32_bf16 v[68:71], a[60:63], a[92:95], v[68:71]
  buffer_load_dwordx4 v12, s[8:11], s32 offen offset:3072 lds
  s_add_u32 s32, s32, 16384
  v_mfma_f32_16x16x32_bf16 v[64:67], a[56:59], a[92:95], v[64:67]
  ds_read_b64_tr_b16 a[44:45], v11 offset:0
  v_mfma_f32_16x16x32_bf16 v[96:99], a[56:59], a[96:99], v[96:99]
  ds_read_b64_tr_b16 a[46:47], v11 offset:4096
  v_mfma_f32_16x16x32_bf16 v[100:103], a[60:63], a[96:99], v[100:103]
  ds_read_b128 a[16:19], v3 offset:4096
  v_mfma_f32_16x16x32_bf16 v[104:107], a[64:67], a[96:99], v[104:107]
  ds_read_b64_tr_b16 a[52:53], v23 offset:0
  v_mfma_f32_16x16x32_bf16 v[108:111], a[68:71], a[96:99], v[108:111]
  s_add_u32 m0, s35, 24576
  v_mfma_f32_16x16x32_bf16 v[112:115], a[72:75], a[96:99], v[112:115]
  buffer_load_dwordx4 v13, s[12:15], s33 offen offset:0 lds
  v_mfma_f32_16x16x32_bf16 v[116:119], a[76:79], a[96:99], v[116:119]
  ds_read_b64_tr_b16 a[54:55], v23 offset:4096
  v_mfma_f32_16x16x32_bf16 v[120:123], a[80:83], a[96:99], v[120:123]
  ds_read_b128 a[20:23], v3 offset:5120
  v_mfma_f32_16x16x32_bf16 v[124:127], a[84:87], a[96:99], v[124:127]
  ds_read_b128 a[24:27], v3 offset:6144
  v_mfma_f32_16x16x32_bf16 v[156:159], a[84:87], a[100:103], v[156:159]
  buffer_load_dwordx4 v14, s[12:15], s33 offen offset:1024 lds
  s_add_u32 s33, s33, 65536
  v_mfma_f32_16x16x32_bf16 v[152:155], a[80:83], a[100:103], v[152:155]
  ds_read_b128 a[28:31], v3 offset:7168
  v_mfma_f32_16x16x32_bf16 v[148:151], a[76:79], a[100:103], v[148:151]
  ds_read_b128 a[48:51], v17
  v_mfma_f32_16x16x32_bf16 v[144:147], a[72:75], a[100:103], v[144:147]
  v_add_u32 v17, 1024, v17
  v_mfma_f32_16x16x32_bf16 v[140:143], a[68:71], a[100:103], v[140:143]
  v_mfma_f32_16x16x32_bf16 v[136:139], a[64:67], a[100:103], v[136:139]
  v_mfma_f32_16x16x32_bf16 v[132:135], a[60:63], a[100:103], v[132:135]
  v_mfma_f32_16x16x32_bf16 v[128:131], a[56:59], a[100:103], v[128:131]
  v_mfma_f32_16x16x32_bf16 v[160:163], a[104:107], a[108:111], v[160:163]
  s_waitcnt vmcnt(12) lgkmcnt(0)
  s_barrier
  v_mfma_f32_16x16x32_bf16 v[32:35], a[0:3], a[32:35], v[32:35]
  s_add_u32 m0, s34, 49152
  v_mfma_f32_16x16x32_bf16 v[36:39], a[4:7], a[32:35], v[36:39]
  buffer_load_dwordx4 v12, s[8:11], s32 offen offset:0 lds
  v_mfma_f32_16x16x32_bf16 v[40:43], a[8:11], a[32:35], v[40:43]
  ds_read_b128 a[56:59], v3 offset:24576
  v_mfma_f32_16x16x32_bf16 v[44:47], a[12:15], a[32:35], v[44:47]
  ds_read_b64_tr_b16 a[88:89], v8 offset:24576
  v_mfma_f32_16x16x32_bf16 v[48:51], a[16:19], a[32:35], v[48:51]
  ds_read_b64_tr_b16 a[90:91], v8 offset:28672
  v_mfma_f32_16x16x32_bf16 v[52:55], a[20:23], a[32:35], v[52:55]
  ds_read_b128 a[60:63], v3 offset:25600
  v_mfma_f32_16x16x32_bf16 v[56:59], a[24:27], a[32:35], v[56:59]
  buffer_load_dwordx4 v12, s[8:11], s32 offen offset:1024 lds
  v_mfma_f32_16x16x32_bf16 v[60:63], a[28:31], a[32:35], v[60:63]
  ds_read_b64_tr_b16 a[92:93], v9 offset:24576
  v_mfma_f32_16x16x32_bf16 v[92:95], a[28:31], a[36:39], v[92:95]
  ds_read_b64_tr_b16 a[94:95], v9 offset:28672
  v_mfma_f32_16x16x32_bf16 v[88:91], a[24:27], a[36:39], v[88:91]
  ds_read_b128 a[64:67], v3 offset:26624
  v_mfma_f32_16x16x32_bf16 v[84:87], a[20:23], a[36:39], v[84:87]
  buffer_load_dwordx4 v12, s[8:11], s32 offen offset:2048 lds
  v_mfma_f32_16x16x32_bf16 v[80:83], a[16:19], a[36:39], v[80:83]
  ds_read_b64_tr_b16 a[96:97], v10 offset:24576
  v_mfma_f32_16x16x32_bf16 v[76:79], a[12:15], a[36:39], v[76:79]
  ds_read_b64_tr_b16 a[98:99], v10 offset:28672
  v_mfma_f32_16x16x32_bf16 v[72:75], a[8:11], a[36:39], v[72:75]
  ds_read_b128 a[68:71], v3 offset:27648
  v_mfma_f32_16x16x32_bf16 v[68:71], a[4:7], a[36:39], v[68:71]
  buffer_load_dwordx4 v12, s[8:11], s32 offen offset:3072 lds
  s_add_u32 s32, s32, 16384
  v_mfma_f32_16x16x32_bf16 v[64:67], a[0:3], a[36:39], v[64:67]
  ds_read_b64_tr_b16 a[100:101], v11 offset:24576
  v_mfma_f32_16x16x32_bf16 v[96:99], a[0:3], a[40:43], v[96:99]
  ds_read_b64_tr_b16 a[102:103], v11 offset:28672
  v_mfma_f32_16x16x32_bf16 v[100:103], a[4:7], a[40:43], v[100:103]
  ds_read_b128 a[72:75], v3 offset:28672
  v_mfma_f32_16x16x32_bf16 v[104:107], a[8:11], a[40:43], v[104:107]
  ds_read_b64_tr_b16 a[108:109], v23 offset:24576
  v_mfma_f32_16x16x32_bf16 v[108:111], a[12:15], a[40:43], v[108:111]
  s_add_u32 m0, s35, 49152
  v_mfma_f32_16x16x32_bf16 v[112:115], a[16:19], a[40:43], v[112:115]
  buffer_load_dwordx4 v13, s[12:15], s33 offen offset:0 lds
  v_mfma_f32_16x16x32_bf16 v[116:119], a[20:23], a[40:43], v[116:119]
  ds_read_b64_tr_b16 a[110:111], v23 offset:28672
  v_mfma_f32_16x16x32_bf16 v[120:123], a[24:27], a[40:43], v[120:123]
  ds_read_b128 a[76:79], v3 offset:29696
  v_mfma_f32_16x16x32_bf16 v[124:127], a[28:31], a[40:43], v[124:127]
  ds_read_b128 a[80:83], v3 offset:30720
  v_mfma_f32_16x16x32_bf16 v[156:159], a[28:31], a[44:47], v[156:159]
  buffer_load_dwordx4 v14, s[12:15], s33 offen offset:1024 lds
  s_add_u32 s33, s33, 65536
  v_mfma_f32_16x16x32_bf16 v[152:155], a[24:27], a[44:47], v[152:155]
  ds_read_b128 a[84:87], v3 offset:31744
  v_mfma_f32_16x16x32_bf16 v[148:151], a[20:23], a[44:47], v[148:151]
  ds_read_b128 a[104:107], v17
  v_mfma_f32_16x16x32_bf16 v[144:147], a[16:19], a[44:47], v[144:147]
  v_add_u32 v17, 1024, v17
  v_mfma_f32_16x16x32_bf16 v[140:143], a[12:15], a[44:47], v[140:143]
  v_mfma_f32_16x16x32_bf16 v[136:139], a[8:11], a[44:47], v[136:139]
  v_mfma_f32_16x16x32_bf16 v[132:135], a[4:7], a[44:47], v[132:135]
  v_mfma_f32_16x16x32_bf16 v[128:131], a[0:3], a[44:47], v[128:131]
  v_mfma_f32_16x16x32_bf16 v[160:163], a[48:51], a[52:55], v[160:163]
  s_waitcnt vmcnt(12) lgkmcnt(0)
  s_barrier
  v_mfma_f32_16x16x32_bf16 v[32:35], a[56:59], a[88:91], v[32:35]
  s_add_u32 m0, s34, 73728
  v_mfma_f32_16x16x32_bf16 v[36:39], a[60:63], a[88:91], v[36:39]
  buffer_load_dwordx4 v12, s[8:11], s32 offen offset:0 lds
  v_mfma_f32_16x16x32_bf16 v[40:43], a[64:67], a[88:91], v[40:43]
  ds_read_b128 a[0:3], v2 offset:0
  v_mfma_f32_16x16x32_bf16 v[44:47], a[68:71], a[88:91], v[44:47]
  ds_read_b64_tr_b16 a[32:33], v4 offset:0
  v_mfma_f32_16x16x32_bf16 v[48:51], a[72:75], a[88:91], v[48:51]
  ds_read_b64_tr_b16 a[34:35], v4 offset:4096
  v_mfma_f32_16x16x32_bf16 v[52:55], a[76:79], a[88:91], v[52:55]
  ds_read_b128 a[4:7], v2 offset:1024
  v_mfma_f32_16x16x32_bf16 v[56:59], a[80:83], a[88:91], v[56:59]
  buffer_load_dwordx4 v12, s[8:11], s32 offen offset:1024 lds
  v_mfma_f32_16x16x32_bf16 v[60:63], a[84:87], a[88:91], v[60:63]
  ds_read_b64_tr_b16 a[36:37], v5 offset:0
  v_mfma_f32_16x16x32_bf16 v[92:95], a[84:87], a[92:95], v[92:95]
  ds_read_b64_tr_b16 a[38:39], v5 offset:4096
  v_mfma_f32_16x16x32_bf16 v[88:91], a[80:83], a[92:95], v[88:91]
  ds_read_b128 a[8:11], v2 offset:2048
  v_mfma_f32_16x16x32_bf16 v[84:87], a[76:79], a[92:95], v[84:87]
  buffer_load_dwordx4 v12, s[8:11], s32 offen offset:2048 lds
  v_mfma_f32_16x16x32_bf16 v[80:83], a[72:75], a[92:95], v[80:83]
  ds_read_b64_tr_b16 a[40:41], v6 offset:0
  v_mfma_f32_16x16x32_bf16 v[76:79], a[68:71], a[92:95], v[76:79]
  ds_read_b64_tr_b16 a[42:43], v6 offset:4096
  v_mfma_f32_16x16x32_bf16 v[72:75], a[64:67], a[92:95], v[72:75]
  ds_read_b128 a[12:15], v2 offset:3072
  v_mfma_f32_16x16x32_bf16 v[68:71], a[60:63], a[92:95], v[68:71]
  buffer_load_dwordx4 v12, s[8:11], s32 offen offset:3072 lds
  s_add_u32 s32, s32, 16384
  v_mfma_f32_16x16x32_bf16 v[64:67], a[56:59], a[92:95], v[64:67]
  ds_read_b64_tr_b16 a[44:45], v7 offset:0
  v_mfma_f32_16x16x32_bf16 v[96:99], a[56:59], a[96:99], v[96:99]
  ds_read_b64_tr_b16 a[46:47], v7 offset:4096
  v_mfma_f32_16x16x32_bf16 v[100:103], a[60:63], a[96:99], v[100:103]
  ds_read_b128 a[16:19], v2 offset:4096
  v_mfma_f32_16x16x32_bf16 v[104:107], a[64:67], a[96:99], v[104:107]
  ds_read_b64_tr_b16 a[52:53], v22 offset:0
  v_mfma_f32_16x16x32_bf16 v[108:111], a[68:71], a[96:99], v[108:111]
  s_add_u32 m0, s35, 73728
  v_mfma_f32_16x16x32_bf16 v[112:115], a[72:75], a[96:99], v[112:115]
  buffer_load_dwordx4 v13, s[12:15], s33 offen offset:0 lds
  v_mfma_f32_16x16x32_bf16 v[116:119], a[76:79], a[96:99], v[116:119]
  ds_read_b64_tr_b16 a[54:55], v22 offset:4096
  v_mfma_f32_16x16x32_bf16 v[120:123], a[80:83], a[96:99], v[120:123]
  ds_read_b128 a[20:23], v2 offset:5120
  v_mfma_f32_16x16x32_bf16 v[124:127], a[84:87], a[96:99], v[124:127]
  ds_read_b128 a[24:27], v2 offset:6144
  v_mfma_f32_16x16x32_bf16 v[156:159], a[84:87], a[100:103], v[156:159]
  buffer_load_dwordx4 v14, s[12:15], s33 offen offset:1024 lds
  s_add_u32 s33, s33, 65536
  v_mfma_f32_16x16x32_bf16 v[152:155], a[80:83], a[100:103], v[152:155]
  ds_read_b128 a[28:31], v2 offset:7168
  v_mfma_f32_16x16x32_bf16 v[148:151], a[76:79], a[100:103], v[148:151]
  ds_read_b128 a[48:51], v17
  v_mfma_f32_16x16x32_bf16 v[144:147], a[72:75], a[100:103], v[144:147]
  v_add_u32 v17, 1024, v17
  v_mfma_f32_16x16x32_bf16 v[140:143], a[68:71], a[100:103], v[140:143]
  v_mfma_f32_16x16x32_bf16 v[136:139], a[64:67], a[100:103], v[136:139]
  v_mfma_f32_16x16x32_bf16 v[132:135], a[60:63], a[100:103], v[132:135]
  v_mfma_f32_16x16x32_bf16 v[128:131], a[56:59], a[100:103], v[128:131]
  s_sub_u32 s36, s36, 1
  s_cmp_lg_u32 s36, 0
  v_mfma_f32_16x16x32_bf16 v[160:163], a[104:107], a[108:111], v[160:163]
  s_cbranch_scc1 L_f1
  s_lshl_b32 s62, s42, 1
  s_add_u32 s62, s62, s37
  s_mul_i32 s60, s3, 4096
  s_add_u32 s60, s60, 8192
  s_mov_b32 s59, 0
  v_lshrrev_b32 v19, 4, v1
  v_and_b32 v20, 15, v1
  s_mov_b32 s40, 4096
  s_mul_i32 s39, s3, 32768
  v_add_u32 v21, 0, v19
  v_mul_lo_u32 v18, v21, s40
  v_add_u32 v18, s39, v18
  v_lshlrev_b32 v21, 1, v21
  v_xor_b32 v21, v21, v20
  v_lshl_add_u32 v18, v21, 4, v18
  v_add_u32 v24, 4096, v18
  v_add_u32 v26, 2048, v18
  v_add_u32 v21, 4, v19
  v_mul_lo_u32 v18, v21, s40
  v_add_u32 v18, s39, v18
  v_lshlrev_b32 v21, 1, v21
  v_xor_b32 v21, v21, v20
  v_lshl_add_u32 v18, v21, 4, v18
  v_add_u32 v25, 3072, v18
  v_add_u32 v27, 1024, v18
  s_lshl_b32 s59, s42, 20
  s_lshl_b32 s46, s42, 9
  s_sub_u32 s47, 4198400, s46
  s_add_u32 s16, s98, s46
  s_addc_u32 s17, s99, 0
  s_sub_u32 s16, s16, 0x1000
  s_subb_u32 s17, s17, 0
  s_mov_b32 s18, s47
  s_mov_b32 s19, 0x20000
  s_sub_u32 s47, s47, 256
  s_add_u32 s20, s98, s46
  s_addc_u32 s21, s99, 0
  s_sub_u32 s20, s20, 0xf00
  s_subb_u32 s21, s21, 0
  s_mov_b32 s22, s47
  s_mov_b32 s23, 0x20000
  s_cmp_eq_u32 s54, 0
  s_cselect_b32 s47, 0x10000, 0
  s_add_u32 s24, s86, 0x1d00000
  s_addc_u32 s25, s87, 0
  s_mov_b32 s26, s47
  s_mov_b32 s27, 0x20000
  v_lshrrev_b32 v28, 4, v1
  v_lshlrev_b32 v28, 7, v28
  s_lshl_b32 s50, s42, 13
  s_lshl_b32 s51, s37, 12
  s_add_u32 s50, s50, s51
  s_mov_b32 s51, 0x8000
  s_waitcnt vmcnt(12) lgkmcnt(0)
  s_barrier
  v_mfma_f32_16x16x32_bf16 v[32:35], a[0:3], a[32:35], v[32:35]
  s_add_u32 m0, s60, 0
  s_nop 0
  buffer_load_dwordx4 v24, s[16:19], s59 offen offset:0 lds
  v_mfma_f32_16x16x32_bf16 v[36:39], a[4:7], a[32:35], v[36:39]
  ds_read_b128 a[56:59], v2 offset:24576
  v_mfma_f32_16x16x32_bf16 v[40:43], a[8:11], a[32:35], v[40:43]
  ds_read_b64_tr_b16 a[88:89], v4 offset:24576
  v_mfma_f32_16x16x32_bf16 v[44:47], a[12:15], a[32:35], v[44:47]
  buffer_load_dwordx4 v25, s[16:19], s59 offen offset:1024 lds
  v_mfma_f32_16x16x32_bf16 v[48:51], a[16:19], a[32:35], v[48:51]
  ds_read_b64_tr_b16 a[90:91], v4 offset:28672
  ds_read_b128 a[60:63], v2 offset:25600
  v_mfma_f32_16x16x32_bf16 v[52:55], a[20:23], a[32:35], v[52:55]
  buffer_load_dwordx4 v26, s[20:23], s59 offen offset:2048 lds
  v_mfma_f32_16x16x32_bf16 v[56:59], a[24:27], a[32:35], v[56:59]
  ds_read_b64_tr_b16 a[92:93], v5 offset:24576
  v_mfma_f32_16x16x32_bf16 v[60:63], a[28:31], a[32:35], v[60:63]
  buffer_load_dwordx4 v27, s[20:23], s59 offen offset:3072 lds
  s_add_u32 s59, s59, 131072
  v_mfma_f32_16x16x32_bf16 v[92:95], a[28:31], a[36:39], v[92:95]
  ds_read_b64_tr_b16 a[94:95], v5 offset:28672
  v_mfma_f32_16x16x32_bf16 v[88:91], a[24:27], a[36:39], v[88:91]
  ds_read_b128 a[64:67], v2 offset:26624
  buffer_load_dwordx4 v[164:167], v28, s[24:27], s50 offen offset:0 sc1
  v_mfma_f32_16x16x32_bf16 v[84:87], a[20:23], a[36:39], v[84:87]
  ds_read_b64_tr_b16 a[96:97], v6 offset:24576
  v_mfma_f32_16x16x32_bf16 v[80:83], a[16:19], a[36:39], v[80:83]
  buffer_load_dwordx4 v[168:171], v28, s[24:27], s50 offen offset:512 sc1
  v_mfma_f32_16x16x32_bf16 v[76:79], a[12:15], a[36:39], v[76:79]
  ds_read_b64_tr_b16 a[98:99], v6 offset:28672
  v_mfma_f32_16x16x32_bf16 v[72:75], a[8:11], a[36:39], v[72:75]
  ds_read_b128 a[68:71], v2 offset:27648
  v_mfma_f32_16x16x32_bf16 v[68:71], a[4:7], a[36:39], v[68:71]
  buffer_load_dwordx4 v[172:175], v28, s[24:27], s50 offen offset:1024 sc1
  ds_read_b64_tr_b16 a[100:101], v7 offset:24576
  v_mfma_f32_16x16x32_bf16 v[64:67], a[0:3], a[36:39], v[64:67]
  buffer_load_dwordx4 v[176:179], v28, s[24:27], s50 offen offset:1536 sc1
  v_mfma_f32_16x16x32_bf16 v[96:99], a[0:3], a[40:43], v[96:99]
  ds_read_b64_tr_b16 a[102:103], v7 offset:28672
  v_mfma_f32_16x16x32_bf16 v[100:103], a[4:7], a[40:43], v[100:103]
  ds_read_b128 a[72:75], v2 offset:28672
  v_mfma_f32_16x16x32_bf16 v[104:107], a[8:11], a[40:43], v[104:107]
  buffer_load_dwordx4 v[180:183], v28, s[24:27], s50 offen offset:2048 sc1
  ds_read_b64_tr_b16 a[108:109], v22 offset:24576
  v_mfma_f32_16x16x32_bf16 v[108:111], a[12:15], a[40:43], v[108:111]
  buffer_load_dwordx4 v[184:187], v28, s[24:27], s50 offen offset:2560 sc1
  v_mfma_f32_16x16x32_bf16 v[112:115], a[16:19], a[40:43], v[112:115]
  ds_read_b64_tr_b16 a[110:111], v22 offset:28672
  v_mfma_f32_16x16x32_bf16 v[116:119], a[20:23], a[40:43], v[116:119]
  ds_read_b128 a[76:79], v2 offset:29696
  v_mfma_f32_16x16x32_bf16 v[120:123], a[24:27], a[40:43], v[120:123]
  buffer_load_dwordx4 v[188:191], v28, s[24:27], s50 offen offset:3072 sc1
  v_mfma_f32_16x16x32_bf16 v[124:127], a[28:31], a[40:43], v[124:127]
  ds_read_b128 a[80:83], v2 offset:30720
  buffer_load_dwordx4 v[192:195], v28, s[24:27], s50 offen offset:3584 sc1
  v_mfma_f32_16x16x32_bf16 v[156:159], a[28:31], a[44:47], v[156:159]
  ds_read_b128 a[84:87], v2 offset:31744
  v_mfma_f32_16x16x32_bf16 v[152:155], a[24:27], a[44:47], v[152:155]
  ds_read_b128 a[104:107], v17
  v_mfma_f32_16x16x32_bf16 v[148:151], a[20:23], a[44:47], v[148:151]
  buffer_load_dword v196, v28, s[24:27], s51 offen sc1
  v_mfma_f32_16x16x32_bf16 v[144:147], a[16:19], a[44:47], v[144:147]
  v_add_u32 v17, 1024, v17
  v_mfma_f32_16x16x32_bf16 v[140:143], a[12:15], a[44:47], v[140:143]
  v_mfma_f32_16x16x32_bf16 v[136:139], a[8:11], a[44:47], v[136:139]
  v_mfma_f32_16x16x32_bf16 v[132:135], a[4:7], a[44:47], v[132:135]
  v_mfma_f32_16x16x32_bf16 v[128:131], a[0:3], a[44:47], v[128:131]
  v_mfma_f32_16x16x32_bf16 v[160:163], a[48:51], a[52:55], v[160:163]
  s_waitcnt vmcnt(19) lgkmcnt(0)
  s_barrier
  v_mfma_f32_16x16x32_bf16 v[32:35], a[56:59], a[88:91], v[32:35]
  s_add_u32 m0, s60, 24576
  v_mfma_f32_16x16x32_bf16 v[36:39], a[60:63], a[88:91], v[36:39]
  buffer_load_dwordx4 v24, s[16:19], s59 offen offset:0 lds
  v_mfma_f32_16x16x32_bf16 v[40:43], a[64:67], a[88:91], v[40:43]
  ds_read_b128 a[0:3], v3 offset:0
  v_mfma_f32_16x16x32_bf16 v[44:47], a[68:71], a[88:91], v[44:47]
  ds_read_b64_tr_b16 a[32:33], v8 offset:0
  v_mfma_f32_16x16x32_bf16 v[48:51], a[72:75], a[88:91], v[48:51]
  ds_read_b64_tr_b16 a[34:35], v8 offset:4096
  v_mfma_f32_16x16x32_bf16 v[52:55], a[76:79], a[88:91], v[52:55]
  ds_read_b128 a[4:7], v3 offset:1024
  v_mfma_f32_16x16x32_bf16 v[56:59], a[80:83], a[88:91], v[56:59]
  ds_read_b64_tr_b16 a[36:37], v9 offset:0
  v_mfma_f32_16x16x32_bf16 v[60:63], a[84:87], a[88:91], v[60:63]
  buffer_load_dwordx4 v25, s[16:19], s59 offen offset:1024 lds
  v_mfma_f32_16x16x32_bf16 v[92:95], a[84:87], a[92:95], v[92:95]
  ds_read_b64_tr_b16 a[38:39], v9 offset:4096
  v_mfma_f32_16x16x32_bf16 v[88:91], a[80:83], a[92:95], v[88:91]
  v_mfma_f32_16x16x32_bf16 v[84:87], a[76:79], a[92:95], v[84:87]
  ds_read_b128 a[8:11], v3 offset:2048
  v_mfma_f32_16x16x32_bf16 v[80:83], a[72:75], a[92:95], v[80:83]
  ds_read_b64_tr_b16 a[40:41], v10 offset:0
  v_mfma_f32_16x16x32_bf16 v[76:79], a[68:71], a[92:95], v[76:79]
  ds_read_b64_tr_b16 a[42:43], v10 offset:4096
  v_mfma_f32_16x16x32_bf16 v[72:75], a[64:67], a[92:95], v[72:75]
  ds_read_b128 a[12:15], v3 offset:3072
  v_mfma_f32_16x16x32_bf16 v[68:71], a[60:63], a[92:95], v[68:71]
  buffer_load_dwordx4 v26, s[20:23], s59 offen offset:2048 lds
  v_mfma_f32_16x16x32_bf16 v[64:67], a[56:59], a[92:95], v[64:67]
  ds_read_b64_tr_b16 a[44:45], v11 offset:0
  v_mfma_f32_16x16x32_bf16 v[96:99], a[56:59], a[96:99], v[96:99]
  ds_read_b64_tr_b16 a[46:47], v11 offset:4096
  v_mfma_f32_16x16x32_bf16 v[100:103], a[60:63], a[96:99], v[100:103]
  ds_read_b128 a[16:19], v3 offset:4096
  v_mfma_f32_16x16x32_bf16 v[104:107], a[64:67], a[96:99], v[104:107]
  v_mfma_f32_16x16x32_bf16 v[108:111], a[68:71], a[96:99], v[108:111]
  ds_read_b64_tr_b16 a[52:53], v23 offset:0
  v_mfma_f32_16x16x32_bf16 v[112:115], a[72:75], a[96:99], v[112:115]
  ds_read_b64_tr_b16 a[54:55], v23 offset:4096
  v_mfma_f32_16x16x32_bf16 v[116:119], a[76:79], a[96:99], v[116:119]
  buffer_load_dwordx4 v27, s[20:23], s59 offen offset:3072 lds
  s_add_u32 s59, s59, 131072
  v_mfma_f32_16x16x32_bf16 v[120:123], a[80:83], a[96:99], v[120:123]
  ds_read_b128 a[20:23], v3 offset:5120
  v_mfma_f32_16x16x32_bf16 v[124:127], a[84:87], a[96:99], v[124:127]
  ds_read_b128 a[24:27], v3 offset:6144
  v_mfma_f32_16x16x32_bf16 v[156:159], a[84:87], a[100:103], v[156:159]
  ds_read_b128 a[28:31], v3 offset:7168
  v_mfma_f32_16x16x32_bf16 v[152:155], a[80:83], a[100:103], v[152:155]
  ds_read_b128 a[48:51], v17
  v_mfma_f32_16x16x32_bf16 v[148:151], a[76:79], a[100:103], v[148:151]
  v_add_u32 v17, 1024, v17
  v_mfma_f32_16x16x32_bf16 v[144:147], a[72:75], a[100:103], v[144:147]
  v_mfma_f32_16x16x32_bf16 v[140:143], a[68:71], a[100:103], v[140:143]
  v_mfma_f32_16x16x32_bf16 v[136:139], a[64:67], a[100:103], v[136:139]
  v_mfma_f32_16x16x32_bf16 v[132:135], a[60:63], a[100:103], v[132:135]
  v_mfma_f32_16x16x32_bf16 v[128:131], a[56:59], a[100:103], v[128:131]
  v_mfma_f32_16x16x32_bf16 v[160:163], a[104:107], a[108:111], v[160:163]
  s_waitcnt vmcnt(17) lgkmcnt(0)
  s_barrier
  v_mfma_f32_16x16x32_bf16 v[32:35], a[0:3], a[32:35], v[32:35]
  s_add_u32 m0, s60, 49152
  v_mfma_f32_16x16x32_bf16 v[36:39], a[4:7], a[32:35], v[36:39]
  buffer_load_dwordx4 v24, s[16:19], s59 offen offset:0 lds
  v_mfma_f32_16x16x32_bf16 v[40:43], a[8:11], a[32:35], v[40:43]
  ds_read_b128 a[56:59], v3 offset:24576
  v_mfma_f32_16x16x32_bf16 v[44:47], a[12:15], a[32:35], v[44:47]
  ds_read_b64_tr_b16 a[88:89], v8 offset:24576
  v_mfma_f32_16x16x32_bf16 v[48:51], a[16:19], a[32:35], v[48:51]
  ds_read_b64_tr_b16 a[90:91], v8 offset:28672
  v_mfma_f32_16x16x32_bf16 v[52:55], a[20:23], a[32:35], v[52:55]
  ds_read_b128 a[60:63], v3 offset:25600
  v_mfma_f32_16x16x32_bf16 v[56:59], a[24:27], a[32:35], v[56:59]
  ds_read_b64_tr_b16 a[92:93], v9 offset:24576
  v_mfma_f32_16x16x32_bf16 v[60:63], a[28:31], a[32:35], v[60:63]
  buffer_load_dwordx4 v25, s[16:19], s59 offen offset:1024 lds
  v_mfma_f32_16x16x32_bf16 v[92:95], a[28:31], a[36:39], v[92:95]
  ds_read_b64_tr_b16 a[94:95], v9 offset:28672
  v_mfma_f32_16x16x32_bf16 v[88:91], a[24:27], a[36:39], v[88:91]
  v_mfma_f32_16x16x32_bf16 v[84:87], a[20:23], a[36:39], v[84:87]
  ds_read_b128 a[64:67], v3 offset:26624
  v_mfma_f32_16x16x32_bf16 v[80:83], a[16:19], a[36:39], v[80:83]
  ds_read_b64_tr_b16 a[96:97], v10 offset:24576
  v_mfma_f32_16x16x32_bf16 v[76:79], a[12:15], a[36:39], v[76:79]
  ds_read_b64_tr_b16 a[98:99], v10 offset:28672
  v_mfma_f32_16x16x32_bf16 v[72:75], a[8:11], a[36:39], v[72:75]
  ds_read_b128 a[68:71], v3 offset:27648
  v_mfma_f32_16x16x32_bf16 v[68:71], a[4:7], a[36:39], v[68:71]
  buffer_load_dwordx4 v26, s[20:23], s59 offen offset:2048 lds
  v_mfma_f32_16x16x32_bf16 v[64:67], a[0:3], a[36:39], v[64:67]
  ds_read_b64_tr_b16 a[100:101], v11 offset:24576
  v_mfma_f32_16x16x32_bf16 v[96:99], a[0:3], a[40:43], v[96:99]
  ds_read_b64_tr_b16 a[102:103], v11 offset:28672
  v_mfma_f32_16x16x32_bf16 v[100:103], a[4:7], a[40:43], v[100:103]
  ds_read_b128 a[72:75], v3 offset:28672
  v_mfma_f32_16x16x32_bf16 v[104:107], a[8:11], a[40:43], v[104:107]
  v_mfma_f32_16x16x32_bf16 v[108:111], a[12:15], a[40:43], v[108:111]
  ds_read_b64_tr_b16 a[108:109], v23 offset:24576
  v_mfma_f32_16x16x32_bf16 v[112:115], a[16:19], a[40:43], v[112:115]
  ds_read_b64_tr_b16 a[110:111], v23 offset:28672
  v_mfma_f32_16x16x32_bf16 v[116:119], a[20:23], a[40:43], v[116:119]
  buffer_load_dwordx4 v27, s[20:23], s59 offen offset:3072 lds
  s_add_u32 s59, s59, 131072
  v_mfma_f32_16x16x32_bf16 v[120:123], a[24:27], a[40:43], v[120:123]
  ds_read_b128 a[76:79], v3 offset:29696
  v_mfma_f32_16x16x32_bf16 v[124:127], a[28:31], a[40:43], v[124:127]
  ds_read_b128 a[80:83], v3 offset:30720
  v_mfma_f32_16x16x32_bf16 v[156:159], a[28:31], a[44:47], v[156:159]
  ds_read_b128 a[84:87], v3 offset:31744
  v_mfma_f32_16x16x32_bf16 v[152:155], a[24:27], a[44:47], v[152:155]
  ds_read_b128 a[104:107], v17
  v_mfma_f32_16x16x32_bf16 v[148:151], a[20:23], a[44:47], v[148:151]
  v_add_u32 v17, 1024, v17
  v_mfma_f32_16x16x32_bf16 v[144:147], a[16:19], a[44:47], v[144:147]
  v_mfma_f32_16x16x32_bf16 v[140:143], a[12:15], a[44:47], v[140:143]
  v_mfma_f32_16x16x32_bf16 v[136:139], a[8:11], a[44:47], v[136:139]
  v_mfma_f32_16x16x32_bf16 v[132:135], a[4:7], a[44:47], v[132:135]
  v_mfma_f32_16x16x32_bf16 v[128:131], a[0:3], a[44:47], v[128:131]
  v_mfma_f32_16x16x32_bf16 v[160:163], a[48:51], a[52:55], v[160:163]
  s_waitcnt lgkmcnt(0)
  s_barrier
  v_mfma_f32_16x16x32_bf16 v[32:35], a[56:59], a[88:91], v[32:35]
  s_add_u32 m0, s60, 73728
  v_mfma_f32_16x16x32_bf16 v[36:39], a[60:63], a[88:91], v[36:39]
  v_mfma_f32_16x16x32_bf16 v[40:43], a[64:67], a[88:91], v[40:43]
  v_mfma_f32_16x16x32_bf16 v[44:47], a[68:71], a[88:91], v[44:47]
  v_mfma_f32_16x16x32_bf16 v[48:51], a[72:75], a[88:91], v[48:51]
  v_mfma_f32_16x16x32_bf16 v[52:55], a[76:79], a[88:91], v[52:55]
  buffer_load_dwordx4 v24, s[16:19], s59 offen offset:0 lds
  v_mfma_f32_16x16x32_bf16 v[56:59], a[80:83], a[88:91], v[56:59]
  v_mfma_f32_16x16x32_bf16 v[60:63], a[84:87], a[88:91], v[60:63]
  v_mfma_f32_16x16x32_bf16 v[92:95], a[84:87], a[92:95], v[92:95]
  v_mfma_f32_16x16x32_bf16 v[88:91], a[80:83], a[92:95], v[88:91]
  v_mfma_f32_16x16x32_bf16 v[84:87], a[76:79], a[92:95], v[84:87]
  v_mfma_f32_16x16x32_bf16 v[80:83], a[72:75], a[92:95], v[80:83]
  buffer_load_dwordx4 v25, s[16:19], s59 offen offset:1024 lds
  v_mfma_f32_16x16x32_bf16 v[76:79], a[68:71], a[92:95], v[76:79]
  v_mfma_f32_16x16x32_bf16 v[72:75], a[64:67], a[92:95], v[72:75]
  v_mfma_f32_16x16x32_bf16 v[68:71], a[60:63], a[92:95], v[68:71]
  v_mfma_f32_16x16x32_bf16 v[64:67], a[56:59], a[92:95], v[64:67]
  v_mfma_f32_16x16x32_bf16 v[96:99], a[56:59], a[96:99], v[96:99]
  buffer_load_dwordx4 v26, s[20:23], s59 offen offset:2048 lds
  v_mfma_f32_16x16x32_bf16 v[100:103], a[60:63], a[96:99], v[100:103]
  v_mfma_f32_16x16x32_bf16 v[104:107], a[64:67], a[96:99], v[104:107]
  v_mfma_f32_16x16x32_bf16 v[108:111], a[68:71], a[96:99], v[108:111]
  v_mfma_f32_16x16x32_bf16 v[112:115], a[72:75], a[96:99], v[112:115]
  v_mfma_f32_16x16x32_bf16 v[116:119], a[76:79], a[96:99], v[116:119]
  v_mfma_f32_16x16x32_bf16 v[120:123], a[80:83], a[96:99], v[120:123]
  buffer_load_dwordx4 v27, s[20:23], s59 offen offset:3072 lds
  s_add_u32 s59, s59, 131072
  v_mfma_f32_16x16x32_bf16 v[124:127], a[84:87], a[96:99], v[124:127]
  v_mfma_f32_16x16x32_bf16 v[156:159], a[84:87], a[100:103], v[156:159]
  v_mfma_f32_16x16x32_bf16 v[152:155], a[80:83], a[100:103], v[152:155]
  v_mfma_f32_16x16x32_bf16 v[148:151], a[76:79], a[100:103], v[148:151]
  v_mfma_f32_16x16x32_bf16 v[144:147], a[72:75], a[100:103], v[144:147]
  v_mfma_f32_16x16x32_bf16 v[140:143], a[68:71], a[100:103], v[140:143]
  v_mfma_f32_16x16x32_bf16 v[136:139], a[64:67], a[100:103], v[136:139]
  v_mfma_f32_16x16x32_bf16 v[132:135], a[60:63], a[100:103], v[132:135]
  v_mfma_f32_16x16x32_bf16 v[128:131], a[56:59], a[100:103], v[128:131]
  v_mfma_f32_16x16x32_bf16 v[160:163], a[104:107], a[108:111], v[160:163]
  s_waitcnt vmcnt(12)
  v_and_b32 v3, 1, v1
  v_lshlrev_b32 v3, 31, v3
  v_or_b32 v3, 1.0, v3
  s_mul_i32 s46, s54, 1048576
  s_lshl_b32 s47, s55, 18
  s_add_u32 s46, s46, s47
  s_add_u32 s8, s86, s46
  s_addc_u32 s9, s87, 0
  s_add_u32 s8, s8, 0x1500000
  s_addc_u32 s9, s9, 0
  s_mov_b32 s10, 0x40000
  s_mov_b32 s11, 0x20000
  s_lshl_b32 s50, s42, 16
  s_lshl_b32 s51, s37, 15
  s_add_u32 s50, s50, s51
  s_lshl_b32 s51, s38, 12
  s_add_u32 s50, s50, s51
  v_lshlrev_b32 v2, 4, v1
  s_nop 4
  v_fmac_f32 v32, v164, v3
  v_fmac_f32 v33, v165, v3
  v_fmac_f32 v34, v166, v3
  v_fmac_f32 v35, v167, v3
  v_cvt_pk_bf16_f32 v4, v32, v33
  v_cvt_pk_bf16_f32 v5, v34, v35
  v_fmac_f32 v36, v168, v3
  v_fmac_f32 v37, v169, v3
  v_fmac_f32 v38, v170, v3
  v_fmac_f32 v39, v171, v3
  v_cvt_pk_bf16_f32 v6, v36, v37
  v_cvt_pk_bf16_f32 v7, v38, v39
  buffer_store_dwordx4 v[4:7], v2, s[8:11], s50 offen offset:0 sc1
  v_fmac_f32 v64, v164, v3
  v_fmac_f32 v65, v165, v3
  v_fmac_f32 v66, v166, v3
  v_fmac_f32 v67, v167, v3
  v_cvt_pk_bf16_f32 v8, v64, v65
  v_cvt_pk_bf16_f32 v9, v66, v67
  v_fmac_f32 v68, v168, v3
  v_fmac_f32 v69, v169, v3
  v_fmac_f32 v70, v170, v3
  v_fmac_f32 v71, v171, v3
  v_cvt_pk_bf16_f32 v10, v68, v69
  v_cvt_pk_bf16_f32 v11, v70, v71
  buffer_store_dwordx4 v[8:11], v2, s[8:11], s50 offen offset:1024 sc1
  v_fmac_f32 v96, v164, v3
  v_fmac_f32 v97, v165, v3
  v_fmac_f32 v98, v166, v3
  v_fmac_f32 v99, v167, v3
  v_cvt_pk_bf16_f32 v4, v96, v97
  v_cvt_pk_bf16_f32 v5, v98, v99
  v_fmac_f32 v100, v168, v3
  v_fmac_f32 v101, v169, v3
  v_fmac_f32 v102, v170, v3
  v_fmac_f32 v103, v171, v3
  v_cvt_pk_bf16_f32 v6, v100, v101
  v_cvt_pk_bf16_f32 v7, v102, v103
  buffer_store_dwordx4 v[4:7], v2, s[8:11], s50 offen offset:2048 sc1
  v_fmac_f32 v128, v164, v3
  v_fmac_f32 v129, v165, v3
  v_fmac_f32 v130, v166, v3
  v_fmac_f32 v131, v167, v3
  v_cvt_pk_bf16_f32 v8, v128, v129
  v_cvt_pk_bf16_f32 v9, v130, v131
  v_fmac_f32 v132, v168, v3
  v_fmac_f32 v133, v169, v3
  v_fmac_f32 v134, v170, v3
  v_fmac_f32 v135, v171, v3
  v_cvt_pk_bf16_f32 v10, v132, v133
  v_cvt_pk_bf16_f32 v11, v134, v135
  buffer_store_dwordx4 v[8:11], v2, s[8:11], s50 offen offset:3072 sc1
  s_add_u32 s50, s50, 0x2000
  v_fmac_f32 v40, v172, v3
  v_fmac_f32 v41, v173, v3
  v_fmac_f32 v42, v174, v3
  v_fmac_f32 v43, v175, v3
  v_cvt_pk_bf16_f32 v4, v40, v41
  v_cvt_pk_bf16_f32 v5, v42, v43
  v_fmac_f32 v44, v176, v3
  v_fmac_f32 v45, v177, v3
  v_fmac_f32 v46, v178, v3
  v_fmac_f32 v47, v179, v3
  v_cvt_pk_bf16_f32 v6, v44, v45
  v_cvt_pk_bf16_f32 v7, v46, v47
  buffer_store_dwordx4 v[4:7], v2, s[8:11], s50 offen offset:0 sc1
  v_fmac_f32 v72, v172, v3
  v_fmac_f32 v73, v173, v3
  v_fmac_f32 v74, v174, v3
  v_fmac_f32 v75, v175, v3
  v_cvt_pk_bf16_f32 v8, v72, v73
  v_cvt_pk_bf16_f32 v9, v74, v75
  v_fmac_f32 v76, v176, v3
  v_fmac_f32 v77, v177, v3
  v_fmac_f32 v78, v178, v3
  v_fmac_f32 v79, v179, v3
  v_cvt_pk_bf16_f32 v10, v76, v77
  v_cvt_pk_bf16_f32 v11, v78, v79
  buffer_store_dwordx4 v[8:11], v2, s[8:11], s50 offen offset:1024 sc1
  v_fmac_f32 v104, v172, v3
  v_fmac_f32 v105, v173, v3
  v_fmac_f32 v106, v174, v3
  v_fmac_f32 v107, v175, v3
  v_cvt_pk_bf16_f32 v4, v104, v105
  v_cvt_pk_bf16_f32 v5, v106, v107
  v_fmac_f32 v108, v176, v3
  v_fmac_f32 v109, v177, v3
  v_fmac_f32 v110, v178, v3
  v_fmac_f32 v111, v179, v3
  v_cvt_pk_bf16_f32 v6, v108, v109
  v_cvt_pk_bf16_f32 v7, v110, v111
  buffer_store_dwordx4 v[4:7], v2, s[8:11], s50 offen offset:2048 sc1
  v_fmac_f32 v136, v172, v3
  v_fmac_f32 v137, v173, v3
  v_fmac_f32 v138, v174, v3
  v_fmac_f32 v139, v175, v3
  v_cvt_pk_bf16_f32 v8, v136, v137
  v_cvt_pk_bf16_f32 v9, v138, v139
  v_fmac_f32 v140, v176, v3
  v_fmac_f32 v141, v177, v3
  v_fmac_f32 v142, v178, v3
  v_fmac_f32 v143, v179, v3
  v_cvt_pk_bf16_f32 v10, v140, v141
  v_cvt_pk_bf16_f32 v11, v142, v143
  buffer_store_dwordx4 v[8:11], v2, s[8:11], s50 offen offset:3072 sc1
  s_add_u32 s50, s50, 0x2000
  v_fmac_f32 v48, v180, v3
  v_fmac_f32 v49, v181, v3
  v_fmac_f32 v50, v182, v3
  v_fmac_f32 v51, v183, v3
  v_cvt_pk_bf16_f32 v4, v48, v49
  v_cvt_pk_bf16_f32 v5, v50, v51
  v_fmac_f32 v52, v184, v3
  v_fmac_f32 v53, v185, v3
  v_fmac_f32 v54, v186, v3
  v_fmac_f32 v55, v187, v3
  v_cvt_pk_bf16_f32 v6, v52, v53
  v_cvt_pk_bf16_f32 v7, v54, v55
  buffer_store_dwordx4 v[4:7], v2, s[8:11], s50 offen offset:0 sc1
  v_fmac_f32 v80, v180, v3
  v_fmac_f32 v81, v181, v3
  v_fmac_f32 v82, v182, v3
  v_fmac_f32 v83, v183, v3
  v_cvt_pk_bf16_f32 v8, v80, v81
  v_cvt_pk_bf16_f32 v9, v82, v83
  v_fmac_f32 v84, v184, v3
  v_fmac_f32 v85, v185, v3
  v_fmac_f32 v86, v186, v3
  v_fmac_f32 v87, v187, v3
  v_cvt_pk_bf16_f32 v10, v84, v85
  v_cvt_pk_bf16_f32 v11, v86, v87
  buffer_store_dwordx4 v[8:11], v2, s[8:11], s50 offen offset:1024 sc1
  v_fmac_f32 v112, v180, v3
  v_fmac_f32 v113, v181, v3
  v_fmac_f32 v114, v182, v3
  v_fmac_f32 v115, v183, v3
  v_cvt_pk_bf16_f32 v4, v112, v113
  v_cvt_pk_bf16_f32 v5, v114, v115
  v_fmac_f32 v116, v184, v3
  v_fmac_f32 v117, v185, v3
  v_fmac_f32 v118, v186, v3
  v_fmac_f32 v119, v187, v3
  v_cvt_pk_bf16_f32 v6, v116, v117
  v_cvt_pk_bf16_f32 v7, v118, v119
  buffer_store_dwordx4 v[4:7], v2, s[8:11], s50 offen offset:2048 sc1
  v_fmac_f32 v144, v180, v3
  v_fmac_f32 v145, v181, v3
  v_fmac_f32 v146, v182, v3
  v_fmac_f32 v147, v183, v3
  v_cvt_pk_bf16_f32 v8, v144, v145
  v_cvt_pk_bf16_f32 v9, v146, v147
  v_fmac_f32 v148, v184, v3
  v_fmac_f32 v149, v185, v3
  v_fmac_f32 v150, v186, v3
  v_fmac_f32 v151, v187, v3
  v_cvt_pk_bf16_f32 v10, v148, v149
  v_cvt_pk_bf16_f32 v11, v150, v151
  buffer_store_dwordx4 v[8:11], v2, s[8:11], s50 offen offset:3072 sc1
  s_add_u32 s50, s50, 0x2000
  v_fmac_f32 v56, v188, v3
  v_fmac_f32 v57, v189, v3
  v_fmac_f32 v58, v190, v3
  v_fmac_f32 v59, v191, v3
  v_cvt_pk_bf16_f32 v4, v56, v57
  v_cvt_pk_bf16_f32 v5, v58, v59
  v_fmac_f32 v60, v192, v3
  v_fmac_f32 v61, v193, v3
  v_fmac_f32 v62, v194, v3
  v_fmac_f32 v63, v195, v3
  v_cvt_pk_bf16_f32 v6, v60, v61
  v_cvt_pk_bf16_f32 v7, v62, v63
  buffer_store_dwordx4 v[4:7], v2, s[8:11], s50 offen offset:0 sc1
  v_fmac_f32 v88, v188, v3
  v_fmac_f32 v89, v189, v3
  v_fmac_f32 v90, v190, v3
  v_fmac_f32 v91, v191, v3
  v_cvt_pk_bf16_f32 v8, v88, v89
  v_cvt_pk_bf16_f32 v9, v90, v91
  v_fmac_f32 v92, v192, v3
  v_fmac_f32 v93, v193, v3
  v_fmac_f32 v94, v194, v3
  v_fmac_f32 v95, v195, v3
  v_cvt_pk_bf16_f32 v10, v92, v93
  v_cvt_pk_bf16_f32 v11, v94, v95
  buffer_store_dwordx4 v[8:11], v2, s[8:11], s50 offen offset:1024 sc1
  v_fmac_f32 v120, v188, v3
  v_fmac_f32 v121, v189, v3
  v_fmac_f32 v122, v190, v3
  v_fmac_f32 v123, v191, v3
  v_cvt_pk_bf16_f32 v4, v120, v121
  v_cvt_pk_bf16_f32 v5, v122, v123
  v_fmac_f32 v124, v192, v3
  v_fmac_f32 v125, v193, v3
  v_fmac_f32 v126, v194, v3
  v_fmac_f32 v127, v195, v3
  v_cvt_pk_bf16_f32 v6, v124, v125
  v_cvt_pk_bf16_f32 v7, v126, v127
  buffer_store_dwordx4 v[4:7], v2, s[8:11], s50 offen offset:2048 sc1
  v_fmac_f32 v152, v188, v3
  v_fmac_f32 v153, v189, v3
  v_fmac_f32 v154, v190, v3
  v_fmac_f32 v155, v191, v3
  v_cvt_pk_bf16_f32 v8, v152, v153
  v_cvt_pk_bf16_f32 v9, v154, v155
  v_fmac_f32 v156, v192, v3
  v_fmac_f32 v157, v193, v3
  v_fmac_f32 v158, v194, v3
  v_fmac_f32 v159, v195, v3
  v_cvt_pk_bf16_f32 v10, v156, v157
  v_cvt_pk_bf16_f32 v11, v158, v159
  buffer_store_dwordx4 v[8:11], v2, s[8:11], s50 offen offset:3072 sc1
  s_add_u32 s50, s50, 0x2000
  v_and_b32 v2, 15, v1
  v_lshlrev_b32 v2, 2, v2
  s_lshl_b32 s50, s62, 11
  s_lshl_b32 s51, s55, 9
  s_add_u32 s50, s50, s51
  s_lshl_b32 s52, s38, 8
  s_add_u32 s50, s50, s52
  s_add_u32 s50, s50, 40960
  v_pk_add_f32 v[200:201], v[32:33], v[34:35]
  v_pk_add_f32 v[200:201], v[200:201], v[36:37]
  v_pk_add_f32 v[200:201], v[200:201], v[38:39]
  v_pk_add_f32 v[200:201], v[200:201], v[40:41]
  v_pk_add_f32 v[200:201], v[200:201], v[42:43]
  v_pk_add_f32 v[200:201], v[200:201], v[44:45]
  v_pk_add_f32 v[200:201], v[200:201], v[46:47]
  v_pk_add_f32 v[200:201], v[200:201], v[48:49]
  v_pk_add_f32 v[200:201], v[200:201], v[50:51]
  v_pk_add_f32 v[200:201], v[200:201], v[52:53]
  v_pk_add_f32 v[200:201], v[200:201], v[54:55]
  v_pk_add_f32 v[200:201], v[200:201], v[56:57]
  v_pk_add_f32 v[200:201], v[200:201], v[58:59]
  v_pk_add_f32 v[200:201], v[200:201], v[60:61]
  v_pk_add_f32 v[200:201], v[200:201], v[62:63]
  v_sub_f32 v204, v200, v201
  v_mov_b32 v202, v204
  s_nop 1
  v_permlane32_swap_b32 v204, v202
  s_nop 1
  v_add_f32 v204, v204, v202
  v_mov_b32 v202, v204
  s_nop 1
  v_permlane16_swap_b32 v204, v202
  s_nop 1
  v_add_f32 v204, v204, v202
  buffer_store_dword v204, v2, s[24:27], s50 offen offset:0 sc1
  v_pk_add_f32 v[200:201], v[64:65], v[66:67]
  v_pk_add_f32 v[200:201], v[200:201], v[68:69]
  v_pk_add_f32 v[200:201], v[200:201], v[70:71]
  v_pk_add_f32 v[200:201], v[200:201], v[72:73]
  v_pk_add_f32 v[200:201], v[200:201], v[74:75]
  v_pk_add_f32 v[200:201], v[200:201], v[76:77]
  v_pk_add_f32 v[200:201], v[200:201], v[78:79]
  v_pk_add_f32 v[200:201], v[200:201], v[80:81]
  v_pk_add_f32 v[200:201], v[200:201], v[82:83]
  v_pk_add_f32 v[200:201], v[200:201], v[84:85]
  v_pk_add_f32 v[200:201], v[200:201], v[86:87]
  v_pk_add_f32 v[200:201], v[200:201], v[88:89]
  v_pk_add_f32 v[200:201], v[200:201], v[90:91]
  v_pk_add_f32 v[200:201], v[200:201], v[92:93]
  v_pk_add_f32 v[200:201], v[200:201], v[94:95]
  v_sub_f32 v205, v200, v201
  v_mov_b32 v202, v205
  s_nop 1
  v_permlane32_swap_b32 v205, v202
  s_nop 1
  v_add_f32 v205, v205, v202
  v_mov_b32 v202, v205
  s_nop 1
  v_permlane16_swap_b32 v205, v202
  s_nop 1
  v_add_f32 v205, v205, v202
  buffer_store_dword v205, v2, s[24:27], s50 offen offset:64 sc1
  v_pk_add_f32 v[200:201], v[96:97], v[98:99]
  v_pk_add_f32 v[200:201], v[200:201], v[100:101]
  v_pk_add_f32 v[200:201], v[200:201], v[102:103]
  v_pk_add_f32 v[200:201], v[200:201], v[104:105]
  v_pk_add_f32 v[200:201], v[200:201], v[106:107]
  v_pk_add_f32 v[200:201], v[200:201], v[108:109]
  v_pk_add_f32 v[200:201], v[200:201], v[110:111]
  v_pk_add_f32 v[200:201], v[200:201], v[112:113]
  v_pk_add_f32 v[200:201], v[200:201], v[114:115]
  v_pk_add_f32 v[200:201], v[200:201], v[116:117]
  v_pk_add_f32 v[200:201], v[200:201], v[118:119]
  v_pk_add_f32 v[200:201], v[200:201], v[120:121]
  v_pk_add_f32 v[200:201], v[200:201], v[122:123]
  v_pk_add_f32 v[200:201], v[200:201], v[124:125]
  v_pk_add_f32 v[200:201], v[200:201], v[126:127]
  v_sub_f32 v206, v200, v201
  v_mov_b32 v202, v206
  s_nop 1
  v_permlane32_swap_b32 v206, v202
  s_nop 1
  v_add_f32 v206, v206, v202
  v_mov_b32 v202, v206
  s_nop 1
  v_permlane16_swap_b32 v206, v202
  s_nop 1
  v_add_f32 v206, v206, v202
  buffer_store_dword v206, v2, s[24:27], s50 offen offset:128 sc1
  v_pk_add_f32 v[200:201], v[128:129], v[130:131]
  v_pk_add_f32 v[200:201], v[200:201], v[132:133]
  v_pk_add_f32 v[200:201], v[200:201], v[134:135]
  v_pk_add_f32 v[200:201], v[200:201], v[136:137]
  v_pk_add_f32 v[200:201], v[200:201], v[138:139]
  v_pk_add_f32 v[200:201], v[200:201], v[140:141]
  v_pk_add_f32 v[200:201], v[200:201], v[142:143]
  v_pk_add_f32 v[200:201], v[200:201], v[144:145]
  v_pk_add_f32 v[200:201], v[200:201], v[146:147]
  v_pk_add_f32 v[200:201], v[200:201], v[148:149]
  v_pk_add_f32 v[200:201], v[200:201], v[150:151]
  v_pk_add_f32 v[200:201], v[200:201], v[152:153]
  v_pk_add_f32 v[200:201], v[200:201], v[154:155]
  v_pk_add_f32 v[200:201], v[200:201], v[156:157]
  v_pk_add_f32 v[200:201], v[200:201], v[158:159]
  v_sub_f32 v207, v200, v201
  v_mov_b32 v202, v207
  s_nop 1
  v_permlane32_swap_b32 v207, v202
  s_nop 1
  v_add_f32 v207, v207, v202
  v_mov_b32 v202, v207
  s_nop 1
  v_permlane16_swap_b32 v207, v202
  s_nop 1
  v_add_f32 v207, v207, v202
  buffer_store_dword v207, v2, s[24:27], s50 offen offset:192 sc1
  s_cmp_ge_u32 s62, 4
  s_cbranch_scc1 L_f1_noc2
  v_fmac_f32 v160, v196, v3
  s_add_u32 s50, s51, s52
  s_lshl_b32 s52, s62, 6
  s_add_u32 s50, s50, s52
  s_add_u32 s50, s50, 36864
  s_mov_b64 exec, 0xffff
  buffer_store_dword v160, v2, s[24:27], s50 offen sc1
  s_mov_b64 exec, -1
L_f1_noc2:
  s_lshl_b32 s62, s55, 1
  s_add_u32 s62, s62, s37
  v_lshlrev_b32 v18, 4, v1
  s_mul_i32 s39, s37, 4096
  v_add_u32 v2, s39, v18
  v_add_u32 v3, 49152, v2
  s_mul_i32 s34, s3, 2048
  s_mov_b32 s32, 0
  v_add_u32 v12, s34, v18
  v_add_u32 v17, 98304, v18
  v_bfe_u32 v19, v1, 2, 3
  v_lshrrev_b32 v20, 5, v1
  v_mul_u32_u24 v20, 4096, v20
  v_lshl_add_u32 v20, v19, 8, v20
  v_and_b32 v21, 3, v1
  v_lshl_add_u32 v20, v21, 3, v20
  v_add_u32 v20, 8192, v20
  s_lshl_b32 s39, s38, 2
  s_add_u32 s40, s39, 0
  v_xor_b32 v21, s40, v19
  v_lshl_add_u32 v4, v21, 5, v20
  v_add_u32 v8, 49152, v4
  s_add_u32 s40, s39, 1
  v_xor_b32 v21, s40, v19
  v_lshl_add_u32 v5, v21, 5, v20
  v_add_u32 v9, 49152, v5
  s_add_u32 s40, s39, 2
  v_xor_b32 v21, s40, v19
  v_lshl_add_u32 v6, v21, 5, v20
  v_add_u32 v10, 49152, v6
  s_add_u32 s40, s39, 3
  v_xor_b32 v21, s40, v19
  v_lshl_add_u32 v7, v21, 5, v20
  v_add_u32 v11, 49152, v7
  s_and_b32 s40, s62, 3
  s_add_u32 s40, s40, s39
  v_xor_b32 v21, s40, v19
  v_lshl_add_u32 v22, v21, 5, v20
  s_lshr_b32 s40, s62, 2
  s_lshl_b32 s40, s40, 11
  v_add_u32 v22, s40, v22
  v_add_u32 v23, 49152, v22
  s_mov_b32 s101, 0x80000
  s_lshl_b32 s46, s3, 13
  v_lshl_add_u32 v28, v1, 7, s46
  buffer_load_dwordx4 v[164:167], v28, s[24:27], 0 offen offset:16 sc1
  s_lshl_b32 s32, s42, 16
  s_lshl_b32 s47, s42, 13
  v_add_u32 v17, s47, v17
  s_waitcnt vmcnt(0)
  s_barrier
  s_cmp_lg_u32 s3, 0
  s_cbranch_scc1 pub_17
  s_lshl_b32 s4, s43, 7
  s_add_u32 s5, s100, 2
  v_lshl_add_u32 v18, v1, 2, s4
  v_mov_b32 v19, s5
  s_mov_b64 exec, 0xffffffff
  buffer_store_dword v19, v18, s[28:31], 0 offen sc1
  s_mov_b64 exec, -1
pub_17:
  s_add_u32 m0, s34, 0
  s_nop 0
  buffer_load_dwordx4 v12, s[8:11], s32 offen offset:0 lds
  buffer_load_dwordx4 v12, s[8:11], s32 offen offset:1024 lds
  s_add_u32 s32, s32, 8192
  s_add_u32 m0, s34, 24576
  s_nop 0
  buffer_load_dwordx4 v12, s[8:11], s32 offen offset:0 lds
  buffer_load_dwordx4 v12, s[8:11], s32 offen offset:1024 lds
  s_add_u32 s32, s32, 8192
  s_add_u32 m0, s34, 49152
  s_nop 0
  buffer_load_dwordx4 v12, s[8:11], s32 offen offset:0 lds
  buffer_load_dwordx4 v12, s[8:11], s32 offen offset:1024 lds
  s_add_u32 s32, s32, 8192
  s_add_u32 m0, s34, 73728
  s_nop 0
  buffer_load_dwordx4 v12, s[8:11], s32 offen offset:0 lds
  buffer_load_dwordx4 v12, s[8:11], s32 offen offset:1024 lds
  s_add_u32 s32, s32, 8192
  v_lshrrev_b32 v28, 3, v1
  v_lshlrev_b32 v28, 10, v28
  v_and_b32 v29, 3, v1
  v_lshl_add_u32 v28, v29, 8, v28
  v_bfe_u32 v29, v1, 2, 1
  v_lshl_add_u32 v28, v29, 3, v28
  s_add_u32 s46, s46, 98304
  v_add_u32 v28, s46, v28
  v_cvt_pk_bf16_f32 v164, v164, v165
  v_cvt_pk_bf16_f32 v165, v166, v167
  ds_write_b64 v28, v[164:165]
  s_and_b32 s46, s43, 0xfc
  v_and_b32 v28, 3, v1
  v_add_u32 v28, s46, v28
  v_lshlrev_b32 v28, 7, v28
  v_and_b32 v29, 4, v1
  v_add_u32 v28, v28, v29
  s_mov_b32 s63, 0x7fff
  v_mov_b32 v29, 98304
  s_waitcnt vmcnt(6) lgkmcnt(0)
  s_barrier
  ds_read_b128 a[0:3], v2 offset:0
  ds_read_b64_tr_b16 a[16:17], v4 offset:0
  ds_read_b64_tr_b16 a[18:19], v4 offset:8192
  ds_read_b128 a[4:7], v2 offset:1024
  ds_read_b64_tr_b16 a[20:21], v5 offset:0
  ds_read_b64_tr_b16 a[22:23], v5 offset:8192
  ds_read_b128 a[8:11], v2 offset:2048
  ds_read_b64_tr_b16 a[24:25], v6 offset:0
  ds_read_b64_tr_b16 a[26:27], v6 offset:8192
  ds_read_b128 a[12:15], v2 offset:3072
  ds_read_b64_tr_b16 a[28:29], v7 offset:0
  ds_read_b64_tr_b16 a[30:31], v7 offset:8192
  ds_read_b128 a[48:51], v17
  ds_read_b64_tr_b16 a[32:33], v4 offset:2048
  ds_read_b64_tr_b16 a[34:35], v4 offset:10240
  ds_read_b64_tr_b16 a[36:37], v5 offset:2048
  ds_read_b64_tr_b16 a[38:39], v5 offset:10240
  ds_read_b64_tr_b16 a[40:41], v6 offset:2048
  ds_read_b64_tr_b16 a[42:43], v6 offset:10240
  ds_read_b64_tr_b16 a[44:45], v7 offset:2048
  ds_read_b64_tr_b16 a[46:47], v7 offset:10240
  ds_read_b64_tr_b16 a[52:53], v22 offset:0
  ds_read_b64_tr_b16 a[54:55], v22 offset:8192
  v_add_u32 v17, 1024, v17
  v_and_or_b32 v17, v17, s63, v29
  s_waitcnt vmcnt(4) lgkmcnt(0)
  s_barrier
  v_mfma_f32_16x16x32_bf16 v[32:35], a[0:3], a[16:19], 0
  s_add_u32 m0, s34, 0
  s_nop 0
  buffer_load_dwordx4 v12, s[8:11], s32 offen offset:0 lds
  v_mfma_f32_16x16x32_bf16 v[36:39], a[4:7], a[16:19], 0
  ds_read_b128 a[56:59], v2 offset:24576
  v_mfma_f32_16x16x32_bf16 v[40:43], a[8:11], a[16:19], 0
  ds_read_b64_tr_b16 a[72:73], v4 offset:24576
  v_mfma_f32_16x16x32_bf16 v[44:47], a[12:15], a[16:19], 0
  ds_read_b64_tr_b16 a[74:75], v4 offset:32768
  v_mfma_f32_16x16x32_bf16 v[60:63], a[12:15], a[20:23], 0
  ds_read_b128 a[60:63], v2 offset:25600
  v_mfma_f32_16x16x32_bf16 v[56:59], a[8:11], a[20:23], 0
  buffer_load_dwordx4 v12, s[8:11], s32 offen offset:1024 lds
  s_add_u32 s32, s32, 8192
  v_mfma_f32_16x16x32_bf16 v[52:55], a[4:7], a[20:23], 0
  ds_read_b64_tr_b16 a[76:77], v5 offset:24576
  v_mfma_f32_16x16x32_bf16 v[48:51], a[0:3], a[20:23], 0
  ds_read_b64_tr_b16 a[78:79], v5 offset:32768
  ds_read_b128 a[64:67], v2 offset:26624
  v_mfma_f32_16x16x32_bf16 v[64:67], a[0:3], a[24:27], 0
  ds_read_b64_tr_b16 a[80:81], v6 offset:24576
  v_mfma_f32_16x16x32_bf16 v[68:71], a[4:7], a[24:27], 0
  s_add_u32 m0, s60, 0
  v_mfma_f32_16x16x32_bf16 v[72:75], a[8:11], a[24:27], 0
  buffer_load_dwordx4 v24, s[16:19], s59 offen offset:0 lds
  v_mfma_f32_16x16x32_bf16 v[76:79], a[12:15], a[24:27], 0
  ds_read_b64_tr_b16 a[82:83], v6 offset:32768
  v_mfma_f32_16x16x32_bf16 v[92:95], a[12:15], a[28:31], 0
  ds_read_b128 a[68:71], v2 offset:27648
  v_mfma_f32_16x16x32_bf16 v[88:91], a[8:11], a[28:31], 0
  ds_read_b64_tr_b16 a[84:85], v7 offset:24576
  v_mfma_f32_16x16x32_bf16 v[84:87], a[4:7], a[28:31], 0
  ds_read_b64_tr_b16 a[86:87], v7 offset:32768
  buffer_load_dwordx4 v25, s[16:19], s59 offen offset:1024 lds
  v_mfma_f32_16x16x32_bf16 v[80:83], a[0:3], a[28:31], 0
  ds_read_b128 a[104:107], v17
  v_mfma_f32_16x16x32_bf16 v[96:99], a[0:3], a[32:35], 0
  ds_read_b64_tr_b16 a[88:89], v4 offset:26624
  v_mfma_f32_16x16x32_bf16 v[100:103], a[4:7], a[32:35], 0
  ds_read_b64_tr_b16 a[90:91], v4 offset:34816
  v_mfma_f32_16x16x32_bf16 v[104:107], a[8:11], a[32:35], 0
  ds_read_b64_tr_b16 a[92:93], v5 offset:26624
  v_mfma_f32_16x16x32_bf16 v[108:111], a[12:15], a[32:35], 0
  buffer_load_dwordx4 v26, s[20:23], s59 offen offset:2048 lds
  v_mfma_f32_16x16x32_bf16 v[124:127], a[12:15], a[36:39], 0
  ds_read_b64_tr_b16 a[94:95], v5 offset:34816
  v_mfma_f32_16x16x32_bf16 v[120:123], a[8:11], a[36:39], 0
  ds_read_b64_tr_b16 a[96:97], v6 offset:26624
  ds_read_b64_tr_b16 a[98:99], v6 offset:34816
  v_mfma_f32_16x16x32_bf16 v[116:119], a[4:7], a[36:39], 0
  ds_read_b64_tr_b16 a[100:101], v7 offset:26624
  v_mfma_f32_16x16x32_bf16 v[112:115], a[0:3], a[36:39], 0
  buffer_load_dwordx4 v27, s[20:23], s59 offen offset:3072 lds
  s_add_u32 s59, s59, 131072
  v_mfma_f32_16x16x32_bf16 v[128:131], a[0:3], a[40:43], 0
  ds_read_b64_tr_b16 a[102:103], v7 offset:34816
  v_mfma_f32_16x16x32_bf16 v[132:135], a[4:7], a[40:43], 0
  ds_read_b64_tr_b16 a[108:109], v22 offset:24576
  v_mfma_f32_16x16x32_bf16 v[136:139], a[8:11], a[40:43], 0
  ds_read_b64_tr_b16 a[110:111], v22 offset:32768
  v_mfma_f32_16x16x32_bf16 v[140:143], a[12:15], a[40:43], 0
  v_add_u32 v17, 1024, v17
  v_and_or_b32 v17, v17, s63, v29
  v_mfma_f32_16x16x32_bf16 v[156:159], a[12:15], a[44:47], 0
  v_mfma_f32_16x16x32_bf16 v[152:155], a[8:11], a[44:47], 0
  v_mfma_f32_16x16x32_bf16 v[148:151], a[4:7], a[44:47], 0
  v_mfma_f32_16x16x32_bf16 v[144:147], a[0:3], a[44:47], 0
  v_mfma_f32_16x16x32_bf16 v[160:163], a[48:51], a[52:55], 0
  s_waitcnt vmcnt(8) lgkmcnt(0)
  s_barrier
  v_mfma_f32_16x16x32_bf16 v[32:35], a[56:59], a[72:75], v[32:35]
  s_add_u32 m0, s34, 24576
  s_nop 0
  buffer_load_dwordx4 v12, s[8:11], s32 offen offset:0 lds
  v_mfma_f32_16x16x32_bf16 v[36:39], a[60:63], a[72:75], v[36:39]
  ds_read_b128 a[0:3], v3 offset:0
  v_mfma_f32_16x16x32_bf16 v[40:43], a[64:67], a[72:75], v[40:43]
  ds_read_b64_tr_b16 a[16:17], v8 offset:0
  v_mfma_f32_16x16x32_bf16 v[44:47], a[68:71], a[72:75], v[44:47]
  ds_read_b64_tr_b16 a[18:19], v8 offset:8192
  v_mfma_f32_16x16x32_bf16 v[60:63], a[68:71], a[76:79], v[60:63]
  ds_read_b128 a[4:7], v3 offset:1024
  v_mfma_f32_16x16x32_bf16 v[56:59], a[64:67], a[76:79], v[56:59]
  buffer_load_dwordx4 v12, s[8:11], s32 offen offset:1024 lds
  s_add_u32 s32, s32, 8192
  ds_read_b64_tr_b16 a[20:21], v9 offset:0
  v_mfma_f32_16x16x32_bf16 v[52:55], a[60:63], a[76:79], v[52:55]
  ds_read_b64_tr_b16 a[22:23], v9 offset:8192
  v_mfma_f32_16x16x32_bf16 v[48:51], a[56:59], a[76:79], v[48:51]
  ds_read_b128 a[8:11], v3 offset:2048
  v_mfma_f32_16x16x32_bf16 v[64:67], a[56:59], a[80:83], v[64:67]
  s_add_u32 m0, s60, 24576
  v_mfma_f32_16x16x32_bf16 v[68:71], a[60:63], a[80:83], v[68:71]
  buffer_load_dwordx4 v24, s[16:19], s59 offen offset:0 lds
  v_mfma_f32_16x16x32_bf16 v[72:75], a[64:67], a[80:83], v[72:75]
  ds_read_b64_tr_b16 a[24:25], v10 offset:0
  v_mfma_f32_16x16x32_bf16 v[76:79], a[68:71], a[80:83], v[76:79]
  ds_read_b64_tr_b16 a[26:27], v10 offset:8192
  ds_read_b128 a[12:15], v3 offset:3072
  v_mfma_f32_16x16x32_bf16 v[92:95], a[68:71], a[84:87], v[92:95]
  ds_read_b64_tr_b16 a[28:29], v11 offset:0
  v_mfma_f32_16x16x32_bf16 v[88:91], a[64:67], a[84:87], v[88:91]
  buffer_load_dwordx4 v25, s[16:19], s59 offen offset:1024 lds
  v_mfma_f32_16x16x32_bf16 v[84:87], a[60:63], a[84:87], v[84:87]
  ds_read_b64_tr_b16 a[30:31], v11 offset:8192
  v_mfma_f32_16x16x32_bf16 v[80:83], a[56:59], a[84:87], v[80:83]
  ds_read_b128 a[48:51], v17
  v_mfma_f32_16x16x32_bf16 v[96:99], a[56:59], a[88:91], v[96:99]
  ds_read_b64_tr_b16 a[32:33], v8 offset:2048
  buffer_load_dwordx4 v26, s[20:23], s59 offen offset:2048 lds
  v_mfma_f32_16x16x32_bf16 v[100:103], a[60:63], a[88:91], v[100:103]
  ds_read_b64_tr_b16 a[34:35], v8 offset:10240
  v_mfma_f32_16x16x32_bf16 v[104:107], a[64:67], a[88:91], v[104:107]
  ds_read_b64_tr_b16 a[36:37], v9 offset:2048
  v_mfma_f32_16x16x32_bf16 v[108:111], a[68:71], a[88:91], v[108:111]
  ds_read_b64_tr_b16 a[38:39], v9 offset:10240
  v_mfma_f32_16x16x32_bf16 v[124:127], a[68:71], a[92:95], v[124:127]
  ds_read_b64_tr_b16 a[40:41], v10 offset:2048
  v_mfma_f32_16x16x32_bf16 v[120:123], a[64:67], a[92:95], v[120:123]
  buffer_load_dwordx4 v27, s[20:23], s59 offen offset:3072 lds
  s_add_u32 s59, s59, 131072
  v_mfma_f32_16x16x32_bf16 v[116:119], a[60:63], a[92:95], v[116:119]
  ds_read_b64_tr_b16 a[42:43], v10 offset:10240
  ds_read_b64_tr_b16 a[44:45], v11 offset:2048
  v_mfma_f32_16x16x32_bf16 v[112:115], a[56:59], a[92:95], v[112:115]
  ds_read_b64_tr_b16 a[46:47], v11 offset:10240
  v_mfma_f32_16x16x32_bf16 v[128:131], a[56:59], a[96:99], v[128:131]
  buffer_load_dword v30, v28, s[28:31], 0 offen sc1
  v_mfma_f32_16x16x32_bf16 v[132:135], a[60:63], a[96:99], v[132:135]
  ds_read_b64_tr_b16 a[52:53], v23 offset:0
  v_mfma_f32_16x16x32_bf16 v[136:139], a[64:67], a[96:99], v[136:139]
  ds_read_b64_tr_b16 a[54:55], v23 offset:8192
  v_mfma_f32_16x16x32_bf16 v[140:143], a[68:71], a[96:99], v[140:143]
  v_add_u32 v17, 1024, v17
  v_and_or_b32 v17, v17, s63, v29
  v_mfma_f32_16x16x32_bf16 v[156:159], a[68:71], a[100:103], v[156:159]
  v_mfma_f32_16x16x32_bf16 v[152:155], a[64:67], a[100:103], v[152:155]
  v_mfma_f32_16x16x32_bf16 v[148:151], a[60:63], a[100:103], v[148:151]
  v_mfma_f32_16x16x32_bf16 v[144:147], a[56:59], a[100:103], v[144:147]
  v_mfma_f32_16x16x32_bf16 v[160:163], a[104:107], a[108:111], v[160:163]
  s_waitcnt vmcnt(12) lgkmcnt(0)
  s_barrier
  v_mfma_f32_16x16x32_bf16 v[32:35], a[0:3], a[16:19], v[32:35]
  s_add_u32 m0, s34, 49152
  s_nop 0
  buffer_load_dwordx4 v12, s[8:11], s32 offen offset:0 lds
  v_mfma_f32_16x16x32_bf16 v[36:39], a[4:7], a[16:19], v[36:39]
  ds_read_b128 a[56:59], v3 offset:24576
  v_mfma_f32_16x16x32_bf16 v[40:43], a[8:11], a[16:19], v[40:43]
  ds_read_b64_tr_b16 a[72:73], v8 offset:24576
  v_mfma_f32_16x16x32_bf16 v[44:47], a[12:15], a[16:19], v[44:47]
  ds_read_b64_tr_b16 a[74:75], v8 offset:32768
  v_mfma_f32_16x16x32_bf16 v[60:63], a[12:15], a[20:23], v[60:63]
  ds_read_b128 a[60:63], v3 offset:25600
  v_mfma_f32_16x16x32_bf16 v[56:59], a[8:11], a[20:23], v[56:59]
  buffer_load_dwordx4 v12, s[8:11], s32 offen offset:1024 lds
  s_add_u32 s32, s32, 8192
  v_mfma_f32_16x16x32_bf16 v[52:55], a[4:7], a[20:23], v[52:55]
  ds_read_b64_tr_b16 a[76:77], v9 offset:24576
  v_mfma_f32_16x16x32_bf16 v[48:51], a[0:3], a[20:23], v[48:51]
  ds_read_b64_tr_b16 a[78:79], v9 offset:32768
  ds_read_b128 a[64:67], v3 offset:26624
  v_mfma_f32_16x16x32_bf16 v[64:67], a[0:3], a[24:27], v[64:67]
  ds_read_b64_tr_b16 a[80:81], v10 offset:24576
  v_mfma_f32_16x16x32_bf16 v[68:71], a[4:7], a[24:27], v[68:71]
  s_add_u32 m0, s60, 49152
  v_mfma_f32_16x16x32_bf16 v[72:75], a[8:11], a[24:27], v[72:75]
  buffer_load_dwordx4 v24, s[16:19], s59 offen offset:0 lds
  v_mfma_f32_16x16x32_bf16 v[76:79], a[12:15], a[24:27], v[76:79]
  ds_read_b64_tr_b16 a[82:83], v10 offset:32768
  v_mfma_f32_16x16x32_bf16 v[92:95], a[12:15], a[28:31], v[92:95]
  ds_read_b128 a[68:71], v3 offset:27648
  v_mfma_f32_16x16x32_bf16 v[88:91], a[8:11], a[28:31], v[88:91]
  ds_read_b64_tr_b16 a[84:85], v11 offset:24576
  v_mfma_f32_16x16x32_bf16 v[84:87], a[4:7], a[28:31], v[84:87]
  ds_read_b64_tr_b16 a[86:87], v11 offset:32768
  buffer_load_dwordx4 v25, s[16:19], s59 offen offset:1024 lds
  v_mfma_f32_16x16x32_bf16 v[80:83], a[0:3], a[28:31], v[80:83]
  ds_read_b128 a[104:107], v17
  v_mfma_f32_16x16x32_bf16 v[96:99], a[0:3], a[32:35], v[96:99]
  ds_read_b64_tr_b16 a[88:89], v8 offset:26624
  v_mfma_f32_16x16x32_bf16 v[100:103], a[4:7], a[32:35], v[100:103]
  ds_read_b64_tr_b16 a[90:91], v8 offset:34816
  v_mfma_f32_16x16x32_bf16 v[104:107], a[8:11], a[32:35], v[104:107]
  ds_read_b64_tr_b16 a[92:93], v9 offset:26624
  v_mfma_f32_16x16x32_bf16 v[108:111], a[12:15], a[32:35], v[108:111]
  buffer_load_dwordx4 v26, s[20:23], s59 offen offset:2048 lds
  v_mfma_f32_16x16x32_bf16 v[124:127], a[12:15], a[36:39], v[124:127]
  ds_read_b64_tr_b16 a[94:95], v9 offset:34816
  v_mfma_f32_16x16x32_bf16 v[120:123], a[8:11], a[36:39], v[120:123]
  ds_read_b64_tr_b16 a[96:97], v10 offset:26624
  ds_read_b64_tr_b16 a[98:99], v10 offset:34816
  v_mfma_f32_16x16x32_bf16 v[116:119], a[4:7], a[36:39], v[116:119]
  ds_read_b64_tr_b16 a[100:101], v11 offset:26624
  v_mfma_f32_16x16x32_bf16 v[112:115], a[0:3], a[36:39], v[112:115]
  buffer_load_dwordx4 v27, s[20:23], s59 offen offset:3072 lds
  s_add_u32 s59, s59, 131072
  v_mfma_f32_16x16x32_bf16 v[128:131], a[0:3], a[40:43], v[128:131]
  ds_read_b64_tr_b16 a[102:103], v11 offset:34816
  v_mfma_f32_16x16x32_bf16 v[132:135], a[4:7], a[40:43], v[132:135]
  ds_read_b64_tr_b16 a[108:109], v23 offset:24576
  v_mfma_f32_16x16x32_bf16 v[136:139], a[8:11], a[40:43], v[136:139]
  ds_read_b64_tr_b16 a[110:111], v23 offset:32768
  v_mfma_f32_16x16x32_bf16 v[140:143], a[12:15], a[40:43], v[140:143]
  v_add_u32 v17, 1024, v17
  v_and_or_b32 v17, v17, s63, v29
  v_mfma_f32_16x16x32_bf16 v[156:159], a[12:15], a[44:47], v[156:159]
  v_mfma_f32_16x16x32_bf16 v[152:155], a[8:11], a[44:47], v[152:155]
  v_mfma_f32_16x16x32_bf16 v[148:151], a[4:7], a[44:47], v[148:151]
  v_mfma_f32_16x16x32_bf16 v[144:147], a[0:3], a[44:47], v[144:147]
  v_mfma_f32_16x16x32_bf16 v[160:163], a[48:51], a[52:55], v[160:163]
  s_waitcnt vmcnt(12) lgkmcnt(0)
  s_barrier
  v_mfma_f32_16x16x32_bf16 v[32:35], a[56:59], a[72:75], v[32:35]
  s_add_u32 m0, s34, 73728
  s_nop 0
  buffer_load_dwordx4 v12, s[8:11], s32 offen offset:0 lds
  v_mfma_f32_16x16x32_bf16 v[36:39], a[60:63], a[72:75], v[36:39]
  ds_read_b128 a[0:3], v2 offset:0
  v_mfma_f32_16x16x32_bf16 v[40:43], a[64:67], a[72:75], v[40:43]
  ds_read_b64_tr_b16 a[16:17], v4 offset:0
  v_mfma_f32_16x16x32_bf16 v[44:47], a[68:71], a[72:75], v[44:47]
  ds_read_b64_tr_b16 a[18:19], v4 offset:8192
  v_mfma_f32_16x16x32_bf16 v[60:63], a[68:71], a[76:79], v[60:63]
  ds_read_b128 a[4:7], v2 offset:1024
  v_mfma_f32_16x16x32_bf16 v[56:59], a[64:67], a[76:79], v[56:59]
  buffer_load_dwordx4 v12, s[8:11], s32 offen offset:1024 lds
  s_add_u32 s32, s32, 8192
  v_mfma_f32_16x16x32_bf16 v[52:55], a[60:63], a[76:79], v[52:55]
  ds_read_b64_tr_b16 a[20:21], v5 offset:0
  v_mfma_f32_16x16x32_bf16 v[48:51], a[56:59], a[76:79], v[48:51]
  ds_read_b64_tr_b16 a[22:23], v5 offset:8192
  ds_read_b128 a[8:11], v2 offset:2048
  v_mfma_f32_16x16x32_bf16 v[64:67], a[56:59], a[80:83], v[64:67]
  ds_read_b64_tr_b16 a[24:25], v6 offset:0
  v_mfma_f32_16x16x32_bf16 v[68:71], a[60:63], a[80:83], v[68:71]
  s_add_u32 m0, s60, 73728
  v_mfma_f32_16x16x32_bf16 v[72:75], a[64:67], a[80:83], v[72:75]
  buffer_load_dwordx4 v24, s[16:19], s59 offen offset:0 lds
  v_mfma_f32_16x16x32_bf16 v[76:79], a[68:71], a[80:83], v[76:79]
  ds_read_b64_tr_b16 a[26:27], v6 offset:8192
  v_mfma_f32_16x16x32_bf16 v[92:95], a[68:71], a[84:87], v[92:95]
  ds_read_b128 a[12:15], v2 offset:3072
  v_mfma_f32_16x16x32_bf16 v[88:91], a[64:67], a[84:87], v[88:91]
  ds_read_b64_tr_b16 a[28:29], v7 offset:0
  v_mfma_f32_16x16x32_bf16 v[84:87], a[60:63], a[84:87], v[84:87]
  ds_read_b64_tr_b16 a[30:31], v7 offset:8192
  buffer_load_dwordx4 v25, s[16:19], s59 offen offset:1024 lds
  v_mfma_f32_16x16x32_bf16 v[80:83], a[56:59], a[84:87], v[80:83]
  ds_read_b128 a[48:51], v17
  v_mfma_f32_16x16x32_bf16 v[96:99], a[56:59], a[88:91], v[96:99]
  ds_read_b64_tr_b16 a[32:33], v4 offset:2048
  v_mfma_f32_16x16x32_bf16 v[100:103], a[60:63], a[88:91], v[100:103]
  ds_read_b64_tr_b16 a[34:35], v4 offset:10240
  v_mfma_f32_16x16x32_bf16 v[104:107], a[64:67], a[88:91], v[104:107]
  ds_read_b64_tr_b16 a[36:37], v5 offset:2048
  v_mfma_f32_16x16x32_bf16 v[108:111], a[68:71], a[88:91], v[108:111]
  buffer_load_dwordx4 v26, s[20:23], s59 offen offset:2048 lds
  v_mfma_f32_16x16x32_bf16 v[124:127], a[68:71], a[92:95], v[124:127]
  ds_read_b64_tr_b16 a[38:39], v5 offset:10240
  v_mfma_f32_16x16x32_bf16 v[120:123], a[64:67], a[92:95], v[120:123]
  ds_read_b64_tr_b16 a[40:41], v6 offset:2048
  ds_read_b64_tr_b16 a[42:43], v6 offset:10240
  v_mfma_f32_16x16x32_bf16 v[116:119], a[60:63], a[92:95], v[116:119]
  ds_read_b64_tr_b16 a[44:45], v7 offset:2048
  v_mfma_f32_16x16x32_bf16 v[112:115], a[56:59], a[92:95], v[112:115]
  buffer_load_dwordx4 v27, s[20:23], s59 offen offset:3072 lds
  s_add_u32 s59, s59, 131072
  v_mfma_f32_16x16x32_bf16 v[128:131], a[56:59], a[96:99], v[128:131]
  ds_read_b64_tr_b16 a[46:47], v7 offset:10240
  v_mfma_f32_16x16x32_bf16 v[132:135], a[60:63], a[96:99], v[132:135]
  ds_read_b64_tr_b16 a[52:53], v22 offset:0
  v_mfma_f32_16x16x32_bf16 v[136:139], a[64:67], a[96:99], v[136:139]
  ds_read_b64_tr_b16 a[54:55], v22 offset:8192
  v_mfma_f32_16x16x32_bf16 v[140:143], a[68:71], a[96:99], v[140:143]
  v_add_u32 v17, 1024, v17
  v_and_or_b32 v17, v17, s63, v29
  v_mfma_f32_16x16x32_bf16 v[156:159], a[68:71], a[100:103], v[156:159]
  v_mfma_f32_16x16x32_bf16 v[152:155], a[64:67], a[100:103], v[152:155]
  v_mfma_f32_16x16x32_bf16 v[148:151], a[60:63], a[100:103], v[148:151]
  v_mfma_f32_16x16x32_bf16 v[144:147], a[56:59], a[100:103], v[144:147]
  v_mfma_f32_16x16x32_bf16 v[160:163], a[104:107], a[108:111], v[160:163]
  s_mov_b32 s36, 6
L_f2:
  s_waitcnt vmcnt(12) lgkmcnt(0)
  s_and_b32 s32, s32, 0x3ffff
  s_and_b32 s59, s59, 0x3fffff
  s_lshr_b32 s46, s32, 16
  s_branch spc_20
sp_18:
  buffer_load_dword v30, v28, s[28:31], 0 offen sc1
  s_waitcnt vmcnt(0)
spc_20:
  v_subrev_u32 v30, s100, v30
  v_subrev_u32 v30, 2, v30
  v_cmp_lt_u32 vcc, 7, v30
  s_lshl_b32 s4, 0x11, s46
  s_and_b32 vcc_lo, vcc_lo, s4
  s_mov_b32 vcc_hi, 0
  s_sub_u32 s101, s101, 1
  s_cbranch_scc1 spd_19
  s_cbranch_vccnz sp_18
spd_19:
  s_barrier
  v_mfma_f32_16x16x32_bf16 v[32:35], a[0:3], a[16:19], v[32:35]
  s_add_u32 m0, s34, 0
  s_nop 0
  buffer_load_dwordx4 v12, s[8:11], s32 offen offset:0 lds
  v_mfma_f32_16x16x32_bf16 v[36:39], a[4:7], a[16:19], v[36:39]
  ds_read_b128 a[56:59], v2 offset:24576
  v_mfma_f32_16x16x32_bf16 v[40:43], a[8:11], a[16:19], v[40:43]
  ds_read_b64_tr_b16 a[72:73], v4 offset:24576
  v_mfma_f32_16x16x32_bf16 v[44:47], a[12:15], a[16:19], v[44:47]
  ds_read_b64_tr_b16 a[74:75], v4 offset:32768
  v_mfma_f32_16x16x32_bf16 v[60:63], a[12:15], a[20:23], v[60:63]
  ds_read_b128 a[60:63], v2 offset:25600
  v_mfma_f32_16x16x32_bf16 v[56:59], a[8:11], a[20:23], v[56:59]
  buffer_load_dwordx4 v12, s[8:11], s32 offen offset:1024 lds
  s_add_u32 s32, s32, 8192
  v_mfma_f32_16x16x32_bf16 v[52:55], a[4:7], a[20:23], v[52:55]
  ds_read_b64_tr_b16 a[76:77], v5 offset:24576
  v_mfma_f32_16x16x32_bf16 v[48:51], a[0:3], a[20:23], v[48:51]
  ds_read_b64_tr_b16 a[78:79], v5 offset:32768
  ds_read_b128 a[64:67], v2 offset:26624
  v_mfma_f32_16x16x32_bf16 v[64:67], a[0:3], a[24:27], v[64:67]
  ds_read_b64_tr_b16 a[80:81], v6 offset:24576
  v_mfma_f32_16x16x32_bf16 v[68:71], a[4:7], a[24:27], v[68:71]
  s_add_u32 m0, s60, 0
  v_mfma_f32_16x16x32_bf16 v[72:75], a[8:11], a[24:27], v[72:75]
  buffer_load_dwordx4 v24, s[16:19], s59 offen offset:0 lds
  v_mfma_f32_16x16x32_bf16 v[76:79], a[12:15], a[24:27], v[76:79]
  ds_read_b64_tr_b16 a[82:83], v6 offset:32768
  v_mfma_f32_16x16x32_bf16 v[92:95], a[12:15], a[28:31], v[92:95]
  ds_read_b128 a[68:71], v2 offset:27648
  v_mfma_f32_16x16x32_bf16 v[88:91], a[8:11], a[28:31], v[88:91]
  ds_read_b64_tr_b16 a[84:85], v7 offset:24576
  v_mfma_f32_16x16x32_bf16 v[84:87], a[4:7], a[28:31], v[84:87]
  ds_read_b64_tr_b16 a[86:87], v7 offset:32768
  buffer_load_dwordx4 v25, s[16:19], s59 offen offset:1024 lds
  v_mfma_f32_16x16x32_bf16 v[80:83], a[0:3], a[28:31], v[80:83]
  ds_read_b128 a[104:107], v17
  v_mfma_f32_16x16x32_bf16 v[96:99], a[0:3], a[32:35], v[96:99]
  ds_read_b64_tr_b16 a[88:89], v4 offset:26624
  v_mfma_f32_16x16x32_bf16 v[100:103], a[4:7], a[32:35], v[100:103]
  ds_read_b64_tr_b16 a[90:91], v4 offset:34816
  v_mfma_f32_16x16x32_bf16 v[104:107], a[8:11], a[32:35], v[104:107]
  ds_read_b64_tr_b16 a[92:93], v5 offset:26624
  v_mfma_f32_16x16x32_bf16 v[108:111], a[12:15], a[32:35], v[108:111]
  buffer_load_dwordx4 v26, s[20:23], s59 offen offset:2048 lds
  v_mfma_f32_16x16x32_bf16 v[124:127], a[12:15], a[36:39], v[124:127]
  ds_read_b64_tr_b16 a[94:95], v5 offset:34816
  v_mfma_f32_16x16x32_bf16 v[120:123], a[8:11], a[36:39], v[120:123]
  ds_read_b64_tr_b16 a[96:97], v6 offset:26624
  ds_read_b64_tr_b16 a[98:99], v6 offset:34816
  v_mfma_f32_16x16x32_bf16 v[116:119], a[4:7], a[36:39], v[116:119]
  ds_read_b64_tr_b16 a[100:101], v7 offset:26624
  v_mfma_f32_16x16x32_bf16 v[112:115], a[0:3], a[36:39], v[112:115]
  buffer_load_dwordx4 v27, s[20:23], s59 offen offset:3072 lds
  s_add_u32 s59, s59, 131072
  v_mfma_f32_16x16x32_bf16 v[128:131], a[0:3], a[40:43], v[128:131]
  ds_read_b64_tr_b16 a[102:103], v7 offset:34816
  v_mfma_f32_16x16x32_bf16 v[132:135], a[4:7], a[40:43], v[132:135]
  ds_read_b64_tr_b16 a[108:109], v22 offset:24576
  v_mfma_f32_16x16x32_bf16 v[136:139], a[8:11], a[40:43], v[136:139]
  ds_read_b64_tr_b16 a[110:111], v22 offset:32768
  v_mfma_f32_16x16x32_bf16 v[140:143], a[12:15], a[40:43], v[140:143]
  v_add_u32 v17, 1024, v17
  v_and_or_b32 v17, v17, s63, v29
  v_mfma_f32_16x16x32_bf16 v[156:159], a[12:15], a[44:47], v[156:159]
  v_mfma_f32_16x16x32_bf16 v[152:155], a[8:11], a[44:47], v[152:155]
  v_mfma_f32_16x16x32_bf16 v[148:151], a[4:7], a[44:47], v[148:151]
  v_mfma_f32_16x16x32_bf16 v[144:147], a[0:3], a[44:47], v[144:147]
  v_mfma_f32_16x16x32_bf16 v[160:163], a[48:51], a[52:55], v[160:163]
  s_waitcnt vmcnt(12) lgkmcnt(0)
  s_barrier
  v_mfma_f32_16x16x32_bf16 v[32:35], a[56:59], a[72:75], v[32:35]
  s_add_u32 m0, s34, 24576
  s_nop 0
  buffer_load_dwordx4 v12, s[8:11], s32 offen offset:0 lds
  v_mfma_f32_16x16x32_bf16 v[36:39], a[60:63], a[72:75], v[36:39]
  ds_read_b128 a[0:3], v3 offset:0
  v_mfma_f32_16x16x32_bf16 v[40:43], a[64:67], a[72:75], v[40:43]
  ds_read_b64_tr_b16 a[16:17], v8 offset:0
  v_mfma_f32_16x16x32_bf16 v[44:47], a[68:71], a[72:75], v[44:47]
  ds_read_b64_tr_b16 a[18:19], v8 offset:8192
  v_mfma_f32_16x16x32_bf16 v[60:63], a[68:71], a[76:79], v[60:63]
  ds_read_b128 a[4:7], v3 offset:1024
  v_mfma_f32_16x16x32_bf16 v[56:59], a[64:67], a[76:79], v[56:59]
  buffer_load_dwordx4 v12, s[8:11], s32 offen offset:1024 lds
  s_add_u32 s32, s32, 8192
  ds_read_b64_tr_b16 a[20:21], v9 offset:0
  v_mfma_f32_16x16x32_bf16 v[52:55], a[60:63], a[76:79], v[52:55]
  ds_read_b64_tr_b16 a[22:23], v9 offset:8192
  v_mfma_f32_16x16x32_bf16 v[48:51], a[56:59], a[76:79], v[48:51]
  ds_read_b128 a[8:11], v3 offset:2048
  v_mfma_f32_16x16x32_bf16 v[64:67], a[56:59], a[80:83], v[64:67]
  s_add_u32 m0, s60, 24576
  v_mfma_f32_16x16x32_bf16 v[68:71], a[60:63], a[80:83], v[68:71]
  buffer_load_dwordx4 v24, s[16:19], s59 offen offset:0 lds
  v_mfma_f32_16x16x32_bf16 v[72:75], a[64:67], a[80:83], v[72:75]
  ds_read_b64_tr_b16 a[24:25], v10 offset:0
  v_mfma_f32_16x16x32_bf16 v[76:79], a[68:71], a[80:83], v[76:79]
  ds_read_b64_tr_b16 a[26:27], v10 offset:8192
  ds_read_b128 a[12:15], v3 offset:3072
  v_mfma_f32_16x16x32_bf16 v[92:95], a[68:71], a[84:87], v[92:95]
  ds_read_b64_tr_b16 a[28:29], v11 offset:0
  v_mfma_f32_16x16x32_bf16 v[88:91], a[64:67], a[84:87], v[88:91]
  buffer_load_dwordx4 v25, s[16:19], s59 offen offset:1024 lds
  v_mfma_f32_16x16x32_bf16 v[84:87], a[60:63], a[84:87], v[84:87]
  ds_read_b64_tr_b16 a[30:31], v11 offset:8192
  v_mfma_f32_16x16x32_bf16 v[80:83], a[56:59], a[84:87], v[80:83]
  ds_read_b128 a[48:51], v17
  v_mfma_f32_16x16x32_bf16 v[96:99], a[56:59], a[88:91], v[96:99]
  ds_read_b64_tr_b16 a[32:33], v8 offset:2048
  buffer_load_dwordx4 v26, s[20:23], s59 offen offset:2048 lds
  v_mfma_f32_16x16x32_bf16 v[100:103], a[60:63], a[88:91], v[100:103]
  ds_read_b64_tr_b16 a[34:35], v8 offset:10240
  v_mfma_f32_16x16x32_bf16 v[104:107], a[64:67], a[88:91], v[104:107]
  ds_read_b64_tr_b16 a[36:37], v9 offset:2048
  v_mfma_f32_16x16x32_bf16 v[108:111], a[68:71], a[88:91], v[108:111]
  ds_read_b64_tr_b16 a[38:39], v9 offset:10240
  v_mfma_f32_16x16x32_bf16 v[124:127], a[68:71], a[92:95], v[124:127]
  ds_read_b64_tr_b16 a[40:41], v10 offset:2048
  v_mfma_f32_16x16x32_bf16 v[120:123], a[64:67], a[92:95], v[120:123]
  buffer_load_dwordx4 v27, s[20:23], s59 offen offset:3072 lds
  s_add_u32 s59, s59, 131072
  v_mfma_f32_16x16x32_bf16 v[116:119], a[60:63], a[92:95], v[116:119]
  ds_read_b64_tr_b16 a[42:43], v10 offset:10240
  ds_read_b64_tr_b16 a[44:45], v11 offset:2048
  v_mfma_f32_16x16x32_bf16 v[112:115], a[56:59], a[92:95], v[112:115]
  ds_read_b64_tr_b16 a[46:47], v11 offset:10240
  v_mfma_f32_16x16x32_bf16 v[128:131], a[56:59], a[96:99], v[128:131]
  buffer_load_dword v30, v28, s[28:31], 0 offen sc1
  v_mfma_f32_16x16x32_bf16 v[132:135], a[60:63], a[96:99], v[132:135]
  ds_read_b64_tr_b16 a[52:53], v23 offset:0
  v_mfma_f32_16x16x32_bf16 v[136:139], a[64:67], a[96:99], v[136:139]
  ds_read_b64_tr_b16 a[54:55], v23 offset:8192
  v_mfma_f32_16x16x32_bf16 v[140:143], a[68:71], a[96:99], v[140:143]
  v_add_u32 v17, 1024, v17
  v_and_or_b32 v17, v17, s63, v29
  v_mfma_f32_16x16x32_bf16 v[156:159], a[68:71], a[100:103], v[156:159]
  v_mfma_f32_16x16x32_bf16 v[152:155], a[64:67], a[100:103], v[152:155]
  v_mfma_f32_16x16x32_bf16 v[148:151], a[60:63], a[100:103], v[148:151]
  v_mfma_f32_16x16x32_bf16 v[144:147], a[56:59], a[100:103], v[144:147]
  v_mfma_f32_16x16x32_bf16 v[160:163], a[104:107], a[108:111], v[160:163]
  s_waitcnt vmcnt(12) lgkmcnt(0)
  s_barrier
  v_mfma_f32_16x16x32_bf16 v[32:35], a[0:3], a[16:19], v[32:35]
  s_add_u32 m0, s34, 49152
  s_nop 0
  buffer_load_dwordx4 v12, s[8:11], s32 offen offset:0 lds
  v_mfma_f32_16x16x32_bf16 v[36:39], a[4:7], a[16:19], v[36:39]
  ds_read_b128 a[56:59], v3 offset:24576
  v_mfma_f32_16x16x32_bf16 v[40:43], a[8:11], a[16:19], v[40:43]
  ds_read_b64_tr_b16 a[72:73], v8 offset:24576
  v_mfma_f32_16x16x32_bf16 v[44:47], a[12:15], a[16:19], v[44:47]
  ds_read_b64_tr_b16 a[74:75], v8 offset:32768
  v_mfma_f32_16x16x32_bf16 v[60:63], a[12:15], a[20:23], v[60:63]
  ds_read_b128 a[60:63], v3 offset:25600
  v_mfma_f32_16x16x32_bf16 v[56:59], a[8:11], a[20:23], v[56:59]
  buffer_load_dwordx4 v12, s[8:11], s32 offen offset:1024 lds
  s_add_u32 s32, s32, 8192
  v_mfma_f32_16x16x32_bf16 v[52:55], a[4:7], a[20:23], v[52:55]
  ds_read_b64_tr_b16 a[76:77], v9 offset:24576
  v_mfma_f32_16x16x32_bf16 v[48:51], a[0:3], a[20:23], v[48:51]
  ds_read_b64_tr_b16 a[78:79], v9 offset:32768
  ds_read_b128 a[64:67], v3 offset:26624
  v_mfma_f32_16x16x32_bf16 v[64:67], a[0:3], a[24:27], v[64:67]
  ds_read_b64_tr_b16 a[80:81], v10 offset:24576
  v_mfma_f32_16x16x32_bf16 v[68:71], a[4:7], a[24:27], v[68:71]
  s_add_u32 m0, s60, 49152
  v_mfma_f32_16x16x32_bf16 v[72:75], a[8:11], a[24:27], v[72:75]
  buffer_load_dwordx4 v24, s[16:19], s59 offen offset:0 lds
  v_mfma_f32_16x16x32_bf16 v[76:79], a[12:15], a[24:27], v[76:79]
  ds_read_b64_tr_b16 a[82:83], v10 offset:32768
  v_mfma_f32_16x16x32_bf16 v[92:95], a[12:15], a[28:31], v[92:95]
  ds_read_b128 a[68:71], v3 offset:27648
  v_mfma_f32_16x16x32_bf16 v[88:91], a[8:11], a[28:31], v[88:91]
  ds_read_b64_tr_b16 a[84:85], v11 offset:24576
  v_mfma_f32_16x16x32_bf16 v[84:87], a[4:7], a[28:31], v[84:87]
  ds_read_b64_tr_b16 a[86:87], v11 offset:32768
  buffer_load_dwordx4 v25, s[16:19], s59 offen offset:1024 lds
  v_mfma_f32_16x16x32_bf16 v[80:83], a[0:3], a[28:31], v[80:83]
  ds_read_b128 a[104:107], v17
  v_mfma_f32_16x16x32_bf16 v[96:99], a[0:3], a[32:35], v[96:99]
  ds_read_b64_tr_b16 a[88:89], v8 offset:26624
  v_mfma_f32_16x16x32_bf16 v[100:103], a[4:7], a[32:35], v[100:103]
  ds_read_b64_tr_b16 a[90:91], v8 offset:34816
  v_mfma_f32_16x16x32_bf16 v[104:107], a[8:11], a[32:35], v[104:107]
  ds_read_b64_tr_b16 a[92:93], v9 offset:26624
  v_mfma_f32_16x16x32_bf16 v[108:111], a[12:15], a[32:35], v[108:111]
  buffer_load_dwordx4 v26, s[20:23], s59 offen offset:2048 lds
  v_mfma_f32_16x16x32_bf16 v[124:127], a[12:15], a[36:39], v[124:127]
  ds_read_b64_tr_b16 a[94:95], v9 offset:34816
  v_mfma_f32_16x16x32_bf16 v[120:123], a[8:11], a[36:39], v[120:123]
  ds_read_b64_tr_b16 a[96:97], v10 offset:26624
  ds_read_b64_tr_b16 a[98:99], v10 offset:34816
  v_mfma_f32_16x16x32_bf16 v[116:119], a[4:7], a[36:39], v[116:119]
  ds_read_b64_tr_b16 a[100:101], v11 offset:26624
  v_mfma_f32_16x16x32_bf16 v[112:115], a[0:3], a[36:39], v[112:115]
  buffer_load_dwordx4 v27, s[20:23], s59 offen offset:3072 lds
  s_add_u32 s59, s59, 131072
  v_mfma_f32_16x16x32_bf16 v[128:131], a[0:3], a[40:43], v[128:131]
  ds_read_b64_tr_b16 a[102:103], v11 offset:34816
  v_mfma_f32_16x16x32_bf16 v[132:135], a[4:7], a[40:43], v[132:135]
  ds_read_b64_tr_b16 a[108:109], v23 offset:24576
  v_mfma_f32_16x16x32_bf16 v[136:139], a[8:11], a[40:43], v[136:139]
  ds_read_b64_tr_b16 a[110:111], v23 offset:32768
  v_mfma_f32_16x16x32_bf16 v[140:143], a[12:15], a[40:43], v[140:143]
  v_add_u32 v17, 1024, v17
  v_and_or_b32 v17, v17, s63, v29
  v_mfma_f32_16x16x32_bf16 v[156:159], a[12:15], a[44:47], v[156:159]
  v_mfma_f32_16x16x32_bf16 v[152:155], a[8:11], a[44:47], v[152:155]
  v_mfma_f32_16x16x32_bf16 v[148:151], a[4:7], a[44:47], v[148:151]
  v_mfma_f32_16x16x32_bf16 v[144:147], a[0:3], a[44:47], v[144:147]
  v_mfma_f32_16x16x32_bf16 v[160:163], a[48:51], a[52:55], v[160:163]
  s_waitcnt vmcnt(12) lgkmcnt(0)
  s_barrier
  v_mfma_f32_16x16x32_bf16 v[32:35], a[56:59], a[72:75], v[32:35]
  s_add_u32 m0, s34, 73728
  s_nop 0
  buffer_load_dwordx4 v12, s[8:11], s32 offen offset:0 lds
  v_mfma_f32_16x16x32_bf16 v[36:39], a[60:63], a[72:75], v[36:39]
  ds_read_b128 a[0:3], v2 offset:0
  v_mfma_f32_16x16x32_bf16 v[40:43], a[64:67], a[72:75], v[40:43]
  ds_read_b64_tr_b16 a[16:17], v4 offset:0
  v_mfma_f32_16x16x32_bf16 v[44:47], a[68:71], a[72:75], v[44:47]
  ds_read_b64_tr_b16 a[18:19], v4 offset:8192
  v_mfma_f32_16x16x32_bf16 v[60:63], a[68:71], a[76:79], v[60:63]
  ds_read_b128 a[4:7], v2 offset:1024
  v_mfma_f32_16x16x32_bf16 v[56:59], a[64:67], a[76:79], v[56:59]
  buffer_load_dwordx4 v12, s[8:11], s32 offen offset:1024 lds
  s_add_u32 s32, s32, 8192
  v_mfma_f32_16x16x32_bf16 v[52:55], a[60:63], a[76:79], v[52:55]
  ds_read_b64_tr_b16 a[20:21], v5 offset:0
  v_mfma_f32_16x16x32_bf16 v[48:51], a[56:59], a[76:79], v[48:51]
  ds_read_b64_tr_b16 a[22:23], v5 offset:8192
  ds_read_b128 a[8:11], v2 offset:2048
  v_mfma_f32_16x16x32_bf16 v[64:67], a[56:59], a[80:83], v[64:67]
  ds_read_b64_tr_b16 a[24:25], v6 offset:0
  v_mfma_f32_16x16x32_bf16 v[68:71], a[60:63], a[80:83], v[68:71]
  s_add_u32 m0, s60, 73728
  v_mfma_f32_16x16x32_bf16 v[72:75], a[64:67], a[80:83], v[72:75]
  buffer_load_dwordx4 v24, s[16:19], s59 offen offset:0 lds
  v_mfma_f32_16x16x32_bf16 v[76:79], a[68:71], a[80:83], v[76:79]
  ds_read_b64_tr_b16 a[26:27], v6 offset:8192
  v_mfma_f32_16x16x32_bf16 v[92:95], a[68:71], a[84:87], v[92:95]
  ds_read_b128 a[12:15], v2 offset:3072
  v_mfma_f32_16x16x32_bf16 v[88:91], a[64:67], a[84:87], v[88:91]
  ds_read_b64_tr_b16 a[28:29], v7 offset:0
  v_mfma_f32_16x16x32_bf16 v[84:87], a[60:63], a[84:87], v[84:87]
  ds_read_b64_tr_b16 a[30:31], v7 offset:8192
  buffer_load_dwordx4 v25, s[16:19], s59 offen offset:1024 lds
  v_mfma_f32_16x16x32_bf16 v[80:83], a[56:59], a[84:87], v[80:83]
  ds_read_b128 a[48:51], v17
  v_mfma_f32_16x16x32_bf16 v[96:99], a[56:59], a[88:91], v[96:99]
  ds_read_b64_tr_b16 a[32:33], v4 offset:2048
  v_mfma_f32_16x16x32_bf16 v[100:103], a[60:63], a[88:91], v[100:103]
  ds_read_b64_tr_b16 a[34:35], v4 offset:10240
  v_mfma_f32_16x16x32_bf16 v[104:107], a[64:67], a[88:91], v[104:107]
  ds_read_b64_tr_b16 a[36:37], v5 offset:2048
  v_mfma_f32_16x16x32_bf16 v[108:111], a[68:71], a[88:91], v[108:111]
  buffer_load_dwordx4 v26, s[20:23], s59 offen offset:2048 lds
  v_mfma_f32_16x16x32_bf16 v[124:127], a[68:71], a[92:95], v[124:127]
  ds_read_b64_tr_b16 a[38:39], v5 offset:10240
  v_mfma_f32_16x16x32_bf16 v[120:123], a[64:67], a[92:95], v[120:123]
  ds_read_b64_tr_b16 a[40:41], v6 offset:2048
  ds_read_b64_tr_b16 a[42:43], v6 offset:10240
  v_mfma_f32_16x16x32_bf16 v[116:119], a[60:63], a[92:95], v[116:119]
  ds_read_b64_tr_b16 a[44:45], v7 offset:2048
  v_mfma_f32_16x16x32_bf16 v[112:115], a[56:59], a[92:95], v[112:115]
  buffer_load_dwordx4 v27, s[20:23], s59 offen offset:3072 lds
  s_add_u32 s59, s59, 131072
  v_mfma_f32_16x16x32_bf16 v[128:131], a[56:59], a[96:99], v[128:131]
  ds_read_b64_tr_b16 a[46:47], v7 offset:10240
  v_mfma_f32_16x16x32_bf16 v[132:135], a[60:63], a[96:99], v[132:135]
  ds_read_b64_tr_b16 a[52:53], v22 offset:0
  v_mfma_f32_16x16x32_bf16 v[136:139], a[64:67], a[96:99], v[136:139]
  ds_read_b64_tr_b16 a[54:55], v22 offset:8192
  v_mfma_f32_16x16x32_bf16 v[140:143], a[68:71], a[96:99], v[140:143]
  v_add_u32 v17, 1024, v17
  v_and_or_b32 v17, v17, s63, v29
  v_mfma_f32_16x16x32_bf16 v[156:159], a[68:71], a[100:103], v[156:159]
  v_mfma_f32_16x16x32_bf16 v[152:155], a[64:67], a[100:103], v[152:155]
  v_mfma_f32_16x16x32_bf16 v[148:151], a[60:63], a[100:103], v[148:151]
  v_mfma_f32_16x16x32_bf16 v[144:147], a[56:59], a[100:103], v[144:147]
  s_sub_u32 s36, s36, 1
  s_cmp_lg_u32 s36, 0
  v_mfma_f32_16x16x32_bf16 v[160:163], a[104:107], a[108:111], v[160:163]
  s_cbranch_scc1 L_f2
  s_and_b32 s56, s41, 1
  s_lshl_b32 s56, s56, 2
  s_and_b32 s57, s42, 3
  s_add_u32 s56, s56, s57
  s_lshr_b32 s57, s42, 2
  s_lshr_b32 s58, s41, 1
  s_mul_i32 s60, s3, 2048
  s_add_u32 s60, s60, 0
  s_mov_b32 s59, 0
  v_lshrrev_b32 v19, 4, v1
  v_and_b32 v20, 15, v1
  s_mov_b32 s40, 2048
  s_mul_i32 s39, s3, 16384
  v_add_u32 v21, 0, v19
  v_mul_lo_u32 v18, v21, s40
  v_add_u32 v18, s39, v18
  v_lshlrev_b32 v21, 1, v21
  v_xor_b32 v21, v21, v20
  v_lshl_add_u32 v18, v21, 4, v18
  v_add_u32 v24, 4096, v18
  v_add_u32 v21, 4, v19
  v_mul_lo_u32 v18, v21, s40
  v_add_u32 v18, s39, v18
  v_lshlrev_b32 v21, 1, v21
  v_xor_b32 v21, v21, v20
  v_lshl_add_u32 v18, v21, 4, v18
  v_add_u32 v25, 3072, v18
  s_mul_i32 s96, s58, 1835008
  s_sub_u32 s98, s42, 4
  s_max_i32 s98, s98, 0
  s_lshr_b32 s98, s98, 2
  s_lshl_b32 s59, s98, 18
  s_add_u32 s59, s59, s96
  s_lshl_b32 s44, s57, 8
  s_sub_u32 s45, 7344128, s44
  s_add_u32 s20, s80, s44
  s_addc_u32 s21, s81, 0
  s_sub_u32 s20, s20, 0x1000
  s_subb_u32 s21, s21, 0
  s_mov_b32 s22, s45
  s_mov_b32 s23, 0x20000
  v_lshrrev_b32 v28, 4, v1
  v_lshlrev_b32 v28, 4, v28
  s_lshl_b32 s50, s55, 9
  s_lshl_b32 s51, s37, 8
  s_add_u32 s51, s50, s51
  s_add_u32 s51, s51, 36864
  s_mov_b32 s52, 32784
  v_and_b32 v253, 127, v0
  v_lshlrev_b32 v253, 2, v253
  v_add_u32 v253, s50, v253
  v_lshlrev_b32 v254, 7, v1
  s_lshr_b32 s4, s3, 1
  s_or_b32 s4, s4, s42
  s_cmp_eq_u32 s4, 0
  s_cselect_b32 s4, 0, 0x80000000
  v_or_b32 v252, s4, v253
  s_xor_b32 s4, s3, 2
  s_or_b32 s4, s4, s42
  s_or_b32 s4, s4, s55
  s_cmp_eq_u32 s4, 0
  s_cselect_b32 s4, 0, 0x80000000
  v_or_b32 v254, s4, v254
  s_mov_b32 s44, 40960
  s_mov_b32 s45, 45056
  s_mov_b32 s46, 49152
  s_mov_b32 s47, 53248
  s_mov_b32 s48, 36864
  s_mov_b32 s49, 0x2000
  s_mov_b32 s53, 0x6000
  s_mov_b32 s61, 0x4000
  v_and_b32 v250, 1, v1
  v_lshlrev_b32 v250, 31, v250
  v_or_b32 v250, 1.0, v250
  s_mul_i32 s4, s54, 2097152
  s_add_u32 s8, s86, s4
  s_addc_u32 s9, s87, 0
  s_add_u32 s8, s8, 0x1700000
  s_addc_u32 s9, s9, 0
  s_mov_b32 s10, 0x120480
  s_mov_b32 s11, 0x20000
  s_lshl_b32 s4, s3, 13
  s_add_u32 s4, s4, 131072
  v_and_b32 v18, 15, v1
  v_and_b32 v19, 7, v1
  v_lshrrev_b32 v20, 5, v1
  v_bfe_u32 v21, v1, 4, 1
  v_mul_u32_u24 v251, 1152, v18
  v_lshlrev_b32 v18, 7, v18
  v_lshl_add_u32 v18, v21, 3, v18
  v_add_u32 v18, s4, v18
  v_add_u32 v21, 0, v20
  v_xor_b32 v21, v21, v19
  v_lshl_add_u32 v244, v21, 4, v18
  v_add_u32 v21, 2, v20
  v_xor_b32 v21, v21, v19
  v_lshl_add_u32 v245, v21, 4, v18
  v_add_u32 v21, 4, v20
  v_xor_b32 v21, v21, v19
  v_lshl_add_u32 v246, v21, 4, v18
  v_add_u32 v21, 6, v20
  v_xor_b32 v21, v21, v19
  v_lshl_add_u32 v247, v21, 4, v18
  v_lshrrev_b32 v20, 3, v1
  v_xor_b32 v21, v20, v19
  v_lshlrev_b32 v18, 7, v20
  v_lshl_add_u32 v18, v21, 4, v18
  v_add_u32 v248, s4, v18
  v_mul_u32_u24 v249, 1152, v20
  v_lshl_add_u32 v249, v19, 4, v249
  s_waitcnt vmcnt(12) lgkmcnt(0)
  s_barrier
  v_mfma_f32_16x16x32_bf16 v[32:35], a[0:3], a[16:19], v[32:35]
  buffer_load_dwordx4 v[164:167], v28, s[24:27], s51 offen offset:0 sc1
  ds_read_b128 a[56:59], v2 offset:24576
  v_mfma_f32_16x16x32_bf16 v[36:39], a[4:7], a[16:19], v[36:39]
  ds_read_b64_tr_b16 a[72:73], v4 offset:24576
  v_mfma_f32_16x16x32_bf16 v[40:43], a[8:11], a[16:19], v[40:43]
  buffer_load_dwordx4 v[168:171], v28, s[24:27], s51 offen offset:64 sc1
  ds_read_b64_tr_b16 a[74:75], v4 offset:32768
  v_mfma_f32_16x16x32_bf16 v[44:47], a[12:15], a[16:19], v[44:47]
  buffer_load_dwordx4 v[172:175], v28, s[24:27], s51 offen offset:128 sc1
  v_mfma_f32_16x16x32_bf16 v[60:63], a[12:15], a[20:23], v[60:63]
  ds_read_b128 a[60:63], v2 offset:25600
  buffer_load_dwordx4 v[176:179], v28, s[24:27], s51 offen offset:192 sc1
  v_mfma_f32_16x16x32_bf16 v[56:59], a[8:11], a[20:23], v[56:59]
  ds_read_b64_tr_b16 a[76:77], v5 offset:24576
  v_mfma_f32_16x16x32_bf16 v[52:55], a[4:7], a[20:23], v[52:55]
  ds_read_b64_tr_b16 a[78:79], v5 offset:32768
  buffer_load_dword v180, v28, s[24:27], s52 offen sc1
  v_mfma_f32_16x16x32_bf16 v[48:51], a[0:3], a[20:23], v[48:51]
  ds_read_b128 a[64:67], v2 offset:26624
  v_mfma_f32_16x16x32_bf16 v[64:67], a[0:3], a[24:27], v[64:67]
  buffer_load_dword v184, v252, s[24:27], s44 offen offset:0 sc1
  ds_read_b64_tr_b16 a[80:81], v6 offset:24576
  v_mfma_f32_16x16x32_bf16 v[68:71], a[4:7], a[24:27], v[68:71]
  buffer_load_dword v185, v252, s[24:27], s44 offen offset:2048 sc1
  v_mfma_f32_16x16x32_bf16 v[72:75], a[8:11], a[24:27], v[72:75]
  ds_read_b64_tr_b16 a[82:83], v6 offset:32768
  ds_read_b128 a[68:71], v2 offset:27648
  v_mfma_f32_16x16x32_bf16 v[76:79], a[12:15], a[24:27], v[76:79]
  buffer_load_dword v186, v252, s[24:27], s45 offen offset:0 sc1
  v_mfma_f32_16x16x32_bf16 v[92:95], a[12:15], a[28:31], v[92:95]
  ds_read_b64_tr_b16 a[84:85], v7 offset:24576
  buffer_load_dword v187, v252, s[24:27], s45 offen offset:2048 sc1
  v_mfma_f32_16x16x32_bf16 v[88:91], a[8:11], a[28:31], v[88:91]
  ds_read_b64_tr_b16 a[86:87], v7 offset:32768
  v_mfma_f32_16x16x32_bf16 v[84:87], a[4:7], a[28:31], v[84:87]
  buffer_load_dword v188, v252, s[24:27], s46 offen offset:0 sc1
  ds_read_b128 a[104:107], v17
  v_mfma_f32_16x16x32_bf16 v[80:83], a[0:3], a[28:31], v[80:83]
  ds_read_b64_tr_b16 a[88:89], v4 offset:26624
  v_mfma_f32_16x16x32_bf16 v[96:99], a[0:3], a[32:35], v[96:99]
  buffer_load_dword v189, v252, s[24:27], s46 offen offset:2048 sc1
  ds_read_b64_tr_b16 a[90:91], v4 offset:34816
  v_mfma_f32_16x16x32_bf16 v[100:103], a[4:7], a[32:35], v[100:103]
  buffer_load_dword v190, v252, s[24:27], s47 offen offset:0 sc1
  v_mfma_f32_16x16x32_bf16 v[104:107], a[8:11], a[32:35], v[104:107]
  ds_read_b64_tr_b16 a[92:93], v5 offset:26624
  buffer_load_dword v191, v252, s[24:27], s47 offen offset:2048 sc1
  v_mfma_f32_16x16x32_bf16 v[108:111], a[12:15], a[32:35], v[108:111]
  ds_read_b64_tr_b16 a[94:95], v5 offset:34816
  v_mfma_f32_16x16x32_bf16 v[124:127], a[12:15], a[36:39], v[124:127]
  ds_read_b64_tr_b16 a[96:97], v6 offset:26624
  buffer_load_dword v192, v252, s[24:27], s48 offen sc1
  v_mfma_f32_16x16x32_bf16 v[120:123], a[8:11], a[36:39], v[120:123]
  ds_read_b64_tr_b16 a[98:99], v6 offset:34816
  v_mfma_f32_16x16x32_bf16 v[116:119], a[4:7], a[36:39], v[116:119]
  buffer_load_dwordx4 v[196:199], v254, s[24:27], 0 offen offset:16 sc1
  ds_read_b64_tr_b16 a[100:101], v7 offset:26624
  v_mfma_f32_16x16x32_bf16 v[112:115], a[0:3], a[36:39], v[112:115]
  buffer_load_dwordx4 v[200:203], v254, s[24:27], s49 offen offset:16 sc1
  v_mfma_f32_16x16x32_bf16 v[128:131], a[0:3], a[40:43], v[128:131]
  ds_read_b64_tr_b16 a[102:103], v7 offset:34816
  ds_read_b64_tr_b16 a[108:109], v22 offset:24576
  v_mfma_f32_16x16x32_bf16 v[132:135], a[4:7], a[40:43], v[132:135]
  buffer_load_dwordx4 v[204:207], v254, s[24:27], s61 offen offset:16 sc1
  v_mfma_f32_16x16x32_bf16 v[136:139], a[8:11], a[40:43], v[136:139]
  ds_read_b64_tr_b16 a[110:111], v22 offset:32768
  buffer_load_dwordx4 v[208:211], v254, s[24:27], s53 offen offset:16 sc1
  v_mfma_f32_16x16x32_bf16 v[140:143], a[12:15], a[40:43], v[140:143]
  v_add_u32 v17, 1024, v17
  v_and_or_b32 v17, v17, s63, v29
  v_mfma_f32_16x16x32_bf16 v[156:159], a[12:15], a[44:47], v[156:159]
  v_mfma_f32_16x16x32_bf16 v[152:155], a[8:11], a[44:47], v[152:155]
  v_mfma_f32_16x16x32_bf16 v[148:151], a[4:7], a[44:47], v[148:151]
  v_mfma_f32_16x16x32_bf16 v[144:147], a[0:3], a[44:47], v[144:147]
  v_mfma_f32_16x16x32_bf16 v[160:163], a[48:51], a[52:55], v[160:163]
  s_waitcnt vmcnt(24) lgkmcnt(0)
  s_barrier
  v_mfma_f32_16x16x32_bf16 v[32:35], a[56:59], a[72:75], v[32:35]
  ds_read_b128 a[0:3], v3 offset:0
  v_mfma_f32_16x16x32_bf16 v[36:39], a[60:63], a[72:75], v[36:39]
  ds_read_b64_tr_b16 a[16:17], v8 offset:0
  v_mfma_f32_16x16x32_bf16 v[40:43], a[64:67], a[72:75], v[40:43]
  ds_read_b64_tr_b16 a[18:19], v8 offset:8192
  v_mfma_f32_16x16x32_bf16 v[44:47], a[68:71], a[72:75], v[44:47]
  ds_read_b128 a[4:7], v3 offset:1024
  v_mfma_f32_16x16x32_bf16 v[60:63], a[68:71], a[76:79], v[60:63]
  ds_read_b64_tr_b16 a[20:21], v9 offset:0
  v_mfma_f32_16x16x32_bf16 v[56:59], a[64:67], a[76:79], v[56:59]
  ds_read_b64_tr_b16 a[22:23], v9 offset:8192
  v_mfma_f32_16x16x32_bf16 v[52:55], a[60:63], a[76:79], v[52:55]
  v_mfma_f32_16x16x32_bf16 v[48:51], a[56:59], a[76:79], v[48:51]
  ds_read_b128 a[8:11], v3 offset:2048
  v_mfma_f32_16x16x32_bf16 v[64:67], a[56:59], a[80:83], v[64:67]
  ds_read_b64_tr_b16 a[24:25], v10 offset:0
  v_mfma_f32_16x16x32_bf16 v[68:71], a[60:63], a[80:83], v[68:71]
  ds_read_b64_tr_b16 a[26:27], v10 offset:8192
  v_mfma_f32_16x16x32_bf16 v[72:75], a[64:67], a[80:83], v[72:75]
  ds_read_b128 a[12:15], v3 offset:3072
  v_mfma_f32_16x16x32_bf16 v[76:79], a[68:71], a[80:83], v[76:79]
  ds_read_b64_tr_b16 a[28:29], v11 offset:0
  v_mfma_f32_16x16x32_bf16 v[92:95], a[68:71], a[84:87], v[92:95]
  ds_read_b64_tr_b16 a[30:31], v11 offset:8192
  v_mfma_f32_16x16x32_bf16 v[88:91], a[64:67], a[84:87], v[88:91]
  v_mfma_f32_16x16x32_bf16 v[84:87], a[60:63], a[84:87], v[84:87]
  ds_read_b128 a[48:51], v17
  v_mfma_f32_16x16x32_bf16 v[80:83], a[56:59], a[84:87], v[80:83]
  ds_read_b64_tr_b16 a[32:33], v8 offset:2048
  v_mfma_f32_16x16x32_bf16 v[96:99], a[56:59], a[88:91], v[96:99]
  ds_read_b64_tr_b16 a[34:35], v8 offset:10240
  v_mfma_f32_16x16x32_bf16 v[100:103], a[60:63], a[88:91], v[100:103]
  ds_read_b64_tr_b16 a[36:37], v9 offset:2048
  v_mfma_f32_16x16x32_bf16 v[104:107], a[64:67], a[88:91], v[104:107]
  ds_read_b64_tr_b16 a[38:39], v9 offset:10240
  v_mfma_f32_16x16x32_bf16 v[108:111], a[68:71], a[88:91], v[108:111]
  ds_read_b64_tr_b16 a[40:41], v10 offset:2048
  v_mfma_f32_16x16x32_bf16 v[124:127], a[68:71], a[92:95], v[124:127]
  v_mfma_f32_16x16x32_bf16 v[120:123], a[64:67], a[92:95], v[120:123]
  ds_read_b64_tr_b16 a[42:43], v10 offset:10240
  v_mfma_f32_16x16x32_bf16 v[116:119], a[60:63], a[92:95], v[116:119]
  ds_read_b64_tr_b16 a[44:45], v11 offset:2048
  v_mfma_f32_16x16x32_bf16 v[112:115], a[56:59], a[92:95], v[112:115]
  ds_read_b64_tr_b16 a[46:47], v11 offset:10240
  v_mfma_f32_16x16x32_bf16 v[128:131], a[56:59], a[96:99], v[128:131]
  ds_read_b64_tr_b16 a[52:53], v23 offset:0
  v_mfma_f32_16x16x32_bf16 v[132:135], a[60:63], a[96:99], v[132:135]
  ds_read_b64_tr_b16 a[54:55], v23 offset:8192
  v_mfma_f32_16x16x32_bf16 v[136:139], a[64:67], a[96:99], v[136:139]
  v_add_u32 v17, 1024, v17
  v_and_or_b32 v17, v17, s63, v29
  v_mfma_f32_16x16x32_bf16 v[140:143], a[68:71], a[96:99], v[140:143]
  v_mfma_f32_16x16x32_bf16 v[156:159], a[68:71], a[100:103], v[156:159]
  v_mfma_f32_16x16x32_bf16 v[152:155], a[64:67], a[100:103], v[152:155]
  v_mfma_f32_16x16x32_bf16 v[148:151], a[60:63], a[100:103], v[148:151]
  v_mfma_f32_16x16x32_bf16 v[144:147], a[56:59], a[100:103], v[144:147]
  v_mfma_f32_16x16x32_bf16 v[160:163], a[104:107], a[108:111], v[160:163]
  s_waitcnt vmcnt(18) lgkmcnt(0)
  s_barrier
  v_mfma_f32_16x16x32_bf16 v[32:35], a[0:3], a[16:19], v[32:35]
  ds_read_b128 a[56:59], v3 offset:24576
  v_mfma_f32_16x16x32_bf16 v[36:39], a[4:7], a[16:19], v[36:39]
  ds_read_b64_tr_b16 a[72:73], v8 offset:24576
  v_mfma_f32_16x16x32_bf16 v[40:43], a[8:11], a[16:19], v[40:43]
  ds_read_b64_tr_b16 a[74:75], v8 offset:32768
  v_mfma_f32_16x16x32_bf16 v[44:47], a[12:15], a[16:19], v[44:47]
  ds_read_b128 a[60:63], v3 offset:25600
  v_mfma_f32_16x16x32_bf16 v[60:63], a[12:15], a[20:23], v[60:63]
  ds_read_b64_tr_b16 a[76:77], v9 offset:24576
  v_mfma_f32_16x16x32_bf16 v[56:59], a[8:11], a[20:23], v[56:59]
  ds_read_b64_tr_b16 a[78:79], v9 offset:32768
  v_mfma_f32_16x16x32_bf16 v[52:55], a[4:7], a[20:23], v[52:55]
  v_mfma_f32_16x16x32_bf16 v[48:51], a[0:3], a[20:23], v[48:51]
  ds_read_b128 a[64:67], v3 offset:26624
  v_mfma_f32_16x16x32_bf16 v[64:67], a[0:3], a[24:27], v[64:67]
  ds_read_b64_tr_b16 a[80:81], v10 offset:24576
  v_mfma_f32_16x16x32_bf16 v[68:71], a[4:7], a[24:27], v[68:71]
  ds_read_b64_tr_b16 a[82:83], v10 offset:32768
  v_mfma_f32_16x16x32_bf16 v[72:75], a[8:11], a[24:27], v[72:75]
  ds_read_b128 a[68:71], v3 offset:27648
  v_mfma_f32_16x16x32_bf16 v[76:79], a[12:15], a[24:27], v[76:79]
  ds_read_b64_tr_b16 a[84:85], v11 offset:24576
  v_mfma_f32_16x16x32_bf16 v[92:95], a[12:15], a[28:31], v[92:95]
  ds_read_b64_tr_b16 a[86:87], v11 offset:32768
  v_mfma_f32_16x16x32_bf16 v[88:91], a[8:11], a[28:31], v[88:91]
  v_mfma_f32_16x16x32_bf16 v[84:87], a[4:7], a[28:31], v[84:87]
  ds_read_b128 a[104:107], v17
  v_mfma_f32_16x16x32_bf16 v[80:83], a[0:3], a[28:31], v[80:83]
  ds_read_b64_tr_b16 a[88:89], v8 offset:26624
  v_mfma_f32_16x16x32_bf16 v[96:99], a[0:3], a[32:35], v[96:99]
  ds_read_b64_tr_b16 a[90:91], v8 offset:34816
  v_mfma_f32_16x16x32_bf16 v[100:103], a[4:7], a[32:35], v[100:103]
  ds_read_b64_tr_b16 a[92:93], v9 offset:26624
  v_mfma_f32_16x16x32_bf16 v[104:107], a[8:11], a[32:35], v[104:107]
  ds_read_b64_tr_b16 a[94:95], v9 offset:34816
  v_mfma_f32_16x16x32_bf16 v[108:111], a[12:15], a[32:35], v[108:111]
  ds_read_b64_tr_b16 a[96:97], v10 offset:26624
  v_mfma_f32_16x16x32_bf16 v[124:127], a[12:15], a[36:39], v[124:127]
  v_mfma_f32_16x16x32_bf16 v[120:123], a[8:11], a[36:39], v[120:123]
  ds_read_b64_tr_b16 a[98:99], v10 offset:34816
  v_mfma_f32_16x16x32_bf16 v[116:119], a[4:7], a[36:39], v[116:119]
  ds_read_b64_tr_b16 a[100:101], v11 offset:26624
  v_mfma_f32_16x16x32_bf16 v[112:115], a[0:3], a[36:39], v[112:115]
  ds_read_b64_tr_b16 a[102:103], v11 offset:34816
  v_mfma_f32_16x16x32_bf16 v[128:131], a[0:3], a[40:43], v[128:131]
  ds_read_b64_tr_b16 a[108:109], v23 offset:24576
  v_mfma_f32_16x16x32_bf16 v[132:135], a[4:7], a[40:43], v[132:135]
  ds_read_b64_tr_b16 a[110:111], v23 offset:32768
  v_mfma_f32_16x16x32_bf16 v[136:139], a[8:11], a[40:43], v[136:139]
  v_add_u32 v17, 1024, v17
  v_and_or_b32 v17, v17, s63, v29
  v_mfma_f32_16x16x32_bf16 v[140:143], a[12:15], a[40:43], v[140:143]
  v_mfma_f32_16x16x32_bf16 v[156:159], a[12:15], a[44:47], v[156:159]
  v_mfma_f32_16x16x32_bf16 v[152:155], a[8:11], a[44:47], v[152:155]
  v_mfma_f32_16x16x32_bf16 v[148:151], a[4:7], a[44:47], v[148:151]
  v_mfma_f32_16x16x32_bf16 v[144:147], a[0:3], a[44:47], v[144:147]
  v_mfma_f32_16x16x32_bf16 v[160:163], a[48:51], a[52:55], v[160:163]
  s_waitcnt lgkmcnt(0)
  s_barrier
  v_mfma_f32_16x16x32_bf16 v[32:35], a[56:59], a[72:75], v[32:35]
  v_mfma_f32_16x16x32_bf16 v[36:39], a[60:63], a[72:75], v[36:39]
  v_mfma_f32_16x16x32_bf16 v[40:43], a[64:67], a[72:75], v[40:43]
  v_mfma_f32_16x16x32_bf16 v[44:47], a[68:71], a[72:75], v[44:47]
  v_mfma_f32_16x16x32_bf16 v[60:63], a[68:71], a[76:79], v[60:63]
  v_mfma_f32_16x16x32_bf16 v[56:59], a[64:67], a[76:79], v[56:59]
  v_mfma_f32_16x16x32_bf16 v[52:55], a[60:63], a[76:79], v[52:55]
  v_mfma_f32_16x16x32_bf16 v[48:51], a[56:59], a[76:79], v[48:51]
  v_mfma_f32_16x16x32_bf16 v[64:67], a[56:59], a[80:83], v[64:67]
  v_mfma_f32_16x16x32_bf16 v[68:71], a[60:63], a[80:83], v[68:71]
  v_mfma_f32_16x16x32_bf16 v[72:75], a[64:67], a[80:83], v[72:75]
  v_mfma_f32_16x16x32_bf16 v[76:79], a[68:71], a[80:83], v[76:79]
  v_mfma_f32_16x16x32_bf16 v[92:95], a[68:71], a[84:87], v[92:95]
  v_mfma_f32_16x16x32_bf16 v[88:91], a[64:67], a[84:87], v[88:91]
  v_mfma_f32_16x16x32_bf16 v[84:87], a[60:63], a[84:87], v[84:87]
  v_mfma_f32_16x16x32_bf16 v[80:83], a[56:59], a[84:87], v[80:83]
  v_mfma_f32_16x16x32_bf16 v[96:99], a[56:59], a[88:91], v[96:99]
  v_mfma_f32_16x16x32_bf16 v[100:103], a[60:63], a[88:91], v[100:103]
  v_mfma_f32_16x16x32_bf16 v[104:107], a[64:67], a[88:91], v[104:107]
  v_mfma_f32_16x16x32_bf16 v[108:111], a[68:71], a[88:91], v[108:111]
  v_mfma_f32_16x16x32_bf16 v[124:127], a[68:71], a[92:95], v[124:127]
  v_mfma_f32_16x16x32_bf16 v[120:123], a[64:67], a[92:95], v[120:123]
  v_mfma_f32_16x16x32_bf16 v[116:119], a[60:63], a[92:95], v[116:119]
  v_mfma_f32_16x16x32_bf16 v[112:115], a[56:59], a[92:95], v[112:115]
  v_mfma_f32_16x16x32_bf16 v[128:131], a[56:59], a[96:99], v[128:131]
  v_mfma_f32_16x16x32_bf16 v[132:135], a[60:63], a[96:99], v[132:135]
  v_mfma_f32_16x16x32_bf16 v[136:139], a[64:67], a[96:99], v[136:139]
  v_mfma_f32_16x16x32_bf16 v[140:143], a[68:71], a[96:99], v[140:143]
  v_mfma_f32_16x16x32_bf16 v[156:159], a[68:71], a[100:103], v[156:159]
  v_mfma_f32_16x16x32_bf16 v[152:155], a[64:67], a[100:103], v[152:155]
  v_mfma_f32_16x16x32_bf16 v[148:151], a[60:63], a[100:103], v[148:151]
  v_mfma_f32_16x16x32_bf16 v[144:147], a[56:59], a[100:103], v[144:147]
  v_mfma_f32_16x16x32_bf16 v[160:163], a[104:107], a[108:111], v[160:163]
  s_lshl_b32 s50, s42, 8
  s_lshl_b32 s51, s38, 6
  s_add_u32 s50, s50, s51
  s_mul_i32 s52, s50, 1152
  s_lshl_b32 s50, s55, 8
  s_lshl_b32 s51, s37, 7
  s_add_u32 s50, s50, s51
  s_add_u32 s50, s50, s52
  s_waitcnt vmcnt(0)
  v_fmac_f32 v32, v164, v250
  v_fmac_f32 v33, v165, v250
  v_fmac_f32 v34, v166, v250
  v_fmac_f32 v35, v167, v250
  v_cvt_pk_bf16_f32 v32, v32, v33
  v_cvt_pk_bf16_f32 v33, v34, v35
  ds_write_b64 v244, v[32:33] offset:0
  v_fmac_f32 v36, v168, v250
  v_fmac_f32 v37, v169, v250
  v_fmac_f32 v38, v170, v250
  v_fmac_f32 v39, v171, v250
  v_cvt_pk_bf16_f32 v36, v36, v37
  v_cvt_pk_bf16_f32 v37, v38, v39
  ds_write_b64 v245, v[36:37] offset:0
  v_fmac_f32 v40, v172, v250
  v_fmac_f32 v41, v173, v250
  v_fmac_f32 v42, v174, v250
  v_fmac_f32 v43, v175, v250
  v_cvt_pk_bf16_f32 v40, v40, v41
  v_cvt_pk_bf16_f32 v41, v42, v43
  ds_write_b64 v246, v[40:41] offset:0
  v_fmac_f32 v44, v176, v250
  v_fmac_f32 v45, v177, v250
  v_fmac_f32 v46, v178, v250
  v_fmac_f32 v47, v179, v250
  v_cvt_pk_bf16_f32 v44, v44, v45
  v_cvt_pk_bf16_f32 v45, v46, v47
  ds_write_b64 v247, v[44:45] offset:0
  v_fmac_f32 v48, v164, v250
  v_fmac_f32 v49, v165, v250
  v_fmac_f32 v50, v166, v250
  v_fmac_f32 v51, v167, v250
  v_cvt_pk_bf16_f32 v48, v48, v49
  v_cvt_pk_bf16_f32 v49, v50, v51
  ds_write_b64 v244, v[48:49] offset:2048
  v_fmac_f32 v52, v168, v250
  v_fmac_f32 v53, v169, v250
  v_fmac_f32 v54, v170, v250
  v_fmac_f32 v55, v171, v250
  v_cvt_pk_bf16_f32 v52, v52, v53
  v_cvt_pk_bf16_f32 v53, v54, v55
  ds_write_b64 v245, v[52:53] offset:2048
  v_fmac_f32 v56, v172, v250
  v_fmac_f32 v57, v173, v250
  v_fmac_f32 v58, v174, v250
  v_fmac_f32 v59, v175, v250
  v_cvt_pk_bf16_f32 v56, v56, v57
  v_cvt_pk_bf16_f32 v57, v58, v59
  ds_write_b64 v246, v[56:57] offset:2048
  v_fmac_f32 v60, v176, v250
  v_fmac_f32 v61, v177, v250
  v_fmac_f32 v62, v178, v250
  v_fmac_f32 v63, v179, v250
  v_cvt_pk_bf16_f32 v60, v60, v61
  v_cvt_pk_bf16_f32 v61, v62, v63
  ds_write_b64 v247, v[60:61] offset:2048
  v_fmac_f32 v64, v164, v250
  v_fmac_f32 v65, v165, v250
  v_fmac_f32 v66, v166, v250
  v_fmac_f32 v67, v167, v250
  v_cvt_pk_bf16_f32 v64, v64, v65
  v_cvt_pk_bf16_f32 v65, v66, v67
  ds_write_b64 v244, v[64:65] offset:4096
  v_fmac_f32 v68, v168, v250
  v_fmac_f32 v69, v169, v250
  v_fmac_f32 v70, v170, v250
  v_fmac_f32 v71, v171, v250
  v_cvt_pk_bf16_f32 v68, v68, v69
  v_cvt_pk_bf16_f32 v69, v70, v71
  ds_write_b64 v245, v[68:69] offset:4096
  v_fmac_f32 v72, v172, v250
  v_fmac_f32 v73, v173, v250
  v_fmac_f32 v74, v174, v250
  v_fmac_f32 v75, v175, v250
  v_cvt_pk_bf16_f32 v72, v72, v73
  v_cvt_pk_bf16_f32 v73, v74, v75
  ds_write_b64 v246, v[72:73] offset:4096
  v_fmac_f32 v76, v176, v250
  v_fmac_f32 v77, v177, v250
  v_fmac_f32 v78, v178, v250
  v_fmac_f32 v79, v179, v250
  v_cvt_pk_bf16_f32 v76, v76, v77
  v_cvt_pk_bf16_f32 v77, v78, v79
  ds_write_b64 v247, v[76:77] offset:4096
  v_fmac_f32 v80, v164, v250
  v_fmac_f32 v81, v165, v250
  v_fmac_f32 v82, v166, v250
  v_fmac_f32 v83, v167, v250
  v_cvt_pk_bf16_f32 v80, v80, v81
  v_cvt_pk_bf16_f32 v81, v82, v83
  ds_write_b64 v244, v[80:81] offset:6144
  v_fmac_f32 v84, v168, v250
  v_fmac_f32 v85, v169, v250
  v_fmac_f32 v86, v170, v250
  v_fmac_f32 v87, v171, v250
  v_cvt_pk_bf16_f32 v84, v84, v85
  v_cvt_pk_bf16_f32 v85, v86, v87
  ds_write_b64 v245, v[84:85] offset:6144
  v_fmac_f32 v88, v172, v250
  v_fmac_f32 v89, v173, v250
  v_fmac_f32 v90, v174, v250
  v_fmac_f32 v91, v175, v250
  v_cvt_pk_bf16_f32 v88, v88, v89
  v_cvt_pk_bf16_f32 v89, v90, v91
  ds_write_b64 v246, v[88:89] offset:6144
  v_fmac_f32 v92, v176, v250
  v_fmac_f32 v93, v177, v250
  v_fmac_f32 v94, v178, v250
  v_fmac_f32 v95, v179, v250
  v_cvt_pk_bf16_f32 v92, v92, v93
  v_cvt_pk_bf16_f32 v93, v94, v95
  ds_write_b64 v247, v[92:93] offset:6144
  s_waitcnt lgkmcnt(0)
  ds_read_b128 v[212:215], v248 offset:0
  ds_read_b128 v[216:219], v248 offset:1024
  ds_read_b128 v[220:223], v248 offset:2048
  ds_read_b128 v[224:227], v248 offset:3072
  ds_read_b128 v[228:231], v248 offset:4096
  ds_read_b128 v[232:235], v248 offset:5120
  ds_read_b128 v[236:239], v248 offset:6144
  ds_read_b128 v[240:243], v248 offset:7168
  s_add_u32 s51, s50, 0
  s_waitcnt lgkmcnt(7)
  buffer_store_dwordx4 v[212:215], v249, s[8:11], s51 offen sc1
  s_add_u32 s51, s50, 9216
  s_waitcnt lgkmcnt(6)
  buffer_store_dwordx4 v[216:219], v249, s[8:11], s51 offen sc1
  s_add_u32 s51, s50, 18432
  s_waitcnt lgkmcnt(5)
  buffer_store_dwordx4 v[220:223], v249, s[8:11], s51 offen sc1
  s_add_u32 s51, s50, 27648
  s_waitcnt lgkmcnt(4)
  buffer_store_dwordx4 v[224:227], v249, s[8:11], s51 offen sc1
  s_add_u32 s51, s50, 36864
  s_waitcnt lgkmcnt(3)
  buffer_store_dwordx4 v[228:231], v249, s[8:11], s51 offen sc1
  s_add_u32 s51, s50, 46080
  s_waitcnt lgkmcnt(2)
  buffer_store_dwordx4 v[232:235], v249, s[8:11], s51 offen sc1
  s_add_u32 s51, s50, 55296
  s_waitcnt lgkmcnt(1)
  buffer_store_dwordx4 v[236:239], v249, s[8:11], s51 offen sc1
  s_add_u32 s51, s50, 64512
  s_waitcnt lgkmcnt(0)
  buffer_store_dwordx4 v[240:243], v249, s[8:11], s51 offen sc1
  v_fmac_f32 v96, v164, v250
  v_fmac_f32 v97, v165, v250
  v_fmac_f32 v98, v166, v250
  v_fmac_f32 v99, v167, v250
  v_cvt_pk_bf16_f32 v96, v96, v97
  v_cvt_pk_bf16_f32 v97, v98, v99
  ds_write_b64 v244, v[96:97] offset:0
  v_fmac_f32 v100, v168, v250
  v_fmac_f32 v101, v169, v250
  v_fmac_f32 v102, v170, v250
  v_fmac_f32 v103, v171, v250
  v_cvt_pk_bf16_f32 v100, v100, v101
  v_cvt_pk_bf16_f32 v101, v102, v103
  ds_write_b64 v245, v[100:101] offset:0
  v_fmac_f32 v104, v172, v250
  v_fmac_f32 v105, v173, v250
  v_fmac_f32 v106, v174, v250
  v_fmac_f32 v107, v175, v250
  v_cvt_pk_bf16_f32 v104, v104, v105
  v_cvt_pk_bf16_f32 v105, v106, v107
  ds_write_b64 v246, v[104:105] offset:0
  v_fmac_f32 v108, v176, v250
  v_fmac_f32 v109, v177, v250
  v_fmac_f32 v110, v178, v250
  v_fmac_f32 v111, v179, v250
  v_cvt_pk_bf16_f32 v108, v108, v109
  v_cvt_pk_bf16_f32 v109, v110, v111
  ds_write_b64 v247, v[108:109] offset:0
  v_fmac_f32 v112, v164, v250
  v_fmac_f32 v113, v165, v250
  v_fmac_f32 v114, v166, v250
  v_fmac_f32 v115, v167, v250
  v_cvt_pk_bf16_f32 v112, v112, v113
  v_cvt_pk_bf16_f32 v113, v114, v115
  ds_write_b64 v244, v[112:113] offset:2048
  v_fmac_f32 v116, v168, v250
  v_fmac_f32 v117, v169, v250
  v_fmac_f32 v118, v170, v250
  v_fmac_f32 v119, v171, v250
  v_cvt_pk_bf16_f32 v116, v116, v117
  v_cvt_pk_bf16_f32 v117, v118, v119
  ds_write_b64 v245, v[116:117] offset:2048
  v_fmac_f32 v120, v172, v250
  v_fmac_f32 v121, v173, v250
  v_fmac_f32 v122, v174, v250
  v_fmac_f32 v123, v175, v250
  v_cvt_pk_bf16_f32 v120, v120, v121
  v_cvt_pk_bf16_f32 v121, v122, v123
  ds_write_b64 v246, v[120:121] offset:2048
  v_fmac_f32 v124, v176, v250
  v_fmac_f32 v125, v177, v250
  v_fmac_f32 v126, v178, v250
  v_fmac_f32 v127, v179, v250
  v_cvt_pk_bf16_f32 v124, v124, v125
  v_cvt_pk_bf16_f32 v125, v126, v127
  ds_write_b64 v247, v[124:125] offset:2048
  v_fmac_f32 v128, v164, v250
  v_fmac_f32 v129, v165, v250
  v_fmac_f32 v130, v166, v250
  v_fmac_f32 v131, v167, v250
  v_cvt_pk_bf16_f32 v128, v128, v129
  v_cvt_pk_bf16_f32 v129, v130, v131
  ds_write_b64 v244, v[128:129] offset:4096
  v_fmac_f32 v132, v168, v250
  v_fmac_f32 v133, v169, v250
  v_fmac_f32 v134, v170, v250
  v_fmac_f32 v135, v171, v250
  v_cvt_pk_bf16_f32 v132, v132, v133
  v_cvt_pk_bf16_f32 v133, v134, v135
  ds_write_b64 v245, v[132:133] offset:4096
  v_fmac_f32 v136, v172, v250
  v_fmac_f32 v137, v173, v250
  v_fmac_f32 v138, v174, v250
  v_fmac_f32 v139, v175, v250
  v_cvt_pk_bf16_f32 v136, v136, v137
  v_cvt_pk_bf16_f32 v137, v138, v139
  ds_write_b64 v246, v[136:137] offset:4096
  v_fmac_f32 v140, v176, v250
  v_fmac_f32 v141, v177, v250
  v_fmac_f32 v142, v178, v250
  v_fmac_f32 v143, v179, v250
  v_cvt_pk_bf16_f32 v140, v140, v141
  v_cvt_pk_bf16_f32 v141, v142, v143
  ds_write_b64 v247, v[140:141] offset:4096
  v_fmac_f32 v144, v164, v250
  v_fmac_f32 v145, v165, v250
  v_fmac_f32 v146, v166, v250
  v_fmac_f32 v147, v167, v250
  v_cvt_pk_bf16_f32 v144, v144, v145
  v_cvt_pk_bf16_f32 v145, v146, v147
  ds_write_b64 v244, v[144:145] offset:6144
  v_fmac_f32 v148, v168, v250
  v_fmac_f32 v149, v169, v250
  v_fmac_f32 v150, v170, v250
  v_fmac_f32 v151, v171, v250
  v_cvt_pk_bf16_f32 v148, v148, v149
  v_cvt_pk_bf16_f32 v149, v150, v151
  ds_write_b64 v245, v[148:149] offset:6144
  v_fmac_f32 v152, v172, v250
  v_fmac_f32 v153, v173, v250
  v_fmac_f32 v154, v174, v250
  v_fmac_f32 v155, v175, v250
  v_cvt_pk_bf16_f32 v152, v152, v153
  v_cvt_pk_bf16_f32 v153, v154, v155
  ds_write_b64 v246, v[152:153] offset:6144
  v_fmac_f32 v156, v176, v250
  v_fmac_f32 v157, v177, v250
  v_fmac_f32 v158, v178, v250
  v_fmac_f32 v159, v179, v250
  v_cvt_pk_bf16_f32 v156, v156, v157
  v_cvt_pk_bf16_f32 v157, v158, v159
  ds_write_b64 v247, v[156:157] offset:6144
  s_waitcnt lgkmcnt(0)
  ds_read_b128 v[212:215], v248 offset:0
  ds_read_b128 v[216:219], v248 offset:1024
  ds_read_b128 v[220:223], v248 offset:2048
  ds_read_b128 v[224:227], v248 offset:3072
  ds_read_b128 v[228:231], v248 offset:4096
  ds_read_b128 v[232:235], v248 offset:5120
  ds_read_b128 v[236:239], v248 offset:6144
  ds_read_b128 v[240:243], v248 offset:7168
  s_add_u32 s51, s50, 147456
  s_waitcnt lgkmcnt(7)
  buffer_store_dwordx4 v[212:215], v249, s[8:11], s51 offen sc1
  s_add_u32 s51, s50, 156672
  s_waitcnt lgkmcnt(6)
  buffer_store_dwordx4 v[216:219], v249, s[8:11], s51 offen sc1
  s_add_u32 s51, s50, 165888
  s_waitcnt lgkmcnt(5)
  buffer_store_dwordx4 v[220:223], v249, s[8:11], s51 offen sc1
  s_add_u32 s51, s50, 175104
  s_waitcnt lgkmcnt(4)
  buffer_store_dwordx4 v[224:227], v249, s[8:11], s51 offen sc1
  s_add_u32 s51, s50, 184320
  s_waitcnt lgkmcnt(3)
  buffer_store_dwordx4 v[228:231], v249, s[8:11], s51 offen sc1
  s_add_u32 s51, s50, 193536
  s_waitcnt lgkmcnt(2)
  buffer_store_dwordx4 v[232:235], v249, s[8:11], s51 offen sc1
  s_add_u32 s51, s50, 202752
  s_waitcnt lgkmcnt(1)
  buffer_store_dwordx4 v[236:239], v249, s[8:11], s51 offen sc1
  s_add_u32 s51, s50, 211968
  s_waitcnt lgkmcnt(0)
  buffer_store_dwordx4 v[240:243], v249, s[8:11], s51 offen sc1
  v_fmac_f32 v160, v180, v250
  s_cmp_eq_u32 s54, 0
  s_cselect_b32 s46, -1, 0
  v_cvt_pk_bf16_f32 v16, v160, v160
  v_and_b32 v16, s46, v16
  s_lshr_b32 s46, s62, 2
  s_lshl_b32 s46, s46, 7
  s_and_b32 s47, s62, 3
  s_lshl_b32 s47, s47, 4
  s_add_u32 s46, s46, s47
  s_mul_i32 s46, s46, 1152
  s_add_u32 s46, s46, s52
  v_and_b32 v16, 0xffff, v16
  v_lshrrev_b32 v17, 3, v1
  v_lshlrev_b32 v17, 2, v17
  v_add_u32 v18, 32, v17
  v_and_b32 v19, 7, v1
  v_cmp_eq_u32 vcc, 0, v19
  ds_bpermute_b32 v4, v17, v16
  ds_bpermute_b32 v8, v18, v16
  v_mov_b32 v5, 0
  v_mov_b32 v6, 0
  v_mov_b32 v7, 0
  v_mov_b32 v9, 0
  v_mov_b32 v10, 0
  v_mov_b32 v11, 0
  s_waitcnt lgkmcnt(0)
  v_cndmask_b32 v4, 0, v4, vcc
  v_cndmask_b32 v8, 0, v8, vcc
  s_add_u32 s47, s46, 9216
  buffer_store_dwordx4 v[4:7], v249, s[8:11], s46 offen offset:1024 sc1
  buffer_store_dwordx4 v[8:11], v249, s[8:11], s47 offen offset:1024 sc1
  s_cmp_lg_u32 s42, 0
  s_cbranch_scc1 L_f2_done
  s_cmp_ge_u32 s3, 2
  s_cbranch_scc1 L_f2_corner
  v_add_f32 v192, v192, v184
  v_add_f32 v192, v192, v185
  v_add_f32 v192, v192, v186
  v_add_f32 v192, v192, v187
  v_add_f32 v192, v192, v188
  v_add_f32 v192, v192, v189
  v_add_f32 v192, v192, v190
  v_add_f32 v192, v192, v191
  v_cvt_pk_bf16_f32 v12, v192, v192
  v_lshrrev_b32 v2, 1, v253
  s_mov_b32 s51, 1179648
  buffer_store_short v12, v2, s[8:11], s51 offen sc1
  s_branch L_f2_done
L_f2_corner:
  s_cmp_lg_u32 s3, 2
  s_cbranch_scc1 L_f2_done
  s_cmp_lg_u32 s55, 0
  s_cbranch_scc1 L_f2_done
  v_pk_add_f32 v[196:197], v[196:197], v[198:199]
  v_pk_add_f32 v[196:197], v[196:197], v[200:201]
  v_pk_add_f32 v[196:197], v[196:197], v[202:203]
  v_pk_add_f32 v[196:197], v[196:197], v[204:205]
  v_pk_add_f32 v[196:197], v[196:197], v[206:207]
  v_pk_add_f32 v[196:197], v[196:197], v[208:209]
  v_pk_add_f32 v[196:197], v[196:197], v[210:211]
  v_sub_f32 v4, v196, v197
  s_nop 1
  v_add_f32_dpp v4, v4, v4 quad_perm:[1,0,3,2] row_mask:0xf bank_mask:0xf
  s_nop 1
  v_add_f32_dpp v4, v4, v4 quad_perm:[2,3,0,1] row_mask:0xf bank_mask:0xf
  s_nop 1
  v_add_f32_dpp v4, v4, v4 row_half_mirror row_mask:0xf bank_mask:0xf
  s_nop 1
  v_add_f32_dpp v4, v4, v4 row_mirror row_mask:0xf bank_mask:0xf
  s_nop 1
  v_add_f32_dpp v4, v4, v4 row_bcast:15 row_mask:0xa bank_mask:0xf
  s_nop 1
  v_add_f32_dpp v4, v4, v4 row_bcast:31 row_mask:0xc bank_mask:0xf
  s_nop 1
  v_readlane_b32 s50, v4, 63
  s_mov_b32 s51, 1180672
  s_nop 0
  v_add_f32 v4, s50, v180
  v_cvt_pk_bf16_f32 v12, v4, v4
  v_lshlrev_b32 v2, 2, v1
  s_mov_b64 exec, 0xffffffff
  buffer_store_dword v12, v2, s[8:11], s51 offen sc1
  s_mov_b64 exec, -1
L_f2_done:
  s_nop 1
  v_lshlrev_b32 v18, 4, v1
  s_mul_i32 s39, s3, 4096
  v_add_u32 v18, s39, v18
  s_mov_b32 s32, 0
  s_add_u32 s39, s58, 0
  s_and_b32 s39, s39, 3
  s_lshl_b32 s39, s39, 10
  v_add_u32 v12, s39, v18
  s_add_u32 s39, s58, 1
  s_and_b32 s39, s39, 3
  s_lshl_b32 s39, s39, 10
  v_add_u32 v13, s39, v18
  s_add_u32 s39, s58, 2
  s_and_b32 s39, s39, 3
  s_lshl_b32 s39, s39, 10
  v_add_u32 v14, s39, v18
  s_add_u32 s39, s58, 3
  s_and_b32 s39, s39, 3
  s_lshl_b32 s39, s39, 10
  v_add_u32 v15, s39, v18
  v_bfe_u32 v19, v1, 2, 3
  v_lshrrev_b32 v20, 5, v1
  v_lshlrev_b32 v20, 11, v20
  v_lshl_add_u32 v20, v19, 8, v20
  v_and_b32 v21, 3, v1
  v_lshl_add_u32 v20, v21, 3, v20
  v_lshl_add_u32 v20, v19, 5, v20
  v_xor_b32 v4, 0, v20
  v_xor_b32 v5, 32, v20
  v_xor_b32 v6, 64, v20
  v_xor_b32 v7, 96, v20
  v_xor_b32 v8, 128, v20
  v_xor_b32 v9, 160, v20
  v_xor_b32 v10, 192, v20
  v_xor_b32 v11, 224, v20
  s_mul_i32 s44, s56, 1835008
  s_mul_i32 s45, s58, 458752
  s_add_u32 s44, s44, s45
  s_add_u32 s8, s86, s44
  s_addc_u32 s9, s87, 0
  s_add_u32 s8, s8, 0x400000
  s_addc_u32 s9, s9, 0
  s_mov_b32 s10, 0x70000
  s_mov_b32 s11, 0x20000
  s_mul_i32 s44, s56, 28
  s_mul_i32 s45, s58, 7
  s_add_u32 s44, s44, s45
  v_and_b32 v26, 7, v1
  v_min_u32 v26, 6, v26
  v_add_u32 v26, s44, v26
  v_lshlrev_b32 v26, 7, v26
  v_bfe_u32 v18, v1, 3, 1
  v_lshl_add_u32 v26, v18, 2, v26
  s_mov_b32 s101, 0x80000
  s_mov_b32 s47, 0
  s_mov_b32 s97, 0x7f
  v_mov_b32 v30, 0
  v_mov_b32 v16, 0x27ff0
  s_cmp_eq_u32 s3, 0
  s_cselect_b32 s44, 0, 0x80000000
  v_or_b32 v26, s44, v26
  s_mul_i32 s55, s3, 12288
  s_add_u32 s55, s55, 0x8000
  s_lshl_b32 s54, s56, 8
  s_lshl_b32 s44, s3, 6
  s_add_u32 s54, s54, s44
  s_lshl_b32 s44, s58, 4
  s_add_u32 s54, s54, s44
  v_lshrrev_b32 v18, 4, v1
  v_and_b32 v19, 15, v1
  s_cmp_ge_u32 s56, 4
  s_cselect_b64 s[62:63], -1, 0
  v_mov_b32 v28, 0x400
  v_add_u32 v20, 0, v18
  v_xor_b32 v21, v20, v19
  v_lshlrev_b32 v21, 4, v21
  v_add_u32 v21, 4096, v21
  v_add_u32 v20, s54, v20
  v_cmp_eq_u32 vcc, v20, v28
  v_sub_u32 v160, 0xc00, v20
  v_and_b32 v164, 0x3ff, v20
  v_cndmask_b32 v160, v20, v160, s[62:63]
  v_cndmask_b32 v160, v160, v28, vcc
  v_cndmask_b32 v164, v164, v28, vcc
  v_lshlrev_b32 v160, 11, v160
  v_lshl_add_u32 v188, v19, 4, v160
  v_add_u32 v160, v160, v21
  v_mul_u32_u24 v164, 1152, v164
  v_add_u32 v164, v164, v21
  v_add_u32 v20, 4, v18
  v_xor_b32 v21, v20, v19
  v_lshlrev_b32 v21, 4, v21
  v_add_u32 v21, 3072, v21
  v_add_u32 v20, s54, v20
  v_cmp_eq_u32 vcc, v20, v28
  v_sub_u32 v161, 0xc00, v20
  v_and_b32 v165, 0x3ff, v20
  v_cndmask_b32 v161, v20, v161, s[62:63]
  v_cndmask_b32 v161, v161, v28, vcc
  v_cndmask_b32 v165, v165, v28, vcc
  v_lshlrev_b32 v161, 11, v161
  v_lshl_add_u32 v189, v19, 4, v161
  v_add_u32 v161, v161, v21
  v_mul_u32_u24 v165, 1152, v165
  v_add_u32 v165, v165, v21
  v_add_u32 v20, 8, v18
  v_xor_b32 v21, v20, v19
  v_lshlrev_b32 v21, 4, v21
  v_add_u32 v21, 2048, v21
  v_add_u32 v20, s54, v20
  v_cmp_eq_u32 vcc, v20, v28
  v_sub_u32 v162, 0xc00, v20
  v_and_b32 v166, 0x3ff, v20
  v_cndmask_b32 v162, v20, v162, s[62:63]
  v_cndmask_b32 v162, v162, v28, vcc
  v_cndmask_b32 v166, v166, v28, vcc
  v_lshlrev_b32 v162, 11, v162
  v_lshl_add_u32 v190, v19, 4, v162
  v_add_u32 v162, v162, v21
  v_mul_u32_u24 v166, 1152, v166
  v_add_u32 v166, v166, v21
  v_add_u32 v20, 12, v18
  v_xor_b32 v21, v20, v19
  v_lshlrev_b32 v21, 4, v21
  v_add_u32 v21, 1024, v21
  v_add_u32 v20, s54, v20
  v_cmp_eq_u32 vcc, v20, v28
  v_sub_u32 v163, 0xc00, v20
  v_and_b32 v167, 0x3ff, v20
  v_cndmask_b32 v163, v20, v163, s[62:63]
  v_cndmask_b32 v163, v163, v28, vcc
  v_cndmask_b32 v167, v167, v28, vcc
  v_lshlrev_b32 v163, 11, v163
  v_lshl_add_u32 v191, v19, 4, v163
  v_add_u32 v163, v163, v21
  v_mul_u32_u24 v167, 1152, v167
  v_add_u32 v167, v167, v21
  s_lshl_b32 s61, s57, 8
  s_sub_u32 s45, 4198400, s61
  s_add_u32 s12, s64, s61
  s_addc_u32 s13, s65, 0
  s_sub_u32 s12, s12, 0x1000
  s_subb_u32 s13, s13, 0
  s_mov_b32 s14, s45
  s_mov_b32 s15, 0x20000
  s_add_u32 m0, s55, 0
  s_nop 0
  buffer_load_dwordx4 v160, s[12:15], 0 offen offset:0 lds
  buffer_load_dwordx4 v161, s[12:15], 0 offen offset:1024 lds
  buffer_load_dwordx4 v162, s[12:15], 0 offen offset:2048 lds
  buffer_load_dwordx4 v163, s[12:15], 0 offen offset:3072 lds
  s_sub_u32 s48, 1794, s61
  s_cmp_ge_u32 s57, 4
  s_cselect_b32 s44, s48, s61
  s_cselect_b32 s48, 248, 0
  s_cselect_b32 s49, -1, 0
  s_sub_u32 s45, 1184896, s44
  s_add_u32 s12, s86, s44
  s_addc_u32 s13, s87, 0
  s_add_u32 s12, s12, 0x16ff000
  s_addc_u32 s13, s13, 0
  s_mov_b32 s14, s45
  s_mov_b32 s15, 0x20000
  s_add_u32 s16, s86, s44
  s_addc_u32 s17, s87, 0
  s_add_u32 s16, s16, 0x18ff000
  s_addc_u32 s17, s17, 0
  s_mov_b32 s18, s45
  s_mov_b32 s19, 0x20000
  s_xor_b32 s62, s62, s49
  s_cmp_lg_u32 s62, 0
  s_cselect_b32 s62, 1.0, -1.0
  s_mov_b32 s63, s62
  v_and_b32 v18, 15, v1
  v_lshrrev_b32 v19, 5, v1
  v_xor_b32 v19, v19, v18
  v_lshlrev_b32 v19, 4, v19
  v_lshl_add_u32 v19, v18, 8, v19
  v_bfe_u32 v20, v1, 4, 1
  v_lshl_add_u32 v19, v20, 3, v19
  v_xor_b32 v20, 0, v19
  v_add_u32 v168, s55, v20
  v_xor_b32 v20, s48, v20
  v_add_u32 v176, s55, v20
  v_xor_b32 v20, 32, v19
  v_add_u32 v169, s55, v20
  v_xor_b32 v20, s48, v20
  v_add_u32 v177, s55, v20
  v_xor_b32 v20, 64, v19
  v_add_u32 v170, s55, v20
  v_xor_b32 v20, s48, v20
  v_add_u32 v178, s55, v20
  v_xor_b32 v20, 96, v19
  v_add_u32 v171, s55, v20
  v_xor_b32 v20, s48, v20
  v_add_u32 v179, s55, v20
  v_xor_b32 v20, 128, v19
  v_add_u32 v172, s55, v20
  v_xor_b32 v20, s48, v20
  v_add_u32 v180, s55, v20
  v_xor_b32 v20, 160, v19
  v_add_u32 v173, s55, v20
  v_xor_b32 v20, s48, v20
  v_add_u32 v181, s55, v20
  v_xor_b32 v20, 192, v19
  v_add_u32 v174, s55, v20
  v_xor_b32 v20, s48, v20
  v_add_u32 v182, s55, v20
  v_xor_b32 v20, 224, v19
  v_add_u32 v175, s55, v20
  v_xor_b32 v20, s48, v20
  v_add_u32 v183, s55, v20
  v_lshrrev_b32 v18, 4, v1
  v_and_b32 v19, 15, v1
  v_add_u32 v21, 0, v18
  v_xor_b32 v20, v21, v19
  v_lshlrev_b32 v20, 4, v20
  v_lshl_add_u32 v20, v21, 8, v20
  v_add_u32 v184, s55, v20
  v_add_u32 v21, 4, v18
  v_xor_b32 v20, v21, v19
  v_lshlrev_b32 v20, 4, v20
  v_lshl_add_u32 v20, v21, 8, v20
  v_add_u32 v185, s55, v20
  v_add_u32 v21, 8, v18
  v_xor_b32 v20, v21, v19
  v_lshlrev_b32 v20, 4, v20
  v_lshl_add_u32 v20, v21, 8, v20
  v_add_u32 v186, s55, v20
  v_add_u32 v21, 12, v18
  v_xor_b32 v20, v21, v19
  v_lshlrev_b32 v20, 4, v20
  v_lshl_add_u32 v20, v21, 8, v20
  v_add_u32 v187, s55, v20
  s_lshl_b32 s44, s56, 3
  s_add_u32 s44, s44, s57
  s_mul_i32 s44, s44, 196608
  s_lshl_b32 s45, s3, 12
  s_add_u32 s44, s44, s45
  s_add_u32 s24, s86, s44
  s_addc_u32 s25, s87, 0
  s_add_u32 s24, s24, 0x2000000
  s_addc_u32 s25, s25, 0
  s_mov_b32 s26, 0x30000
  s_mov_b32 s27, 0x20000
  s_add_u32 s50, s58, 1
  s_and_b32 s50, s50, 3
  s_mul_i32 s50, s50, 49152
  s_add_u32 s50, s50, 0
  s_add_u32 s51, s58, 2
  s_and_b32 s51, s51, 3
  s_mul_i32 s51, s51, 49152
  s_add_u32 s51, s51, 16384
  s_add_u32 s52, s58, 3
  s_and_b32 s52, s52, 3
  s_mul_i32 s52, s52, 49152
  s_add_u32 s52, s52, 32768
  s_mul_i32 s53, s58, 49152
  v_lshlrev_b32 v29, 4, v1
  v_and_b32 v22, 31, v1
  v_add_u32 v22, 224, v22
  v_lshlrev_b32 v22, 7, v22
  v_lshrrev_b32 v23, 5, v1
  v_lshl_add_u32 v22, v23, 2, v22
  s_cmp_lt_u32 s42, 4
  s_cselect_b32 s44, 8, 7
  v_lshrrev_b32 v23, 1, v1
  v_min_u32 v23, 2, v23
  v_add_u32 v23, 1, v23
  v_add_u32 v23, s58, v23
  v_and_b32 v23, 3, v23
  s_mul_i32 s45, s58, s44
  s_sub_u32 s45, s43, s45
  v_mul_u32_u24 v23, s44, v23
  v_add_u32 v23, s45, v23
  v_lshlrev_b32 v23, 7, v23
  s_lshl_b32 s44, s3, 3
  s_add_u32 s44, s44, 16
  v_and_b32 v27, 1, v1
  v_lshl_add_u32 v27, v27, 2, s44
  v_add_u32 v23, v27, v23
  s_lshl_b32 s45, s43, 7
  v_add_u32 v27, s45, v27
  v_mov_b32 v32, 0
  v_mov_b32 v33, 0
  v_mov_b32 v34, 0
  v_mov_b32 v35, 0
  v_mov_b32 v36, 0
  v_mov_b32 v37, 0
  v_mov_b32 v38, 0
  v_mov_b32 v39, 0
  v_mov_b32 v40, 0
  v_mov_b32 v41, 0
  v_mov_b32 v42, 0
  v_mov_b32 v43, 0
  v_mov_b32 v44, 0
  v_mov_b32 v45, 0
  v_mov_b32 v46, 0
  v_mov_b32 v47, 0
  v_mov_b32 v48, 0
  v_mov_b32 v49, 0
  v_mov_b32 v50, 0
  v_mov_b32 v51, 0
  v_mov_b32 v52, 0
  v_mov_b32 v53, 0
  v_mov_b32 v54, 0
  v_mov_b32 v55, 0
  v_mov_b32 v56, 0
  v_mov_b32 v57, 0
  v_mov_b32 v58, 0
  v_mov_b32 v59, 0
  v_mov_b32 v60, 0
  v_mov_b32 v61, 0
  v_mov_b32 v62, 0
  v_mov_b32 v63, 0
  v_mov_b32 v64, 0
  v_mov_b32 v65, 0
  v_mov_b32 v66, 0
  v_mov_b32 v67, 0
  v_mov_b32 v68, 0
  v_mov_b32 v69, 0
  v_mov_b32 v70, 0
  v_mov_b32 v71, 0
  v_mov_b32 v72, 0
  v_mov_b32 v73, 0
  v_mov_b32 v74, 0
  v_mov_b32 v75, 0
  v_mov_b32 v76, 0
  v_mov_b32 v77, 0
  v_mov_b32 v78, 0
  v_mov_b32 v79, 0
  v_mov_b32 v80, 0
  v_mov_b32 v81, 0
  v_mov_b32 v82, 0
  v_mov_b32 v83, 0
  v_mov_b32 v84, 0
  v_mov_b32 v85, 0
  v_mov_b32 v86, 0
  v_mov_b32 v87, 0
  v_mov_b32 v88, 0
  v_mov_b32 v89, 0
  v_mov_b32 v90, 0
  v_mov_b32 v91, 0
  v_mov_b32 v92, 0
  v_mov_b32 v93, 0
  v_mov_b32 v94, 0
  v_mov_b32 v95, 0
  v_mov_b32 v96, 0
  v_mov_b32 v97, 0
  v_mov_b32 v98, 0
  v_mov_b32 v99, 0
  v_mov_b32 v100, 0
  v_mov_b32 v101, 0
  v_mov_b32 v102, 0
  v_mov_b32 v103, 0
  v_mov_b32 v104, 0
  v_mov_b32 v105, 0
  v_mov_b32 v106, 0
  v_mov_b32 v107, 0
  v_mov_b32 v108, 0
  v_mov_b32 v109, 0
  v_mov_b32 v110, 0
  v_mov_b32 v111, 0
  v_mov_b32 v112, 0
  v_mov_b32 v113, 0
  v_mov_b32 v114, 0
  v_mov_b32 v115, 0
  v_mov_b32 v116, 0
  v_mov_b32 v117, 0
  v_mov_b32 v118, 0
  v_mov_b32 v119, 0
  v_mov_b32 v120, 0
  v_mov_b32 v121, 0
  v_mov_b32 v122, 0
  v_mov_b32 v123, 0
  v_mov_b32 v124, 0
  v_mov_b32 v125, 0
  v_mov_b32 v126, 0
  v_mov_b32 v127, 0
  v_mov_b32 v128, 0
  v_mov_b32 v129, 0
  v_mov_b32 v130, 0
  v_mov_b32 v131, 0
  v_mov_b32 v132, 0
  v_mov_b32 v133, 0
  v_mov_b32 v134, 0
  v_mov_b32 v135, 0
  v_mov_b32 v136, 0
  v_mov_b32 v137, 0
  v_mov_b32 v138, 0
  v_mov_b32 v139, 0
  v_mov_b32 v140, 0
  v_mov_b32 v141, 0
  v_mov_b32 v142, 0
  v_mov_b32 v143, 0
  v_mov_b32 v144, 0
  v_mov_b32 v145, 0
  v_mov_b32 v146, 0
  v_mov_b32 v147, 0
  v_mov_b32 v148, 0
  v_mov_b32 v149, 0
  v_mov_b32 v150, 0
  v_mov_b32 v151, 0
  v_mov_b32 v152, 0
  v_mov_b32 v153, 0
  v_mov_b32 v154, 0
  v_mov_b32 v155, 0
  v_mov_b32 v156, 0
  v_mov_b32 v157, 0
  v_mov_b32 v158, 0
  v_mov_b32 v159, 0
  s_waitcnt vmcnt(0)
  s_barrier
  s_cmp_lg_u32 s3, 0
  s_cbranch_scc1 pub_21
  s_lshl_b32 s4, s43, 7
  s_add_u32 s5, s100, 3
  v_lshl_add_u32 v18, v1, 2, s4
  v_mov_b32 v19, s5
  s_mov_b64 exec, 0xffffffff
  buffer_store_dword v19, v18, s[28:31], 0 offen sc1
  s_mov_b64 exec, -1
pub_21:
  s_cmp_lg_u32 s3, 0
  s_cbranch_scc1 tpx_25
  s_cmp_eq_u32 s47, 0x7f
  s_cbranch_scc1 tpd_23
  s_branch tpc_24
tp_22:
  buffer_load_dword v30, v26, s[28:31], 0 offen sc1
  s_waitcnt vmcnt(0)
tpc_24:
  v_subrev_u32 v30, s100, v30
  v_subrev_u32 v30, 2, v30
  v_cmp_lt_u32 vcc, 7, v30
  s_lshr_b32 s4, vcc_lo, 8
  s_or_b32 s4, s4, vcc_lo
  s_sub_u32 s101, s101, 1
  s_cselect_b32 s4, 0, s4
  s_andn2_b32 s4, 0x7f, s4
  s_or_b32 s47, s47, s4
  s_and_b32 s4, s47, s97
  s_cbranch_scc0 tp_22
tpd_23:
  s_and_b32 s4, s47, s97
  s_ff1_i32_b32 s4, s4
  s_bitset0_b32 s97, s4
  v_mov_b32 v17, s4
  ds_write_b32 v16, v17 offset:4
  s_waitcnt lgkmcnt(0)
tpx_25:
  s_barrier
  ds_read_b32 v17, v16 offset:4
  s_waitcnt lgkmcnt(0)
  v_readfirstlane_b32 s99, v17
  s_lshl_b32 s59, s99, 18
  s_add_u32 s59, s59, s96
  s_lshl_b32 s32, s99, 16
  s_add_u32 m0, s60, 0
  s_nop 0
  buffer_load_dwordx4 v24, s[20:23], s59 offen offset:0 lds
  buffer_load_dwordx4 v25, s[20:23], s59 offen offset:1024 lds
  s_add_u32 s59, s59, 65536
  buffer_load_dwordx4 a[128:131], v12, s[8:11], s32 offen
  buffer_load_dwordx4 a[132:135], v13, s[8:11], s32 offen
  buffer_load_dwordx4 a[136:139], v14, s[8:11], s32 offen
  buffer_load_dwordx4 a[140:143], v15, s[8:11], s32 offen
  s_add_u32 s32, s32, 16384
  s_add_u32 m0, s60, 8192
  s_nop 0
  buffer_load_dwordx4 v24, s[20:23], s59 offen offset:0 lds
  buffer_load_dwordx4 v25, s[20:23], s59 offen offset:1024 lds
  s_add_u32 s59, s59, 65536
  buffer_load_dwordx4 a[144:147], v12, s[8:11], s32 offen
  buffer_load_dwordx4 a[148:151], v13, s[8:11], s32 offen
  buffer_load_dwordx4 a[152:155], v14, s[8:11], s32 offen
  buffer_load_dwordx4 a[156:159], v15, s[8:11], s32 offen
  s_add_u32 s32, s32, 16384
  s_add_u32 m0, s60, 16384
  s_nop 0
  buffer_load_dwordx4 v24, s[20:23], s59 offen offset:0 lds
  buffer_load_dwordx4 v25, s[20:23], s59 offen offset:1024 lds
  s_add_u32 s59, s59, 65536
  buffer_load_dwordx4 a[160:163], v12, s[8:11], s32 offen
  buffer_load_dwordx4 a[164:167], v13, s[8:11], s32 offen
  buffer_load_dwordx4 a[168:171], v14, s[8:11], s32 offen
  buffer_load_dwordx4 a[172:175], v15, s[8:11], s32 offen
  s_add_u32 s32, s32, 16384
  s_add_u32 m0, s60, 24576
  s_nop 0
  buffer_load_dwordx4 v24, s[20:23], s59 offen offset:0 lds
  buffer_load_dwordx4 v25, s[20:23], s59 offen offset:1024 lds
  s_add_u32 s59, s59, 65536
  s_mov_b32 s46, 6
L_k2:
  v_mov_b32 v30, 0
  s_cmp_lg_u32 s3, 0
  s_cbranch_scc1 tpx_29
  s_cmp_eq_u32 s47, 0x7f
  s_cbranch_scc1 tpd_27
  s_branch tpc_28
tp_26:
  buffer_load_dword v30, v26, s[28:31], 0 offen sc1
  s_waitcnt vmcnt(0)
tpc_28:
  v_subrev_u32 v30, s100, v30
  v_subrev_u32 v30, 2, v30
  v_cmp_lt_u32 vcc, 7, v30
  s_lshr_b32 s4, vcc_lo, 8
  s_or_b32 s4, s4, vcc_lo
  s_sub_u32 s101, s101, 1
  s_cselect_b32 s4, 0, s4
  s_andn2_b32 s4, 0x7f, s4
  s_or_b32 s47, s47, s4
  s_and_b32 s4, s47, s97
  s_cbranch_scc0 tp_26
tpd_27:
  s_and_b32 s4, s47, s97
  s_ff1_i32_b32 s4, s4
  s_bitset0_b32 s97, s4
  v_mov_b32 v17, s4
  ds_write_b32 v16, v17 offset:0
  s_waitcnt lgkmcnt(0)
tpx_29:
  s_waitcnt vmcnt(14)
  s_barrier
  ds_read_b32 v17, v16
  ds_read_b64_tr_b16 a[0:1], v4 offset:0
  ds_read_b64_tr_b16 a[2:3], v4 offset:4096
  ds_read_b64_tr_b16 a[4:5], v5 offset:0
  ds_read_b64_tr_b16 a[6:7], v5 offset:4096
  ds_read_b64_tr_b16 a[8:9], v6 offset:0
  ds_read_b64_tr_b16 a[10:11], v6 offset:4096
  ds_read_b64_tr_b16 a[12:13], v7 offset:0
  ds_read_b64_tr_b16 a[14:15], v7 offset:4096
  ds_read_b64_tr_b16 a[16:17], v8 offset:0
  ds_read_b64_tr_b16 a[18:19], v8 offset:4096
  ds_read_b64_tr_b16 a[20:21], v9 offset:0
  ds_read_b64_tr_b16 a[22:23], v9 offset:4096
  ds_read_b64_tr_b16 a[24:25], v10 offset:0
  ds_read_b64_tr_b16 a[26:27], v10 offset:4096
  ds_read_b64_tr_b16 a[28:29], v11 offset:0
  ds_read_b64_tr_b16 a[30:31], v11 offset:4096
  s_mov_b32 s36, s46
L_k2_loop:
  s_waitcnt vmcnt(12) lgkmcnt(0)
  v_readfirstlane_b32 s99, v17
  s_cmp_lg_u32 s36, 1
  s_cbranch_scc1 h0_30
  buffer_load_dword v28, v22, s[28:31], 0 offen sc1
h0_30:
  s_barrier
  v_mfma_f32_16x16x32_bf16 v[32:35], a[0:3], a[128:131], v[32:35]
  buffer_load_dwordx4 a[176:179], v12, s[8:11], s32 offen
  v_mfma_f32_16x16x32_bf16 v[64:67], a[0:3], a[132:135], v[64:67]
  ds_read_b64_tr_b16 a[32:33], v4 offset:8192
  v_mfma_f32_16x16x32_bf16 v[96:99], a[0:3], a[136:139], v[96:99]
  ds_read_b64_tr_b16 a[34:35], v4 offset:12288
  v_mfma_f32_16x16x32_bf16 v[128:131], a[0:3], a[140:143], v[128:131]
  buffer_load_dwordx4 a[180:183], v13, s[8:11], s32 offen
  v_mfma_f32_16x16x32_bf16 v[132:135], a[4:7], a[140:143], v[132:135]
  ds_read_b64_tr_b16 a[36:37], v5 offset:8192
  v_mfma_f32_16x16x32_bf16 v[100:103], a[4:7], a[136:139], v[100:103]
  ds_read_b64_tr_b16 a[38:39], v5 offset:12288
  v_mfma_f32_16x16x32_bf16 v[68:71], a[4:7], a[132:135], v[68:71]
  buffer_load_dwordx4 a[184:187], v14, s[8:11], s32 offen
  v_mfma_f32_16x16x32_bf16 v[36:39], a[4:7], a[128:131], v[36:39]
  ds_read_b64_tr_b16 a[40:41], v6 offset:8192
  v_mfma_f32_16x16x32_bf16 v[40:43], a[8:11], a[128:131], v[40:43]
  ds_read_b64_tr_b16 a[42:43], v6 offset:12288
  v_mfma_f32_16x16x32_bf16 v[72:75], a[8:11], a[132:135], v[72:75]
  v_mfma_f32_16x16x32_bf16 v[104:107], a[8:11], a[136:139], v[104:107]
  buffer_load_dwordx4 a[188:191], v15, s[8:11], s32 offen
  s_add_u32 s32, s32, 16384
  v_mfma_f32_16x16x32_bf16 v[136:139], a[8:11], a[140:143], v[136:139]
  ds_read_b64_tr_b16 a[44:45], v7 offset:8192
  v_mfma_f32_16x16x32_bf16 v[140:143], a[12:15], a[140:143], v[140:143]
  ds_read_b64_tr_b16 a[46:47], v7 offset:12288
  v_mfma_f32_16x16x32_bf16 v[108:111], a[12:15], a[136:139], v[108:111]
  s_lshl_b32 s59, s99, 18
  s_add_u32 s59, s59, s96
  v_mfma_f32_16x16x32_bf16 v[76:79], a[12:15], a[132:135], v[76:79]
  ds_read_b64_tr_b16 a[48:49], v8 offset:8192
  v_mfma_f32_16x16x32_bf16 v[44:47], a[12:15], a[128:131], v[44:47]
  ds_read_b64_tr_b16 a[50:51], v8 offset:12288
  v_mfma_f32_16x16x32_bf16 v[48:51], a[16:19], a[128:131], v[48:51]
  s_add_u32 m0, s60, 0
  v_mfma_f32_16x16x32_bf16 v[80:83], a[16:19], a[132:135], v[80:83]
  buffer_load_dwordx4 v24, s[20:23], s59 offen offset:0 lds
  v_mfma_f32_16x16x32_bf16 v[112:115], a[16:19], a[136:139], v[112:115]
  v_mfma_f32_16x16x32_bf16 v[144:147], a[16:19], a[140:143], v[144:147]
  ds_read_b64_tr_b16 a[52:53], v9 offset:8192
  v_mfma_f32_16x16x32_bf16 v[148:151], a[20:23], a[140:143], v[148:151]
  ds_read_b64_tr_b16 a[54:55], v9 offset:12288
  v_mfma_f32_16x16x32_bf16 v[116:119], a[20:23], a[136:139], v[116:119]
  buffer_load_dwordx4 v25, s[20:23], s59 offen offset:1024 lds
  s_add_u32 s59, s59, 65536
  v_mfma_f32_16x16x32_bf16 v[84:87], a[20:23], a[132:135], v[84:87]
  ds_read_b64_tr_b16 a[56:57], v10 offset:8192
  v_mfma_f32_16x16x32_bf16 v[52:55], a[20:23], a[128:131], v[52:55]
  ds_read_b64_tr_b16 a[58:59], v10 offset:12288
  v_mfma_f32_16x16x32_bf16 v[56:59], a[24:27], a[128:131], v[56:59]
  buffer_load_dword v30, v26, s[28:31], 0 offen sc1
  v_mfma_f32_16x16x32_bf16 v[88:91], a[24:27], a[132:135], v[88:91]
  ds_read_b64_tr_b16 a[60:61], v11 offset:8192
  v_mfma_f32_16x16x32_bf16 v[120:123], a[24:27], a[136:139], v[120:123]
  ds_read_b64_tr_b16 a[62:63], v11 offset:12288
  v_mfma_f32_16x16x32_bf16 v[152:155], a[24:27], a[140:143], v[152:155]
  v_mfma_f32_16x16x32_bf16 v[156:159], a[28:31], a[140:143], v[156:159]
  v_mfma_f32_16x16x32_bf16 v[124:127], a[28:31], a[136:139], v[124:127]
  v_mfma_f32_16x16x32_bf16 v[92:95], a[28:31], a[132:135], v[92:95]
  v_mfma_f32_16x16x32_bf16 v[60:63], a[28:31], a[128:131], v[60:63]
  s_waitcnt vmcnt(12) lgkmcnt(0)
  s_barrier
  v_mfma_f32_16x16x32_bf16 v[32:35], a[32:35], a[144:147], v[32:35]
  s_lshl_b32 s32, s99, 16
  v_mfma_f32_16x16x32_bf16 v[64:67], a[32:35], a[148:151], v[64:67]
  ds_read_b64_tr_b16 a[0:1], v4 offset:16384
  v_mfma_f32_16x16x32_bf16 v[96:99], a[32:35], a[152:155], v[96:99]
  ds_read_b64_tr_b16 a[2:3], v4 offset:20480
  v_mfma_f32_16x16x32_bf16 v[128:131], a[32:35], a[156:159], v[128:131]
  ds_read_b64_tr_b16 a[4:5], v5 offset:16384
  v_mfma_f32_16x16x32_bf16 v[132:135], a[36:39], a[156:159], v[132:135]
  buffer_load_dwordx4 a[128:131], v12, s[8:11], s32 offen
  v_mfma_f32_16x16x32_bf16 v[100:103], a[36:39], a[152:155], v[100:103]
  ds_read_b64_tr_b16 a[6:7], v5 offset:20480
  v_mfma_f32_16x16x32_bf16 v[68:71], a[36:39], a[148:151], v[68:71]
  v_mfma_f32_16x16x32_bf16 v[36:39], a[36:39], a[144:147], v[36:39]
  ds_read_b64_tr_b16 a[8:9], v6 offset:16384
  v_mfma_f32_16x16x32_bf16 v[40:43], a[40:43], a[144:147], v[40:43]
  buffer_load_dwordx4 a[132:135], v13, s[8:11], s32 offen
  v_mfma_f32_16x16x32_bf16 v[72:75], a[40:43], a[148:151], v[72:75]
  ds_read_b64_tr_b16 a[10:11], v6 offset:20480
  v_mfma_f32_16x16x32_bf16 v[104:107], a[40:43], a[152:155], v[104:107]
  ds_read_b64_tr_b16 a[12:13], v7 offset:16384
  v_mfma_f32_16x16x32_bf16 v[136:139], a[40:43], a[156:159], v[136:139]
  buffer_load_dwordx4 a[136:139], v14, s[8:11], s32 offen
  v_mfma_f32_16x16x32_bf16 v[140:143], a[44:47], a[156:159], v[140:143]
  ds_read_b64_tr_b16 a[14:15], v7 offset:20480
  v_mfma_f32_16x16x32_bf16 v[108:111], a[44:47], a[152:155], v[108:111]
  v_mfma_f32_16x16x32_bf16 v[76:79], a[44:47], a[148:151], v[76:79]
  ds_read_b64_tr_b16 a[16:17], v8 offset:16384
  v_mfma_f32_16x16x32_bf16 v[44:47], a[44:47], a[144:147], v[44:47]
  ds_read_b64_tr_b16 a[18:19], v8 offset:20480
  v_mfma_f32_16x16x32_bf16 v[48:51], a[48:51], a[144:147], v[48:51]
  buffer_load_dwordx4 a[140:143], v15, s[8:11], s32 offen
  s_add_u32 s32, s32, 16384
  v_mfma_f32_16x16x32_bf16 v[80:83], a[48:51], a[148:151], v[80:83]
  ds_read_b64_tr_b16 a[20:21], v9 offset:16384
  v_mfma_f32_16x16x32_bf16 v[112:115], a[48:51], a[152:155], v[112:115]
  ds_read_b64_tr_b16 a[22:23], v9 offset:20480
  v_mfma_f32_16x16x32_bf16 v[144:147], a[48:51], a[156:159], v[144:147]
  s_add_u32 m0, s60, 8192
  v_mfma_f32_16x16x32_bf16 v[148:151], a[52:55], a[156:159], v[148:151]
  v_mfma_f32_16x16x32_bf16 v[116:119], a[52:55], a[152:155], v[116:119]
  buffer_load_dwordx4 v24, s[20:23], s59 offen offset:0 lds
  v_mfma_f32_16x16x32_bf16 v[84:87], a[52:55], a[148:151], v[84:87]
  ds_read_b64_tr_b16 a[24:25], v10 offset:16384
  v_mfma_f32_16x16x32_bf16 v[52:55], a[52:55], a[144:147], v[52:55]
  ds_read_b64_tr_b16 a[26:27], v10 offset:20480
  v_mfma_f32_16x16x32_bf16 v[56:59], a[56:59], a[144:147], v[56:59]
  buffer_load_dwordx4 v25, s[20:23], s59 offen offset:1024 lds
  s_add_u32 s59, s59, 65536
  v_mfma_f32_16x16x32_bf16 v[88:91], a[56:59], a[148:151], v[88:91]
  ds_read_b64_tr_b16 a[28:29], v11 offset:16384
  v_mfma_f32_16x16x32_bf16 v[120:123], a[56:59], a[152:155], v[120:123]
  ds_read_b64_tr_b16 a[30:31], v11 offset:20480
  v_mfma_f32_16x16x32_bf16 v[152:155], a[56:59], a[156:159], v[152:155]
  v_mfma_f32_16x16x32_bf16 v[156:159], a[60:63], a[156:159], v[156:159]
  v_mfma_f32_16x16x32_bf16 v[124:127], a[60:63], a[152:155], v[124:127]
  v_mfma_f32_16x16x32_bf16 v[92:95], a[60:63], a[148:151], v[92:95]
  v_mfma_f32_16x16x32_bf16 v[60:63], a[60:63], a[144:147], v[60:63]
  s_waitcnt vmcnt(12) lgkmcnt(0)
  s_barrier
  v_mfma_f32_16x16x32_bf16 v[32:35], a[0:3], a[160:163], v[32:35]
  buffer_load_dwordx4 a[144:147], v12, s[8:11], s32 offen
  v_mfma_f32_16x16x32_bf16 v[64:67], a[0:3], a[164:167], v[64:67]
  ds_read_b64_tr_b16 a[32:33], v4 offset:24576
  v_mfma_f32_16x16x32_bf16 v[96:99], a[0:3], a[168:171], v[96:99]
  ds_read_b64_tr_b16 a[34:35], v4 offset:28672
  v_mfma_f32_16x16x32_bf16 v[128:131], a[0:3], a[172:175], v[128:131]
  ds_read_b64_tr_b16 a[36:37], v5 offset:24576
  v_mfma_f32_16x16x32_bf16 v[132:135], a[4:7], a[172:175], v[132:135]
  buffer_load_dwordx4 a[148:151], v13, s[8:11], s32 offen
  v_mfma_f32_16x16x32_bf16 v[100:103], a[4:7], a[168:171], v[100:103]
  v_mfma_f32_16x16x32_bf16 v[68:71], a[4:7], a[164:167], v[68:71]
  ds_read_b64_tr_b16 a[38:39], v5 offset:28672
  v_mfma_f32_16x16x32_bf16 v[36:39], a[4:7], a[160:163], v[36:39]
  ds_read_b64_tr_b16 a[40:41], v6 offset:24576
  v_mfma_f32_16x16x32_bf16 v[40:43], a[8:11], a[160:163], v[40:43]
  ds_read_b64_tr_b16 a[42:43], v6 offset:28672
  v_mfma_f32_16x16x32_bf16 v[72:75], a[8:11], a[164:167], v[72:75]
  buffer_load_dwordx4 a[152:155], v14, s[8:11], s32 offen
  v_mfma_f32_16x16x32_bf16 v[104:107], a[8:11], a[168:171], v[104:107]
  ds_read_b64_tr_b16 a[44:45], v7 offset:24576
  v_mfma_f32_16x16x32_bf16 v[136:139], a[8:11], a[172:175], v[136:139]
  v_mfma_f32_16x16x32_bf16 v[140:143], a[12:15], a[172:175], v[140:143]
  ds_read_b64_tr_b16 a[46:47], v7 offset:28672
  v_mfma_f32_16x16x32_bf16 v[108:111], a[12:15], a[168:171], v[108:111]
  buffer_load_dwordx4 a[156:159], v15, s[8:11], s32 offen
  s_add_u32 s32, s32, 16384
  v_mfma_f32_16x16x32_bf16 v[76:79], a[12:15], a[164:167], v[76:79]
  ds_read_b64_tr_b16 a[48:49], v8 offset:24576
  v_mfma_f32_16x16x32_bf16 v[44:47], a[12:15], a[160:163], v[44:47]
  ds_read_b64_tr_b16 a[50:51], v8 offset:28672
  v_mfma_f32_16x16x32_bf16 v[48:51], a[16:19], a[160:163], v[48:51]
  v_mfma_f32_16x16x32_bf16 v[80:83], a[16:19], a[164:167], v[80:83]
  ds_read_b64_tr_b16 a[52:53], v9 offset:24576
  v_mfma_f32_16x16x32_bf16 v[112:115], a[16:19], a[168:171], v[112:115]
  s_add_u32 m0, s60, 16384
  v_mfma_f32_16x16x32_bf16 v[144:147], a[16:19], a[172:175], v[144:147]
  buffer_load_dwordx4 v24, s[20:23], s59 offen offset:0 lds
  v_mfma_f32_16x16x32_bf16 v[148:151], a[20:23], a[172:175], v[148:151]
  ds_read_b64_tr_b16 a[54:55], v9 offset:28672
  v_mfma_f32_16x16x32_bf16 v[116:119], a[20:23], a[168:171], v[116:119]
  ds_read_b64_tr_b16 a[56:57], v10 offset:24576
  v_mfma_f32_16x16x32_bf16 v[84:87], a[20:23], a[164:167], v[84:87]
  v_mfma_f32_16x16x32_bf16 v[52:55], a[20:23], a[160:163], v[52:55]
  ds_read_b64_tr_b16 a[58:59], v10 offset:28672
  v_mfma_f32_16x16x32_bf16 v[56:59], a[24:27], a[160:163], v[56:59]
  buffer_load_dwordx4 v25, s[20:23], s59 offen offset:1024 lds
  s_add_u32 s59, s59, 65536
  v_mfma_f32_16x16x32_bf16 v[88:91], a[24:27], a[164:167], v[88:91]
  ds_read_b64_tr_b16 a[60:61], v11 offset:24576
  v_mfma_f32_16x16x32_bf16 v[120:123], a[24:27], a[168:171], v[120:123]
  ds_read_b64_tr_b16 a[62:63], v11 offset:28672
  v_mfma_f32_16x16x32_bf16 v[152:155], a[24:27], a[172:175], v[152:155]
  v_mfma_f32_16x16x32_bf16 v[156:159], a[28:31], a[172:175], v[156:159]
  v_mfma_f32_16x16x32_bf16 v[124:127], a[28:31], a[168:171], v[124:127]
  v_mfma_f32_16x16x32_bf16 v[92:95], a[28:31], a[164:167], v[92:95]
  v_mfma_f32_16x16x32_bf16 v[60:63], a[28:31], a[160:163], v[60:63]
  s_waitcnt vmcnt(12) lgkmcnt(0)
  s_cmp_eq_u32 s97, 0
  s_cbranch_scc1 pn_31
  s_cmp_lg_u32 s3, 0
  s_cbranch_scc1 tpx_35
  s_cmp_eq_u32 s47, 0x7f
  s_cbranch_scc1 tpd_33
  s_branch tpc_34
tp_32:
  buffer_load_dword v30, v26, s[28:31], 0 offen sc1
  s_waitcnt vmcnt(0)
tpc_34:
  v_subrev_u32 v30, s100, v30
  v_subrev_u32 v30, 2, v30
  v_cmp_lt_u32 vcc, 7, v30
  s_lshr_b32 s4, vcc_lo, 8
  s_or_b32 s4, s4, vcc_lo
  s_sub_u32 s101, s101, 1
  s_cselect_b32 s4, 0, s4
  s_andn2_b32 s4, 0x7f, s4
  s_or_b32 s47, s47, s4
  s_and_b32 s4, s47, s97
  s_cbranch_scc0 tp_32
tpd_33:
  s_and_b32 s4, s47, s97
  s_ff1_i32_b32 s4, s4
  s_bitset0_b32 s97, s4
  v_mov_b32 v17, s4
  ds_write_b32 v16, v17 offset:0
  s_waitcnt lgkmcnt(0)
tpx_35:
pn_31:
  s_barrier
  v_mfma_f32_16x16x32_bf16 v[32:35], a[32:35], a[176:179], v[32:35]
  ds_read_b32 v17, v16
  v_mfma_f32_16x16x32_bf16 v[64:67], a[32:35], a[180:183], v[64:67]
  ds_read_b64_tr_b16 a[0:1], v4 offset:0
  v_mfma_f32_16x16x32_bf16 v[96:99], a[32:35], a[184:187], v[96:99]
  ds_read_b64_tr_b16 a[2:3], v4 offset:4096
  v_mfma_f32_16x16x32_bf16 v[128:131], a[32:35], a[188:191], v[128:131]
  ds_read_b64_tr_b16 a[4:5], v5 offset:0
  v_mfma_f32_16x16x32_bf16 v[132:135], a[36:39], a[188:191], v[132:135]
  buffer_load_dwordx4 a[160:163], v12, s[8:11], s32 offen
  v_mfma_f32_16x16x32_bf16 v[100:103], a[36:39], a[184:187], v[100:103]
  ds_read_b64_tr_b16 a[6:7], v5 offset:4096
  v_mfma_f32_16x16x32_bf16 v[68:71], a[36:39], a[180:183], v[68:71]
  v_mfma_f32_16x16x32_bf16 v[36:39], a[36:39], a[176:179], v[36:39]
  ds_read_b64_tr_b16 a[8:9], v6 offset:0
  v_mfma_f32_16x16x32_bf16 v[40:43], a[40:43], a[176:179], v[40:43]
  buffer_load_dwordx4 a[164:167], v13, s[8:11], s32 offen
  v_mfma_f32_16x16x32_bf16 v[72:75], a[40:43], a[180:183], v[72:75]
  ds_read_b64_tr_b16 a[10:11], v6 offset:4096
  v_mfma_f32_16x16x32_bf16 v[104:107], a[40:43], a[184:187], v[104:107]
  ds_read_b64_tr_b16 a[12:13], v7 offset:0
  v_mfma_f32_16x16x32_bf16 v[136:139], a[40:43], a[188:191], v[136:139]
  buffer_load_dwordx4 a[168:171], v14, s[8:11], s32 offen
  v_mfma_f32_16x16x32_bf16 v[140:143], a[44:47], a[188:191], v[140:143]
  ds_read_b64_tr_b16 a[14:15], v7 offset:4096
  v_mfma_f32_16x16x32_bf16 v[108:111], a[44:47], a[184:187], v[108:111]
  v_mfma_f32_16x16x32_bf16 v[76:79], a[44:47], a[180:183], v[76:79]
  ds_read_b64_tr_b16 a[16:17], v8 offset:0
  v_mfma_f32_16x16x32_bf16 v[44:47], a[44:47], a[176:179], v[44:47]
  ds_read_b64_tr_b16 a[18:19], v8 offset:4096
  v_mfma_f32_16x16x32_bf16 v[48:51], a[48:51], a[176:179], v[48:51]
  buffer_load_dwordx4 a[172:175], v15, s[8:11], s32 offen
  s_add_u32 s32, s32, 16384
  v_mfma_f32_16x16x32_bf16 v[80:83], a[48:51], a[180:183], v[80:83]
  ds_read_b64_tr_b16 a[20:21], v9 offset:0
  v_mfma_f32_16x16x32_bf16 v[112:115], a[48:51], a[184:187], v[112:115]
  ds_read_b64_tr_b16 a[22:23], v9 offset:4096
  v_mfma_f32_16x16x32_bf16 v[144:147], a[48:51], a[188:191], v[144:147]
  s_add_u32 m0, s60, 24576
  v_mfma_f32_16x16x32_bf16 v[148:151], a[52:55], a[188:191], v[148:151]
  v_mfma_f32_16x16x32_bf16 v[116:119], a[52:55], a[184:187], v[116:119]
  buffer_load_dwordx4 v24, s[20:23], s59 offen offset:0 lds
  v_mfma_f32_16x16x32_bf16 v[84:87], a[52:55], a[180:183], v[84:87]
  ds_read_b64_tr_b16 a[24:25], v10 offset:0
  v_mfma_f32_16x16x32_bf16 v[52:55], a[52:55], a[176:179], v[52:55]
  ds_read_b64_tr_b16 a[26:27], v10 offset:4096
  v_mfma_f32_16x16x32_bf16 v[56:59], a[56:59], a[176:179], v[56:59]
  buffer_load_dwordx4 v25, s[20:23], s59 offen offset:1024 lds
  s_add_u32 s59, s59, 65536
  v_mfma_f32_16x16x32_bf16 v[88:91], a[56:59], a[180:183], v[88:91]
  ds_read_b64_tr_b16 a[28:29], v11 offset:0
  v_mfma_f32_16x16x32_bf16 v[120:123], a[56:59], a[184:187], v[120:123]
  ds_read_b64_tr_b16 a[30:31], v11 offset:4096
  v_mfma_f32_16x16x32_bf16 v[152:155], a[56:59], a[188:191], v[152:155]
  v_mfma_f32_16x16x32_bf16 v[156:159], a[60:63], a[188:191], v[156:159]
  v_mfma_f32_16x16x32_bf16 v[124:127], a[60:63], a[184:187], v[124:127]
  v_mfma_f32_16x16x32_bf16 v[92:95], a[60:63], a[180:183], v[92:95]
  s_sub_u32 s36, s36, 1
  s_cmp_lg_u32 s36, 0
  v_mfma_f32_16x16x32_bf16 v[60:63], a[60:63], a[176:179], v[60:63]
  s_cbranch_scc1 L_k2_loop
  s_waitcnt vmcnt(12) lgkmcnt(0)
  s_barrier
  s_branch spc_38
sp_36:
  buffer_load_dword v28, v22, s[28:31], 0 offen sc1
  s_waitcnt vmcnt(0)
spc_38:
  v_subrev_u32 v28, s100, v28
  v_subrev_u32 v28, 3, v28
  v_cmp_lt_u32 vcc, 7, v28
  s_sub_u32 s101, s101, 1
  s_cbranch_scc1 spd_37
  s_cbranch_vccnz sp_36
spd_37:
  v_mfma_f32_16x16x32_bf16 v[32:35], a[0:3], a[128:131], v[32:35]
  buffer_load_dwordx4 a[176:179], v12, s[8:11], s32 offen
  v_mfma_f32_16x16x32_bf16 v[64:67], a[0:3], a[132:135], v[64:67]
  ds_read_b64_tr_b16 a[32:33], v4 offset:8192
  v_mfma_f32_16x16x32_bf16 v[96:99], a[0:3], a[136:139], v[96:99]
  ds_read_b64_tr_b16 a[34:35], v4 offset:12288
  v_mfma_f32_16x16x32_bf16 v[128:131], a[0:3], a[140:143], v[128:131]
  buffer_load_dwordx4 a[180:183], v13, s[8:11], s32 offen
  v_mfma_f32_16x16x32_bf16 v[132:135], a[4:7], a[140:143], v[132:135]
  ds_read_b64_tr_b16 a[36:37], v5 offset:8192
  v_mfma_f32_16x16x32_bf16 v[100:103], a[4:7], a[136:139], v[100:103]
  ds_read_b64_tr_b16 a[38:39], v5 offset:12288
  v_mfma_f32_16x16x32_bf16 v[68:71], a[4:7], a[132:135], v[68:71]
  buffer_load_dwordx4 a[184:187], v14, s[8:11], s32 offen
  v_mfma_f32_16x16x32_bf16 v[36:39], a[4:7], a[128:131], v[36:39]
  ds_read_b64_tr_b16 a[40:41], v6 offset:8192
  v_mfma_f32_16x16x32_bf16 v[40:43], a[8:11], a[128:131], v[40:43]
  ds_read_b64_tr_b16 a[42:43], v6 offset:12288
  v_mfma_f32_16x16x32_bf16 v[72:75], a[8:11], a[132:135], v[72:75]
  v_mfma_f32_16x16x32_bf16 v[104:107], a[8:11], a[136:139], v[104:107]
  buffer_load_dwordx4 a[188:191], v15, s[8:11], s32 offen
  s_add_u32 s32, s32, 16384
  v_mfma_f32_16x16x32_bf16 v[136:139], a[8:11], a[140:143], v[136:139]
  ds_read_b64_tr_b16 a[44:45], v7 offset:8192
  v_mfma_f32_16x16x32_bf16 v[140:143], a[12:15], a[140:143], v[140:143]
  ds_read_b64_tr_b16 a[46:47], v7 offset:12288
  v_mfma_f32_16x16x32_bf16 v[108:111], a[12:15], a[136:139], v[108:111]
  s_add_u32 m0, s55, 4096
  v_mfma_f32_16x16x32_bf16 v[76:79], a[12:15], a[132:135], v[76:79]
  ds_read_b64_tr_b16 a[48:49], v8 offset:8192
  v_mfma_f32_16x16x32_bf16 v[44:47], a[12:15], a[128:131], v[44:47]
  buffer_load_dwordx4 v164, s[12:15], 0 offen offset:0 sc1 lds
  v_mfma_f32_16x16x32_bf16 v[48:51], a[16:19], a[128:131], v[48:51]
  ds_read_b64_tr_b16 a[50:51], v8 offset:12288
  v_mfma_f32_16x16x32_bf16 v[80:83], a[16:19], a[132:135], v[80:83]
  ds_read_b64_tr_b16 a[52:53], v9 offset:8192
  v_mfma_f32_16x16x32_bf16 v[112:115], a[16:19], a[136:139], v[112:115]
  v_mfma_f32_16x16x32_bf16 v[144:147], a[16:19], a[140:143], v[144:147]
  buffer_load_dwordx4 v165, s[12:15], 0 offen offset:1024 sc1 lds
  v_mfma_f32_16x16x32_bf16 v[148:151], a[20:23], a[140:143], v[148:151]
  ds_read_b64_tr_b16 a[54:55], v9 offset:12288
  v_mfma_f32_16x16x32_bf16 v[116:119], a[20:23], a[136:139], v[116:119]
  ds_read_b64_tr_b16 a[56:57], v10 offset:8192
  v_mfma_f32_16x16x32_bf16 v[84:87], a[20:23], a[132:135], v[84:87]
  buffer_load_dwordx4 v166, s[12:15], 0 offen offset:2048 sc1 lds
  v_mfma_f32_16x16x32_bf16 v[52:55], a[20:23], a[128:131], v[52:55]
  ds_read_b64_tr_b16 a[58:59], v10 offset:12288
  v_mfma_f32_16x16x32_bf16 v[56:59], a[24:27], a[128:131], v[56:59]
  ds_read_b64_tr_b16 a[60:61], v11 offset:8192
  v_mfma_f32_16x16x32_bf16 v[88:91], a[24:27], a[132:135], v[88:91]
  buffer_load_dwordx4 v167, s[12:15], 0 offen offset:3072 sc1 lds
  v_mfma_f32_16x16x32_bf16 v[120:123], a[24:27], a[136:139], v[120:123]
  ds_read_b64_tr_b16 a[62:63], v11 offset:12288
  v_mfma_f32_16x16x32_bf16 v[152:155], a[24:27], a[140:143], v[152:155]
  v_mfma_f32_16x16x32_bf16 v[156:159], a[28:31], a[140:143], v[156:159]
  v_mfma_f32_16x16x32_bf16 v[124:127], a[28:31], a[136:139], v[124:127]
  v_mfma_f32_16x16x32_bf16 v[92:95], a[28:31], a[132:135], v[92:95]
  v_mfma_f32_16x16x32_bf16 v[60:63], a[28:31], a[128:131], v[60:63]
  s_waitcnt vmcnt(8) lgkmcnt(0)
  s_barrier
  v_mfma_f32_16x16x32_bf16 v[32:35], a[32:35], a[144:147], v[32:35]
  s_add_u32 m0, s55, 8192
  s_nop 0
  ds_read_b64_tr_b16 a[0:1], v4 offset:16384
  v_mfma_f32_16x16x32_bf16 v[64:67], a[32:35], a[148:151], v[64:67]
  buffer_load_dwordx4 v164, s[16:19], 0 offen offset:0 sc1 lds
  v_mfma_f32_16x16x32_bf16 v[96:99], a[32:35], a[152:155], v[96:99]
  ds_read_b64_tr_b16 a[2:3], v4 offset:20480
  v_mfma_f32_16x16x32_bf16 v[128:131], a[32:35], a[156:159], v[128:131]
  buffer_load_dwordx4 v165, s[16:19], 0 offen offset:1024 sc1 lds
  ds_read_b64_tr_b16 a[4:5], v5 offset:16384
  v_mfma_f32_16x16x32_bf16 v[132:135], a[36:39], a[156:159], v[132:135]
  buffer_load_dwordx4 v166, s[16:19], 0 offen offset:2048 sc1 lds
  v_mfma_f32_16x16x32_bf16 v[100:103], a[36:39], a[152:155], v[100:103]
  ds_read_b64_tr_b16 a[6:7], v5 offset:20480
  v_mfma_f32_16x16x32_bf16 v[68:71], a[36:39], a[148:151], v[68:71]
  buffer_load_dwordx4 v167, s[16:19], 0 offen offset:3072 sc1 lds
  ds_read_b64_tr_b16 a[192:193], v4 offset:24576
  v_mfma_f32_16x16x32_bf16 v[36:39], a[36:39], a[144:147], v[36:39]
  ds_read_b64_tr_b16 a[8:9], v6 offset:16384
  v_mfma_f32_16x16x32_bf16 v[40:43], a[40:43], a[144:147], v[40:43]
  ds_read_b64_tr_b16 a[194:195], v4 offset:28672
  v_mfma_f32_16x16x32_bf16 v[72:75], a[40:43], a[148:151], v[72:75]
  ds_read_b64_tr_b16 a[10:11], v6 offset:20480
  ds_read_b64_tr_b16 a[196:197], v5 offset:24576
  v_mfma_f32_16x16x32_bf16 v[104:107], a[40:43], a[152:155], v[104:107]
  ds_read_b64_tr_b16 a[12:13], v7 offset:16384
  v_mfma_f32_16x16x32_bf16 v[136:139], a[40:43], a[156:159], v[136:139]
  ds_read_b64_tr_b16 a[198:199], v5 offset:28672
  v_mfma_f32_16x16x32_bf16 v[140:143], a[44:47], a[156:159], v[140:143]
  ds_read_b64_tr_b16 a[200:201], v6 offset:24576
  ds_read_b64_tr_b16 a[14:15], v7 offset:20480
  v_mfma_f32_16x16x32_bf16 v[108:111], a[44:47], a[152:155], v[108:111]
  ds_read_b64_tr_b16 a[202:203], v6 offset:28672
  v_mfma_f32_16x16x32_bf16 v[76:79], a[44:47], a[148:151], v[76:79]
  ds_read_b64_tr_b16 a[16:17], v8 offset:16384
  v_mfma_f32_16x16x32_bf16 v[44:47], a[44:47], a[144:147], v[44:47]
  ds_read_b64_tr_b16 a[204:205], v7 offset:24576
  ds_read_b64_tr_b16 a[18:19], v8 offset:20480
  v_mfma_f32_16x16x32_bf16 v[48:51], a[48:51], a[144:147], v[48:51]
  ds_read_b64_tr_b16 a[206:207], v7 offset:28672
  v_mfma_f32_16x16x32_bf16 v[80:83], a[48:51], a[148:151], v[80:83]
  ds_read_b64_tr_b16 a[208:209], v8 offset:24576
  v_mfma_f32_16x16x32_bf16 v[112:115], a[48:51], a[152:155], v[112:115]
  ds_read_b64_tr_b16 a[20:21], v9 offset:16384
  ds_read_b64_tr_b16 a[210:211], v8 offset:28672
  v_mfma_f32_16x16x32_bf16 v[144:147], a[48:51], a[156:159], v[144:147]
  ds_read_b64_tr_b16 a[22:23], v9 offset:20480
  v_mfma_f32_16x16x32_bf16 v[148:151], a[52:55], a[156:159], v[148:151]
  ds_read_b64_tr_b16 a[212:213], v9 offset:24576
  v_mfma_f32_16x16x32_bf16 v[116:119], a[52:55], a[152:155], v[116:119]
  ds_read_b64_tr_b16 a[24:25], v10 offset:16384
  ds_read_b64_tr_b16 a[214:215], v9 offset:28672
  v_mfma_f32_16x16x32_bf16 v[84:87], a[52:55], a[148:151], v[84:87]
  ds_read_b64_tr_b16 a[216:217], v10 offset:24576
  v_mfma_f32_16x16x32_bf16 v[52:55], a[52:55], a[144:147], v[52:55]
  ds_read_b64_tr_b16 a[26:27], v10 offset:20480
  v_mfma_f32_16x16x32_bf16 v[56:59], a[56:59], a[144:147], v[56:59]
  ds_read_b64_tr_b16 a[218:219], v10 offset:28672
  ds_read_b64_tr_b16 a[28:29], v11 offset:16384
  v_mfma_f32_16x16x32_bf16 v[88:91], a[56:59], a[148:151], v[88:91]
  ds_read_b64_tr_b16 a[220:221], v11 offset:24576
  v_mfma_f32_16x16x32_bf16 v[120:123], a[56:59], a[152:155], v[120:123]
  ds_read_b64_tr_b16 a[30:31], v11 offset:20480
  v_mfma_f32_16x16x32_bf16 v[152:155], a[56:59], a[156:159], v[152:155]
  ds_read_b64_tr_b16 a[222:223], v11 offset:28672
  v_mfma_f32_16x16x32_bf16 v[156:159], a[60:63], a[156:159], v[156:159]
  v_mfma_f32_16x16x32_bf16 v[124:127], a[60:63], a[152:155], v[124:127]
  v_mfma_f32_16x16x32_bf16 v[92:95], a[60:63], a[148:151], v[92:95]
  v_mfma_f32_16x16x32_bf16 v[60:63], a[60:63], a[144:147], v[60:63]
  s_waitcnt vmcnt(8) lgkmcnt(0)
  s_barrier
  v_mfma_f32_16x16x32_bf16 v[64:67], a[0:3], a[164:167], v[64:67]
  v_mfma_f32_16x16x32_bf16 v[68:71], a[4:7], a[164:167], v[68:71]
  v_mfma_f32_16x16x32_bf16 v[64:67], a[192:195], a[180:183], v[64:67]
  v_mfma_f32_16x16x32_bf16 v[68:71], a[196:199], a[180:183], v[68:71]
  v_mfma_f32_16x16x32_bf16 v[72:75], a[8:11], a[164:167], v[72:75]
  v_mfma_f32_16x16x32_bf16 v[76:79], a[12:15], a[164:167], v[76:79]
  v_mfma_f32_16x16x32_bf16 v[72:75], a[200:203], a[180:183], v[72:75]
  v_mfma_f32_16x16x32_bf16 v[76:79], a[204:207], a[180:183], v[76:79]
  v_mfma_f32_16x16x32_bf16 v[80:83], a[16:19], a[164:167], v[80:83]
  v_mfma_f32_16x16x32_bf16 v[84:87], a[20:23], a[164:167], v[84:87]
  v_mfma_f32_16x16x32_bf16 v[80:83], a[208:211], a[180:183], v[80:83]
  v_mfma_f32_16x16x32_bf16 v[84:87], a[212:215], a[180:183], v[84:87]
  v_mfma_f32_16x16x32_bf16 v[88:91], a[24:27], a[164:167], v[88:91]
  v_cvt_pk_bf16_f32 v192, v64, v65
  v_cvt_pk_bf16_f32 v193, v66, v67
  v_mfma_f32_16x16x32_bf16 v[92:95], a[28:31], a[164:167], v[92:95]
  v_cvt_pk_bf16_f32 v194, v68, v69
  v_cvt_pk_bf16_f32 v195, v70, v71
  v_mfma_f32_16x16x32_bf16 v[88:91], a[216:219], a[180:183], v[88:91]
  buffer_store_dwordx4 v[192:195], v29, s[24:27], s50 offen offset:0 sc1
  v_mfma_f32_16x16x32_bf16 v[92:95], a[220:223], a[180:183], v[92:95]
  v_mfma_f32_16x16x32_bf16 v[96:99], a[0:3], a[168:171], v[96:99]
  v_cvt_pk_bf16_f32 v196, v72, v73
  v_cvt_pk_bf16_f32 v197, v74, v75
  v_mfma_f32_16x16x32_bf16 v[100:103], a[4:7], a[168:171], v[100:103]
  v_cvt_pk_bf16_f32 v198, v76, v77
  v_cvt_pk_bf16_f32 v199, v78, v79
  v_mfma_f32_16x16x32_bf16 v[96:99], a[192:195], a[184:187], v[96:99]
  buffer_store_dwordx4 v[196:199], v29, s[24:27], s50 offen offset:1024 sc1
  v_mfma_f32_16x16x32_bf16 v[100:103], a[196:199], a[184:187], v[100:103]
  v_mfma_f32_16x16x32_bf16 v[104:107], a[8:11], a[168:171], v[104:107]
  v_cvt_pk_bf16_f32 v200, v80, v81
  v_cvt_pk_bf16_f32 v201, v82, v83
  v_mfma_f32_16x16x32_bf16 v[108:111], a[12:15], a[168:171], v[108:111]
  v_cvt_pk_bf16_f32 v202, v84, v85
  v_cvt_pk_bf16_f32 v203, v86, v87
  v_mfma_f32_16x16x32_bf16 v[104:107], a[200:203], a[184:187], v[104:107]
  buffer_store_dwordx4 v[200:203], v29, s[24:27], s50 offen offset:2048 sc1
  v_mfma_f32_16x16x32_bf16 v[108:111], a[204:207], a[184:187], v[108:111]
  v_mfma_f32_16x16x32_bf16 v[112:115], a[16:19], a[168:171], v[112:115]
  v_cvt_pk_bf16_f32 v204, v88, v89
  v_cvt_pk_bf16_f32 v205, v90, v91
  v_mfma_f32_16x16x32_bf16 v[116:119], a[20:23], a[168:171], v[116:119]
  v_cvt_pk_bf16_f32 v206, v92, v93
  v_cvt_pk_bf16_f32 v207, v94, v95
  v_mfma_f32_16x16x32_bf16 v[112:115], a[208:211], a[184:187], v[112:115]
  buffer_store_dwordx4 v[204:207], v29, s[24:27], s50 offen offset:3072 sc1
  v_mfma_f32_16x16x32_bf16 v[116:119], a[212:215], a[184:187], v[116:119]
  v_mfma_f32_16x16x32_bf16 v[120:123], a[24:27], a[168:171], v[120:123]
  v_cvt_pk_bf16_f32 v192, v96, v97
  v_cvt_pk_bf16_f32 v193, v98, v99
  v_mfma_f32_16x16x32_bf16 v[124:127], a[28:31], a[168:171], v[124:127]
  v_cvt_pk_bf16_f32 v194, v100, v101
  v_cvt_pk_bf16_f32 v195, v102, v103
  v_mfma_f32_16x16x32_bf16 v[120:123], a[216:219], a[184:187], v[120:123]
  buffer_store_dwordx4 v[192:195], v29, s[24:27], s51 offen offset:0 sc1
  v_mfma_f32_16x16x32_bf16 v[124:127], a[220:223], a[184:187], v[124:127]
  v_mfma_f32_16x16x32_bf16 v[128:131], a[0:3], a[172:175], v[128:131]
  v_cvt_pk_bf16_f32 v196, v104, v105
  v_cvt_pk_bf16_f32 v197, v106, v107
  v_mfma_f32_16x16x32_bf16 v[132:135], a[4:7], a[172:175], v[132:135]
  v_cvt_pk_bf16_f32 v198, v108, v109
  v_cvt_pk_bf16_f32 v199, v110, v111
  v_mfma_f32_16x16x32_bf16 v[128:131], a[192:195], a[188:191], v[128:131]
  buffer_store_dwordx4 v[196:199], v29, s[24:27], s51 offen offset:1024 sc1
  v_mfma_f32_16x16x32_bf16 v[132:135], a[196:199], a[188:191], v[132:135]
  v_mfma_f32_16x16x32_bf16 v[136:139], a[8:11], a[172:175], v[136:139]
  v_cvt_pk_bf16_f32 v200, v112, v113
  v_cvt_pk_bf16_f32 v201, v114, v115
  v_mfma_f32_16x16x32_bf16 v[140:143], a[12:15], a[172:175], v[140:143]
  v_cvt_pk_bf16_f32 v202, v116, v117
  v_cvt_pk_bf16_f32 v203, v118, v119
  v_mfma_f32_16x16x32_bf16 v[136:139], a[200:203], a[188:191], v[136:139]
  buffer_store_dwordx4 v[200:203], v29, s[24:27], s51 offen offset:2048 sc1
  v_mfma_f32_16x16x32_bf16 v[140:143], a[204:207], a[188:191], v[140:143]
  v_mfma_f32_16x16x32_bf16 v[144:147], a[16:19], a[172:175], v[144:147]
  v_cvt_pk_bf16_f32 v204, v120, v121
  v_cvt_pk_bf16_f32 v205, v122, v123
  v_mfma_f32_16x16x32_bf16 v[148:151], a[20:23], a[172:175], v[148:151]
  v_cvt_pk_bf16_f32 v206, v124, v125
  v_cvt_pk_bf16_f32 v207, v126, v127
  v_mfma_f32_16x16x32_bf16 v[144:147], a[208:211], a[188:191], v[144:147]
  buffer_store_dwordx4 v[204:207], v29, s[24:27], s51 offen offset:3072 sc1
  v_mfma_f32_16x16x32_bf16 v[148:151], a[212:215], a[188:191], v[148:151]
  v_mfma_f32_16x16x32_bf16 v[152:155], a[24:27], a[172:175], v[152:155]
  v_cvt_pk_bf16_f32 v192, v128, v129
  v_cvt_pk_bf16_f32 v193, v130, v131
  v_mfma_f32_16x16x32_bf16 v[156:159], a[28:31], a[172:175], v[156:159]
  v_cvt_pk_bf16_f32 v194, v132, v133
  v_cvt_pk_bf16_f32 v195, v134, v135
  v_mfma_f32_16x16x32_bf16 v[152:155], a[216:219], a[188:191], v[152:155]
  buffer_store_dwordx4 v[192:195], v29, s[24:27], s52 offen offset:0 sc1
  v_mfma_f32_16x16x32_bf16 v[156:159], a[220:223], a[188:191], v[156:159]
  v_mfma_f32_16x16x32_bf16 v[32:35], a[0:3], a[160:163], v[32:35]
  v_cvt_pk_bf16_f32 v196, v136, v137
  v_cvt_pk_bf16_f32 v197, v138, v139
  v_mfma_f32_16x16x32_bf16 v[36:39], a[4:7], a[160:163], v[36:39]
  v_cvt_pk_bf16_f32 v198, v140, v141
  v_cvt_pk_bf16_f32 v199, v142, v143
  v_mfma_f32_16x16x32_bf16 v[32:35], a[192:195], a[176:179], v[32:35]
  buffer_store_dwordx4 v[196:199], v29, s[24:27], s52 offen offset:1024 sc1
  v_mfma_f32_16x16x32_bf16 v[36:39], a[196:199], a[176:179], v[36:39]
  v_mfma_f32_16x16x32_bf16 v[40:43], a[8:11], a[160:163], v[40:43]
  v_cvt_pk_bf16_f32 v200, v144, v145
  v_cvt_pk_bf16_f32 v201, v146, v147
  v_mfma_f32_16x16x32_bf16 v[44:47], a[12:15], a[160:163], v[44:47]
  v_cvt_pk_bf16_f32 v202, v148, v149
  v_cvt_pk_bf16_f32 v203, v150, v151
  v_mfma_f32_16x16x32_bf16 v[40:43], a[200:203], a[176:179], v[40:43]
  buffer_store_dwordx4 v[200:203], v29, s[24:27], s52 offen offset:2048 sc1
  v_mfma_f32_16x16x32_bf16 v[44:47], a[204:207], a[176:179], v[44:47]
  v_mfma_f32_16x16x32_bf16 v[48:51], a[16:19], a[160:163], v[48:51]
  v_cvt_pk_bf16_f32 v204, v152, v153
  v_cvt_pk_bf16_f32 v205, v154, v155
  v_mfma_f32_16x16x32_bf16 v[52:55], a[20:23], a[160:163], v[52:55]
  v_cvt_pk_bf16_f32 v206, v156, v157
  v_cvt_pk_bf16_f32 v207, v158, v159
  v_mfma_f32_16x16x32_bf16 v[48:51], a[208:211], a[176:179], v[48:51]
  buffer_store_dwordx4 v[204:207], v29, s[24:27], s52 offen offset:3072 sc1
  v_mfma_f32_16x16x32_bf16 v[52:55], a[212:215], a[176:179], v[52:55]
  v_mfma_f32_16x16x32_bf16 v[56:59], a[24:27], a[160:163], v[56:59]
  v_mfma_f32_16x16x32_bf16 v[60:63], a[28:31], a[160:163], v[60:63]
  v_mfma_f32_16x16x32_bf16 v[56:59], a[216:219], a[176:179], v[56:59]
  v_mfma_f32_16x16x32_bf16 v[60:63], a[220:223], a[176:179], v[60:63]
  s_nop 7
  s_waitcnt vmcnt(12)
  ds_read_b64 v[128:129], v176 offset:4096
  ds_read_b64 v[130:131], v176 offset:8192
  ds_read_b64 v[132:133], v177 offset:4096
  ds_read_b64 v[134:135], v177 offset:8192
  ds_read_b64 v[136:137], v178 offset:4096
  ds_read_b64 v[138:139], v178 offset:8192
  ds_read_b64 v[140:141], v179 offset:4096
  ds_read_b64 v[142:143], v179 offset:8192
  ds_read_b64 v[144:145], v180 offset:4096
  ds_read_b64 v[146:147], v180 offset:8192
  ds_read_b64 v[148:149], v181 offset:4096
  ds_read_b64 v[150:151], v181 offset:8192
  ds_read_b64 v[152:153], v182 offset:4096
  ds_read_b64 v[154:155], v182 offset:8192
  ds_read_b64 v[156:157], v183 offset:4096
  ds_read_b64 v[158:159], v183 offset:8192
  s_mov_b32 s20, s82
  s_mov_b32 s21, s83
  s_mov_b32 s22, 0x400000
  s_mov_b32 s23, 0x20000
  s_mov_b32 s44, 0xbfb8aa3b
  s_mov_b32 s45, 0xbfb8aa3b
  s_mov_b32 s54, 0xffff0000
  s_mov_b32 s46, 1.0
  s_mov_b32 s47, 1.0
  s_mov_b32 s48, 0x3f80
  s_mov_b32 s49, 0x3f800000
  s_add_u32 s4, s100, 7
  v_mov_b32 v28, s4
  s_cmp_ge_u32 s57, 4
  s_cbranch_scc1 L_k2_rev
  s_waitcnt lgkmcnt(14)
  v_lshlrev_b32 v64, 16, v128
  v_and_b32 v65, s54, v128
  v_lshlrev_b32 v66, 16, v129
  v_and_b32 v67, s54, v129
  v_lshlrev_b32 v4, 16, v130
  v_and_b32 v5, s54, v130
  v_lshlrev_b32 v6, 16, v131
  v_and_b32 v7, s54, v131
  v_pk_fma_f32 v[64:65], v[4:5], s[62:63], v[64:65]
  v_pk_fma_f32 v[66:67], v[6:7], s[62:63], v[66:67]
  s_waitcnt lgkmcnt(12)
  v_lshlrev_b32 v68, 16, v132
  v_and_b32 v69, s54, v132
  v_lshlrev_b32 v70, 16, v133
  v_and_b32 v71, s54, v133
  v_lshlrev_b32 v4, 16, v134
  v_and_b32 v5, s54, v134
  v_lshlrev_b32 v6, 16, v135
  v_and_b32 v7, s54, v135
  v_pk_fma_f32 v[68:69], v[4:5], s[62:63], v[68:69]
  v_pk_fma_f32 v[70:71], v[6:7], s[62:63], v[70:71]
  s_waitcnt lgkmcnt(10)
  v_lshlrev_b32 v72, 16, v136
  v_and_b32 v73, s54, v136
  v_lshlrev_b32 v74, 16, v137
  v_and_b32 v75, s54, v137
  v_lshlrev_b32 v4, 16, v138
  v_and_b32 v5, s54, v138
  v_lshlrev_b32 v6, 16, v139
  v_and_b32 v7, s54, v139
  v_pk_fma_f32 v[72:73], v[4:5], s[62:63], v[72:73]
  v_pk_fma_f32 v[74:75], v[6:7], s[62:63], v[74:75]
  s_waitcnt lgkmcnt(8)
  v_lshlrev_b32 v76, 16, v140
  v_and_b32 v77, s54, v140
  v_lshlrev_b32 v78, 16, v141
  v_and_b32 v79, s54, v141
  v_lshlrev_b32 v4, 16, v142
  v_and_b32 v5, s54, v142
  v_lshlrev_b32 v6, 16, v143
  v_and_b32 v7, s54, v143
  v_pk_fma_f32 v[76:77], v[4:5], s[62:63], v[76:77]
  v_pk_fma_f32 v[78:79], v[6:7], s[62:63], v[78:79]
  s_waitcnt lgkmcnt(6)
  v_lshlrev_b32 v80, 16, v144
  v_and_b32 v81, s54, v144
  v_lshlrev_b32 v82, 16, v145
  v_and_b32 v83, s54, v145
  v_lshlrev_b32 v4, 16, v146
  v_and_b32 v5, s54, v146
  v_lshlrev_b32 v6, 16, v147
  v_and_b32 v7, s54, v147
  v_pk_fma_f32 v[80:81], v[4:5], s[62:63], v[80:81]
  v_pk_fma_f32 v[82:83], v[6:7], s[62:63], v[82:83]
  s_waitcnt lgkmcnt(4)
  v_lshlrev_b32 v84, 16, v148
  v_and_b32 v85, s54, v148
  v_lshlrev_b32 v86, 16, v149
  v_and_b32 v87, s54, v149
  v_lshlrev_b32 v4, 16, v150
  v_and_b32 v5, s54, v150
  v_lshlrev_b32 v6, 16, v151
  v_and_b32 v7, s54, v151
  v_pk_fma_f32 v[84:85], v[4:5], s[62:63], v[84:85]
  v_pk_fma_f32 v[86:87], v[6:7], s[62:63], v[86:87]
  s_waitcnt lgkmcnt(2)
  v_lshlrev_b32 v88, 16, v152
  v_and_b32 v89, s54, v152
  v_lshlrev_b32 v90, 16, v153
  v_and_b32 v91, s54, v153
  v_lshlrev_b32 v4, 16, v154
  v_and_b32 v5, s54, v154
  v_lshlrev_b32 v6, 16, v155
  v_and_b32 v7, s54, v155
  v_pk_fma_f32 v[88:89], v[4:5], s[62:63], v[88:89]
  v_pk_fma_f32 v[90:91], v[6:7], s[62:63], v[90:91]
  s_waitcnt lgkmcnt(0)
  v_lshlrev_b32 v92, 16, v156
  v_and_b32 v93, s54, v156
  v_lshlrev_b32 v94, 16, v157
  v_and_b32 v95, s54, v157
  v_lshlrev_b32 v4, 16, v158
  v_and_b32 v5, s54, v158
  v_lshlrev_b32 v6, 16, v159
  v_and_b32 v7, s54, v159
  v_pk_fma_f32 v[92:93], v[4:5], s[62:63], v[92:93]
  v_pk_fma_f32 v[94:95], v[6:7], s[62:63], v[94:95]
  s_branch L_k2_y
L_k2_rev:
  s_waitcnt lgkmcnt(14)
  v_lshlrev_b32 v67, 16, v128
  v_and_b32 v66, s54, v128
  v_lshlrev_b32 v65, 16, v129
  v_and_b32 v64, s54, v129
  v_lshlrev_b32 v7, 16, v130
  v_and_b32 v6, s54, v130
  v_lshlrev_b32 v5, 16, v131
  v_and_b32 v4, s54, v131
  v_pk_fma_f32 v[64:65], v[4:5], s[62:63], v[64:65]
  v_pk_fma_f32 v[66:67], v[6:7], s[62:63], v[66:67]
  s_waitcnt lgkmcnt(12)
  v_lshlrev_b32 v71, 16, v132
  v_and_b32 v70, s54, v132
  v_lshlrev_b32 v69, 16, v133
  v_and_b32 v68, s54, v133
  v_lshlrev_b32 v7, 16, v134
  v_and_b32 v6, s54, v134
  v_lshlrev_b32 v5, 16, v135
  v_and_b32 v4, s54, v135
  v_pk_fma_f32 v[68:69], v[4:5], s[62:63], v[68:69]
  v_pk_fma_f32 v[70:71], v[6:7], s[62:63], v[70:71]
  s_waitcnt lgkmcnt(10)
  v_lshlrev_b32 v75, 16, v136
  v_and_b32 v74, s54, v136
  v_lshlrev_b32 v73, 16, v137
  v_and_b32 v72, s54, v137
  v_lshlrev_b32 v7, 16, v138
  v_and_b32 v6, s54, v138
  v_lshlrev_b32 v5, 16, v139
  v_and_b32 v4, s54, v139
  v_pk_fma_f32 v[72:73], v[4:5], s[62:63], v[72:73]
  v_pk_fma_f32 v[74:75], v[6:7], s[62:63], v[74:75]
  s_waitcnt lgkmcnt(8)
  v_lshlrev_b32 v79, 16, v140
  v_and_b32 v78, s54, v140
  v_lshlrev_b32 v77, 16, v141
  v_and_b32 v76, s54, v141
  v_lshlrev_b32 v7, 16, v142
  v_and_b32 v6, s54, v142
  v_lshlrev_b32 v5, 16, v143
  v_and_b32 v4, s54, v143
  v_pk_fma_f32 v[76:77], v[4:5], s[62:63], v[76:77]
  v_pk_fma_f32 v[78:79], v[6:7], s[62:63], v[78:79]
  s_waitcnt lgkmcnt(6)
  v_lshlrev_b32 v83, 16, v144
  v_and_b32 v82, s54, v144
  v_lshlrev_b32 v81, 16, v145
  v_and_b32 v80, s54, v145
  v_lshlrev_b32 v7, 16, v146
  v_and_b32 v6, s54, v146
  v_lshlrev_b32 v5, 16, v147
  v_and_b32 v4, s54, v147
  v_pk_fma_f32 v[80:81], v[4:5], s[62:63], v[80:81]
  v_pk_fma_f32 v[82:83], v[6:7], s[62:63], v[82:83]
  s_waitcnt lgkmcnt(4)
  v_lshlrev_b32 v87, 16, v148
  v_and_b32 v86, s54, v148
  v_lshlrev_b32 v85, 16, v149
  v_and_b32 v84, s54, v149
  v_lshlrev_b32 v7, 16, v150
  v_and_b32 v6, s54, v150
  v_lshlrev_b32 v5, 16, v151
  v_and_b32 v4, s54, v151
  v_pk_fma_f32 v[84:85], v[4:5], s[62:63], v[84:85]
  v_pk_fma_f32 v[86:87], v[6:7], s[62:63], v[86:87]
  s_waitcnt lgkmcnt(2)
  v_lshlrev_b32 v91, 16, v152
  v_and_b32 v90, s54, v152
  v_lshlrev_b32 v89, 16, v153
  v_and_b32 v88, s54, v153
  v_lshlrev_b32 v7, 16, v154
  v_and_b32 v6, s54, v154
  v_lshlrev_b32 v5, 16, v155
  v_and_b32 v4, s54, v155
  v_pk_fma_f32 v[88:89], v[4:5], s[62:63], v[88:89]
  v_pk_fma_f32 v[90:91], v[6:7], s[62:63], v[90:91]
  s_waitcnt lgkmcnt(0)
  v_lshlrev_b32 v95, 16, v156
  v_and_b32 v94, s54, v156
  v_lshlrev_b32 v93, 16, v157
  v_and_b32 v92, s54, v157
  v_lshlrev_b32 v7, 16, v158
  v_and_b32 v6, s54, v158
  v_lshlrev_b32 v5, 16, v159
  v_and_b32 v4, s54, v159
  v_pk_fma_f32 v[92:93], v[4:5], s[62:63], v[92:93]
  v_pk_fma_f32 v[94:95], v[6:7], s[62:63], v[94:95]
L_k2_y:
  ds_read_b64 v[128:129], v168
  ds_read_b64 v[130:131], v169
  ds_read_b64 v[132:133], v170
  ds_read_b64 v[134:135], v171
  ds_read_b64 v[136:137], v172
  ds_read_b64 v[138:139], v173
  ds_read_b64 v[140:141], v174
  ds_read_b64 v[142:143], v175
  s_waitcnt vmcnt(0)
  s_mov_b64 exec, 3
  buffer_store_dword v28, v27, s[28:31], 0 offen sc1
  s_mov_b64 exec, -1
  buffer_load_dword v30, v23, s[28:31], 0 offen sc1
  s_waitcnt lgkmcnt(7)
  v_lshlrev_b32 v96, 16, v128
  v_and_b32 v97, s54, v128
  v_lshlrev_b32 v98, 16, v129
  v_and_b32 v99, s54, v129
  s_waitcnt lgkmcnt(6)
  v_lshlrev_b32 v100, 16, v130
  v_and_b32 v101, s54, v130
  v_lshlrev_b32 v102, 16, v131
  v_and_b32 v103, s54, v131
  s_waitcnt lgkmcnt(5)
  v_lshlrev_b32 v104, 16, v132
  v_and_b32 v105, s54, v132
  v_lshlrev_b32 v106, 16, v133
  v_and_b32 v107, s54, v133
  s_waitcnt lgkmcnt(4)
  v_lshlrev_b32 v108, 16, v134
  v_and_b32 v109, s54, v134
  v_lshlrev_b32 v110, 16, v135
  v_and_b32 v111, s54, v135
  s_waitcnt lgkmcnt(3)
  v_lshlrev_b32 v112, 16, v136
  v_and_b32 v113, s54, v136
  v_lshlrev_b32 v114, 16, v137
  v_and_b32 v115, s54, v137
  s_waitcnt lgkmcnt(2)
  v_lshlrev_b32 v116, 16, v138
  v_and_b32 v117, s54, v138
  v_lshlrev_b32 v118, 16, v139
  v_and_b32 v119, s54, v139
  s_waitcnt lgkmcnt(1)
  v_lshlrev_b32 v120, 16, v140
  v_and_b32 v121, s54, v140
  v_lshlrev_b32 v122, 16, v141
  v_and_b32 v123, s54, v141
  s_waitcnt lgkmcnt(0)
  v_lshlrev_b32 v124, 16, v142
  v_and_b32 v125, s54, v142
  v_lshlrev_b32 v126, 16, v143
  v_and_b32 v127, s54, v143
  s_waitcnt vmcnt(0)
  s_branch spc_41
sp_39:
  buffer_load_dword v30, v23, s[28:31], 0 offen sc1
  s_waitcnt vmcnt(0)
spc_41:
  v_subrev_u32 v30, s100, v30
  v_subrev_u32 v30, 7, v30
  v_cmp_lt_u32 vcc, 7, v30
  s_sub_u32 s101, s101, 1
  s_cbranch_scc1 spd_40
  s_cbranch_vccnz sp_39
spd_40:
  s_add_u32 s4, s53, 0
  buffer_load_dwordx4 v[208:211], v29, s[24:27], s4 offen offset:0 sc1
  s_add_u32 s4, s53, 16384
  buffer_load_dwordx4 v[224:227], v29, s[24:27], s4 offen offset:0 sc1
  s_add_u32 s4, s53, 32768
  buffer_load_dwordx4 v[240:243], v29, s[24:27], s4 offen offset:0 sc1
  s_add_u32 s4, s53, 0
  buffer_load_dwordx4 v[212:215], v29, s[24:27], s4 offen offset:1024 sc1
  s_add_u32 s4, s53, 16384
  buffer_load_dwordx4 v[228:231], v29, s[24:27], s4 offen offset:1024 sc1
  s_add_u32 s4, s53, 32768
  buffer_load_dwordx4 v[244:247], v29, s[24:27], s4 offen offset:1024 sc1
  s_add_u32 s4, s53, 0
  buffer_load_dwordx4 v[216:219], v29, s[24:27], s4 offen offset:2048 sc1
  s_add_u32 s4, s53, 16384
  buffer_load_dwordx4 v[232:235], v29, s[24:27], s4 offen offset:2048 sc1
  s_add_u32 s4, s53, 32768
  buffer_load_dwordx4 v[248:251], v29, s[24:27], s4 offen offset:2048 sc1
  s_add_u32 s4, s53, 0
  buffer_load_dwordx4 v[220:223], v29, s[24:27], s4 offen offset:3072 sc1
  s_add_u32 s4, s53, 16384
  buffer_load_dwordx4 v[236:239], v29, s[24:27], s4 offen offset:3072 sc1
  s_add_u32 s4, s53, 32768
  buffer_load_dwordx4 v[252:255], v29, s[24:27], s4 offen offset:3072 sc1
  s_waitcnt vmcnt(9)
  v_dot2c_f32_bf16 v32, s48, v208
  v_dot2c_f32_bf16 v33, s49, v208
  v_dot2c_f32_bf16 v34, s48, v209
  v_dot2c_f32_bf16 v35, s49, v209
  v_dot2c_f32_bf16 v32, s48, v224
  v_dot2c_f32_bf16 v33, s49, v224
  v_dot2c_f32_bf16 v34, s48, v225
  v_dot2c_f32_bf16 v35, s49, v225
  v_dot2c_f32_bf16 v32, s48, v240
  v_dot2c_f32_bf16 v33, s49, v240
  v_dot2c_f32_bf16 v34, s48, v241
  v_dot2c_f32_bf16 v35, s49, v241
  s_nop 1
  v_pk_mul_f32 v[4:5], v[32:33], s[44:45]
  v_pk_mul_f32 v[6:7], v[34:35], s[44:45]
  v_exp_f32 v4, v4
  v_exp_f32 v5, v5
  v_exp_f32 v6, v6
  v_exp_f32 v7, v7
  s_nop 0
  v_pk_add_f32 v[4:5], v[4:5], s[46:47]
  v_pk_add_f32 v[6:7], v[6:7], s[46:47]
  v_rcp_f32 v4, v4
  v_rcp_f32 v5, v5
  v_rcp_f32 v6, v6
  v_rcp_f32 v7, v7
  v_pk_mul_f32 v[64:65], v[64:65], v[32:33]
  v_pk_mul_f32 v[66:67], v[66:67], v[34:35]
  v_pk_fma_f32 v[96:97], v[4:5], v[64:65], v[96:97]
  v_pk_fma_f32 v[98:99], v[6:7], v[66:67], v[98:99]
  v_cvt_pk_bf16_f32 v96, v96, v97
  v_cvt_pk_bf16_f32 v97, v98, v99
  ds_write_b64 v168, v[96:97]
  v_dot2c_f32_bf16 v36, s48, v210
  v_dot2c_f32_bf16 v37, s49, v210
  v_dot2c_f32_bf16 v38, s48, v211
  v_dot2c_f32_bf16 v39, s49, v211
  v_dot2c_f32_bf16 v36, s48, v226
  v_dot2c_f32_bf16 v37, s49, v226
  v_dot2c_f32_bf16 v38, s48, v227
  v_dot2c_f32_bf16 v39, s49, v227
  v_dot2c_f32_bf16 v36, s48, v242
  v_dot2c_f32_bf16 v37, s49, v242
  v_dot2c_f32_bf16 v38, s48, v243
  v_dot2c_f32_bf16 v39, s49, v243
  s_nop 1
  v_pk_mul_f32 v[4:5], v[36:37], s[44:45]
  v_pk_mul_f32 v[6:7], v[38:39], s[44:45]
  v_exp_f32 v4, v4
  v_exp_f32 v5, v5
  v_exp_f32 v6, v6
  v_exp_f32 v7, v7
  s_nop 0
  v_pk_add_f32 v[4:5], v[4:5], s[46:47]
  v_pk_add_f32 v[6:7], v[6:7], s[46:47]
  v_rcp_f32 v4, v4
  v_rcp_f32 v5, v5
  v_rcp_f32 v6, v6
  v_rcp_f32 v7, v7
  v_pk_mul_f32 v[68:69], v[68:69], v[36:37]
  v_pk_mul_f32 v[70:71], v[70:71], v[38:39]
  v_pk_fma_f32 v[100:101], v[4:5], v[68:69], v[100:101]
  v_pk_fma_f32 v[102:103], v[6:7], v[70:71], v[102:103]
  v_cvt_pk_bf16_f32 v100, v100, v101
  v_cvt_pk_bf16_f32 v101, v102, v103
  ds_write_b64 v169, v[100:101]
  s_waitcnt vmcnt(6)
  v_dot2c_f32_bf16 v40, s48, v212
  v_dot2c_f32_bf16 v41, s49, v212
  v_dot2c_f32_bf16 v42, s48, v213
  v_dot2c_f32_bf16 v43, s49, v213
  v_dot2c_f32_bf16 v40, s48, v228
  v_dot2c_f32_bf16 v41, s49, v228
  v_dot2c_f32_bf16 v42, s48, v229
  v_dot2c_f32_bf16 v43, s49, v229
  v_dot2c_f32_bf16 v40, s48, v244
  v_dot2c_f32_bf16 v41, s49, v244
  v_dot2c_f32_bf16 v42, s48, v245
  v_dot2c_f32_bf16 v43, s49, v245
  s_nop 1
  v_pk_mul_f32 v[4:5], v[40:41], s[44:45]
  v_pk_mul_f32 v[6:7], v[42:43], s[44:45]
  v_exp_f32 v4, v4
  v_exp_f32 v5, v5
  v_exp_f32 v6, v6
  v_exp_f32 v7, v7
  s_nop 0
  v_pk_add_f32 v[4:5], v[4:5], s[46:47]
  v_pk_add_f32 v[6:7], v[6:7], s[46:47]
  v_rcp_f32 v4, v4
  v_rcp_f32 v5, v5
  v_rcp_f32 v6, v6
  v_rcp_f32 v7, v7
  v_pk_mul_f32 v[72:73], v[72:73], v[40:41]
  v_pk_mul_f32 v[74:75], v[74:75], v[42:43]
  v_pk_fma_f32 v[104:105], v[4:5], v[72:73], v[104:105]
  v_pk_fma_f32 v[106:107], v[6:7], v[74:75], v[106:107]
  v_cvt_pk_bf16_f32 v104, v104, v105
  v_cvt_pk_bf16_f32 v105, v106, v107
  ds_write_b64 v170, v[104:105]
  v_dot2c_f32_bf16 v44, s48, v214
  v_dot2c_f32_bf16 v45, s49, v214
  v_dot2c_f32_bf16 v46, s48, v215
  v_dot2c_f32_bf16 v47, s49, v215
  v_dot2c_f32_bf16 v44, s48, v230
  v_dot2c_f32_bf16 v45, s49, v230
  v_dot2c_f32_bf16 v46, s48, v231
  v_dot2c_f32_bf16 v47, s49, v231
  v_dot2c_f32_bf16 v44, s48, v246
  v_dot2c_f32_bf16 v45, s49, v246
  v_dot2c_f32_bf16 v46, s48, v247
  v_dot2c_f32_bf16 v47, s49, v247
  s_nop 1
  v_pk_mul_f32 v[4:5], v[44:45], s[44:45]
  v_pk_mul_f32 v[6:7], v[46:47], s[44:45]
  v_exp_f32 v4, v4
  v_exp_f32 v5, v5
  v_exp_f32 v6, v6
  v_exp_f32 v7, v7
  s_nop 0
  v_pk_add_f32 v[4:5], v[4:5], s[46:47]
  v_pk_add_f32 v[6:7], v[6:7], s[46:47]
  v_rcp_f32 v4, v4
  v_rcp_f32 v5, v5
  v_rcp_f32 v6, v6
  v_rcp_f32 v7, v7
  v_pk_mul_f32 v[76:77], v[76:77], v[44:45]
  v_pk_mul_f32 v[78:79], v[78:79], v[46:47]
  v_pk_fma_f32 v[108:109], v[4:5], v[76:77], v[108:109]
  v_pk_fma_f32 v[110:111], v[6:7], v[78:79], v[110:111]
  v_cvt_pk_bf16_f32 v108, v108, v109
  v_cvt_pk_bf16_f32 v109, v110, v111
  ds_write_b64 v171, v[108:109]
  s_waitcnt vmcnt(3)
  v_dot2c_f32_bf16 v48, s48, v216
  v_dot2c_f32_bf16 v49, s49, v216
  v_dot2c_f32_bf16 v50, s48, v217
  v_dot2c_f32_bf16 v51, s49, v217
  v_dot2c_f32_bf16 v48, s48, v232
  v_dot2c_f32_bf16 v49, s49, v232
  v_dot2c_f32_bf16 v50, s48, v233
  v_dot2c_f32_bf16 v51, s49, v233
  v_dot2c_f32_bf16 v48, s48, v248
  v_dot2c_f32_bf16 v49, s49, v248
  v_dot2c_f32_bf16 v50, s48, v249
  v_dot2c_f32_bf16 v51, s49, v249
  s_nop 1
  v_pk_mul_f32 v[4:5], v[48:49], s[44:45]
  v_pk_mul_f32 v[6:7], v[50:51], s[44:45]
  v_exp_f32 v4, v4
  v_exp_f32 v5, v5
  v_exp_f32 v6, v6
  v_exp_f32 v7, v7
  s_nop 0
  v_pk_add_f32 v[4:5], v[4:5], s[46:47]
  v_pk_add_f32 v[6:7], v[6:7], s[46:47]
  v_rcp_f32 v4, v4
  v_rcp_f32 v5, v5
  v_rcp_f32 v6, v6
  v_rcp_f32 v7, v7
  v_pk_mul_f32 v[80:81], v[80:81], v[48:49]
  v_pk_mul_f32 v[82:83], v[82:83], v[50:51]
  v_pk_fma_f32 v[112:113], v[4:5], v[80:81], v[112:113]
  v_pk_fma_f32 v[114:115], v[6:7], v[82:83], v[114:115]
  v_cvt_pk_bf16_f32 v112, v112, v113
  v_cvt_pk_bf16_f32 v113, v114, v115
  ds_write_b64 v172, v[112:113]
  v_dot2c_f32_bf16 v52, s48, v218
  v_dot2c_f32_bf16 v53, s49, v218
  v_dot2c_f32_bf16 v54, s48, v219
  v_dot2c_f32_bf16 v55, s49, v219
  v_dot2c_f32_bf16 v52, s48, v234
  v_dot2c_f32_bf16 v53, s49, v234
  v_dot2c_f32_bf16 v54, s48, v235
  v_dot2c_f32_bf16 v55, s49, v235
  v_dot2c_f32_bf16 v52, s48, v250
  v_dot2c_f32_bf16 v53, s49, v250
  v_dot2c_f32_bf16 v54, s48, v251
  v_dot2c_f32_bf16 v55, s49, v251
  s_nop 1
  v_pk_mul_f32 v[4:5], v[52:53], s[44:45]
  v_pk_mul_f32 v[6:7], v[54:55], s[44:45]
  v_exp_f32 v4, v4
  v_exp_f32 v5, v5
  v_exp_f32 v6, v6
  v_exp_f32 v7, v7
  s_nop 0
  v_pk_add_f32 v[4:5], v[4:5], s[46:47]
  v_pk_add_f32 v[6:7], v[6:7], s[46:47]
  v_rcp_f32 v4, v4
  v_rcp_f32 v5, v5
  v_rcp_f32 v6, v6
  v_rcp_f32 v7, v7
  v_pk_mul_f32 v[84:85], v[84:85], v[52:53]
  v_pk_mul_f32 v[86:87], v[86:87], v[54:55]
  v_pk_fma_f32 v[116:117], v[4:5], v[84:85], v[116:117]
  v_pk_fma_f32 v[118:119], v[6:7], v[86:87], v[118:119]
  v_cvt_pk_bf16_f32 v116, v116, v117
  v_cvt_pk_bf16_f32 v117, v118, v119
  ds_write_b64 v173, v[116:117]
  s_waitcnt vmcnt(0)
  v_dot2c_f32_bf16 v56, s48, v220
  v_dot2c_f32_bf16 v57, s49, v220
  v_dot2c_f32_bf16 v58, s48, v221
  v_dot2c_f32_bf16 v59, s49, v221
  v_dot2c_f32_bf16 v56, s48, v236
  v_dot2c_f32_bf16 v57, s49, v236
  v_dot2c_f32_bf16 v58, s48, v237
  v_dot2c_f32_bf16 v59, s49, v237
  v_dot2c_f32_bf16 v56, s48, v252
  v_dot2c_f32_bf16 v57, s49, v252
  v_dot2c_f32_bf16 v58, s48, v253
  v_dot2c_f32_bf16 v59, s49, v253
  s_nop 1
  v_pk_mul_f32 v[4:5], v[56:57], s[44:45]
  v_pk_mul_f32 v[6:7], v[58:59], s[44:45]
  v_exp_f32 v4, v4
  v_exp_f32 v5, v5
  v_exp_f32 v6, v6
  v_exp_f32 v7, v7
  s_nop 0
  v_pk_add_f32 v[4:5], v[4:5], s[46:47]
  v_pk_add_f32 v[6:7], v[6:7], s[46:47]
  v_rcp_f32 v4, v4
  v_rcp_f32 v5, v5
  v_rcp_f32 v6, v6
  v_rcp_f32 v7, v7
  v_pk_mul_f32 v[88:89], v[88:89], v[56:57]
  v_pk_mul_f32 v[90:91], v[90:91], v[58:59]
  v_pk_fma_f32 v[120:121], v[4:5], v[88:89], v[120:121]
  v_pk_fma_f32 v[122:123], v[6:7], v[90:91], v[122:123]
  v_cvt_pk_bf16_f32 v120, v120, v121
  v_cvt_pk_bf16_f32 v121, v122, v123
  ds_write_b64 v174, v[120:121]
  v_dot2c_f32_bf16 v60, s48, v222
  v_dot2c_f32_bf16 v61, s49, v222
  v_dot2c_f32_bf16 v62, s48, v223
  v_dot2c_f32_bf16 v63, s49, v223
  v_dot2c_f32_bf16 v60, s48, v238
  v_dot2c_f32_bf16 v61, s49, v238
  v_dot2c_f32_bf16 v62, s48, v239
  v_dot2c_f32_bf16 v63, s49, v239
  v_dot2c_f32_bf16 v60, s48, v254
  v_dot2c_f32_bf16 v61, s49, v254
  v_dot2c_f32_bf16 v62, s48, v255
  v_dot2c_f32_bf16 v63, s49, v255
  s_nop 1
  v_pk_mul_f32 v[4:5], v[60:61], s[44:45]
  v_pk_mul_f32 v[6:7], v[62:63], s[44:45]
  v_exp_f32 v4, v4
  v_exp_f32 v5, v5
  v_exp_f32 v6, v6
  v_exp_f32 v7, v7
  s_nop 0
  v_pk_add_f32 v[4:5], v[4:5], s[46:47]
  v_pk_add_f32 v[6:7], v[6:7], s[46:47]
  v_rcp_f32 v4, v4
  v_rcp_f32 v5, v5
  v_rcp_f32 v6, v6
  v_rcp_f32 v7, v7
  v_pk_mul_f32 v[92:93], v[92:93], v[60:61]
  v_pk_mul_f32 v[94:95], v[94:95], v[62:63]
  v_pk_fma_f32 v[124:125], v[4:5], v[92:93], v[124:125]
  v_pk_fma_f32 v[126:127], v[6:7], v[94:95], v[126:127]
  v_cvt_pk_bf16_f32 v124, v124, v125
  v_cvt_pk_bf16_f32 v125, v126, v127
  ds_write_b64 v175, v[124:125]
  ds_read_b128 v[128:131], v184
  ds_read_b128 v[132:135], v185
  ds_read_b128 v[136:139], v186
  ds_read_b128 v[140:143], v187
  s_waitcnt lgkmcnt(3)
  buffer_store_dwordx4 v[128:131], v188, s[20:23], s61 offen
  s_waitcnt lgkmcnt(2)
  buffer_store_dwordx4 v[132:135], v189, s[20:23], s61 offen
  s_waitcnt lgkmcnt(1)
  buffer_store_dwordx4 v[136:139], v190, s[20:23], s61 offen
  s_waitcnt lgkmcnt(0)
  buffer_store_dwordx4 v[140:143], v191, s[20:23], s61 offen
L_done:
  s_endpgm
L_end:
  s_endpgm
.section .rodata,"a"
.p2align 6
.amdhsa_kernel recurrent_scan__spectral_fnet__glu_gated_bilinear__prompt_kernel
  .amdhsa_next_free_vgpr 480
  .amdhsa_next_free_sgpr 102
  .amdhsa_accum_offset 256
  .amdhsa_group_segment_fixed_size 0
  .amdhsa_kernarg_size 96
  .amdhsa_user_sgpr_count 2
  .amdhsa_user_sgpr_kernarg_segment_ptr 1
  .amdhsa_system_sgpr_workgroup_id_x 1
.end_amdhsa_kernel
```
